```python
import torch

def _softmax(x, axis=-1):
    return torch.softmax(x, dim=axis)
def _gelu(x):
    return torch.nn.functional.gelu(x, approximate="tanh")
def _silu(x):
    return torch.nn.functional.silu(x)
def _sigmoid(x):
    return torch.sigmoid(x)
def _layernorm(x, axis=-1, eps=1e-5):
    m = x.mean(dim=axis, keepdim=True)
    v = x.var(dim=axis, keepdim=True, unbiased=False)
    return (x - m) / torch.sqrt(v + eps)
def _scatter_add(tgt, idx, src, axis=0):
    return tgt.clone().index_add_(axis, idx, src)
def _segment_sum(src, seg, n):
    out = torch.zeros((n,) + src.shape[1:], dtype=src.dtype)
    return out.index_add_(0, seg, src)
def _pad(x, pw):
    flat = tuple(v for pair in reversed(pw) for v in pair)
    return torch.nn.functional.pad(x, flat)

kernel_name = 'sequential_preLN__softmax_full_mha__glu_gated_glu__prompt'

def setup_inputs():

    _w = (lambda a: (lambda t: t.to(torch.bfloat16) if t.is_floating_point() else t)(torch.as_tensor(a)))
    def _A_setup():
        B, S, D = 1, 2048, 640
        return {
            "x": _w((lambda *s: torch.randn(*s, dtype=torch.bfloat16) * 0.05)(B, S, D)),
            "wqkv": _w((lambda *s: torch.randn(*s, dtype=torch.bfloat16) * 0.05)(D, 3 * D)),
            "wo": _w((lambda *s: torch.randn(*s, dtype=torch.bfloat16) * 0.05)(D, D)),
        }
    _A_in = _A_setup()

    def _B_setup():
        B, S, D, F = 1, 2048, 640, 1536
        return {
            "x": _w((lambda *s: torch.randn(*s, dtype=torch.bfloat16) * 0.05)(B, S, D)),
            "w_gate": _w((lambda *s: torch.randn(*s, dtype=torch.bfloat16) * 0.05)(D, F)),
            "w_up": _w((lambda *s: torch.randn(*s, dtype=torch.bfloat16) * 0.05)(D, F)),
            "w_down": _w((lambda *s: torch.randn(*s, dtype=torch.bfloat16) * 0.05)(F, D)),
        }
    _B_in = _B_setup()

    return {
        "A_x": _A_in["x"],
        "A_wqkv": _A_in["wqkv"],
        "A_wo": _A_in["wo"],
        "B_x": _B_in["x"],
        "B_w_gate": _B_in["w_gate"],
        "B_w_up": _B_in["w_up"],
        "B_w_down": _B_in["w_down"],
    }

def reference(A_x, A_wqkv, A_wo, B_x, B_w_gate, B_w_up, B_w_down):
    def _A_ref(x, wqkv, wo):
        B, S, D = x.shape
        H = 32; Dh = D // H
        qkv = (lambda x, *d: x.permute(*d))((x @ wqkv).reshape(B, S, 3, H, Dh), 2, 0, 3, 1, 4)
        q, k, v = qkv[0], qkv[1], qkv[2]
        scale = Dh ** -0.5
        scores = torch.einsum("bhqd,bhkd->bhqk", q, k) * scale
        p = _softmax(scores, axis=-1)
        o = torch.einsum("bhqk,bhkd->bhqd", p, v)
        return (lambda x, *d: x.permute(*d))(o, 0, 2, 1, 3).reshape(B, S, D) @ wo

    def _B_ref(x, w_gate, w_up, w_down):
        g = torch.einsum("bsd,df->bsf", x, w_gate)
        u = torch.einsum("bsd,df->bsf", x, w_up)
        h = _sigmoid(g) * u
        return torch.einsum("bsf,fd->bsd", h, w_down)

    x = A_x
    h = x + _A_ref(_layernorm(x, axis=-1), A_wqkv, A_wo)
    h2 = h + _B_ref(_layernorm(h, axis=-1), B_w_gate, B_w_up, B_w_down)
    return h2
```

```asm
; @launch grid=(256,1,1) block=(256,1,1) lds=163840
.amdgcn_target "amdgcn-amd-amdhsa--gfx950"
.text
.globl sequential_preLN__softmax_full_mha__glu_gated_glu__prompt_kernel
.p2align 12
.p2align 8
.type sequential_preLN__softmax_full_mha__glu_gated_glu__prompt_kernel,@function
sequential_preLN__softmax_full_mha__glu_gated_glu__prompt_kernel:
    s_load_dwordx2 s[12:13], s[0:1], 0
    s_load_dwordx2 s[16:17], s[0:1], 8
    s_load_dwordx2 s[48:49], s[0:1], 64
    s_load_dwordx2 s[20:21], s[0:1], 72
    s_cmp_ge_u32 s2, 256
    s_cbranch_scc1 L_end
    v_lshrrev_b32 v1, 6, v0
    v_and_b32 v2, 63, v0
    s_and_b32 s30, s2, 7
    v_readfirstlane_b32 s24, v1
    s_lshr_b32 s31, s2, 3
    s_getpc_b64 s[36:37]
L_pc:
    s_lshl_b32 s38, s24, 5
    s_add_u32 s38, s38, s31
    s_lshl_b32 s38, s38, 13
    s_cmp_gt_u32 s38, L_codeend-L_pc
    s_cbranch_scc1 L_nocpf
    v_lshlrev_b32 v4, 7, v2
    v_add_u32 v4, s38, v4
    v_min_u32 v4, L_codeend-L_pc, v4
    v_add_co_u32 v4, vcc, s36, v4
    v_mov_b32 v5, s37
    s_nop 0
    v_addc_co_u32 v5, vcc, 0, v5, vcc
    global_load_dword v252, v[4:5], off
L_nocpf:
    s_and_b32 s32, s31, 3
    s_and_b32 s25, s30, 3
    s_lshl2_add_u32 s25, s25, s32
    s_lshr_b32 s34, s31, 2
    s_lshr_b32 s26, s30, 2
    s_lshl3_add_u32 s26, s26, s34
    s_lshl2_add_u32 s27, s25, s24
    s_mul_i32 s28, s27, 40960
    v_lshrrev_b32 v13, 4, v2
    s_mov_b32 s14, 2621440
    s_mov_b32 s15, 0x00020000
    s_mov_b32 s18, 2457600
    s_mov_b32 s19, 0x00020000
    s_mov_b32 s22, 33554432
    s_mov_b32 s23, 0x00020000
    s_mov_b32 s50, 256
    s_mov_b32 s51, 0x00020000
    s_cmp_eq_u32 s26, 15
    s_cbranch_scc1 L_aux
    s_add_u32 s53, s34, s32
    s_and_b32 s53, s53, 1
    s_lshl_b32 s64, s30, 2
    s_lshr_b32 s64, 0x4404040, s64
    s_and_b32 s64, s64, 15
    s_mul_i32 s29, s24, 61440
    s_lshl_b32 s34, s26, 8
    s_add_u32 s29, s29, s34
    s_lshl_b32 s35, s24, 12
    v_lshrrev_b32 v3, 3, v2
    v_mul_u32_u24 v12, 1280, v3
    v_and_b32 v14, 7, v2
    v_xor_b32 v15, v14, v13
    v_xor_b32 v16, 4, v15
    v_lshl_add_u32 v4, v15, 4, v12
    v_lshl_add_u32 v5, v16, 4, v12
    v_add_u32 v6, 18432, v4
    v_add_u32 v7, 27648, v5
    v_add_u32 v5, 9216, v5
    v_mul_u32_u24 v12, 3840, v13
    v_and_b32 v14, 15, v2
    v_lshlrev_b32 v15, 2, v13
    v_xor_b32 v14, v14, v15
    v_lshl_add_u32 v8, v14, 4, v12
    v_add_u32 v9, 14336, v8
    v_add_u32 v10, 28672, v8
    v_add_u32 v11, 43008, v8
    s_cmp_eq_u32 s53, 0
    s_cselect_b32 s47, 0, 1
    s_add_u32 s47, s47, s64
    s_sub_u32 s46, s47, 10
    s_cselect_b32 s47, s47, s46
    s_lshl_b32 s46, s47, 7
    s_add_u32 s46, s46, s28
    s_mul_i32 s47, s47, 245760
    s_add_u32 m0, s35, 65536
    s_add_u32 s47, s47, s29
    s_waitcnt lgkmcnt(0)
    buffer_load_dwordx4 v4, s[12:15], s46 offen lds
    buffer_load_dwordx4 v5, s[12:15], s46 offen offset:1024 lds
    buffer_load_dwordx4 v6, s[12:15], s46 offen offset:2048 lds
    buffer_load_dwordx4 v7, s[12:15], s46 offen offset:3072 lds
    s_add_u32 m0, s35, 0
    s_nop 0
    buffer_load_dwordx4 v8, s[16:19], s47 offen lds
    buffer_load_dwordx4 v9, s[16:19], s47 offen offset:1024 lds
    buffer_load_dwordx4 v10, s[16:19], s47 offen offset:2048 lds
    buffer_load_dwordx4 v11, s[16:19], s47 offen offset:3072 lds
    s_cmp_eq_u32 s53, 0
    s_cselect_b32 s47, 1, 0
    s_add_u32 s47, s47, s64
    s_sub_u32 s46, s47, 10
    s_cselect_b32 s47, s47, s46
    s_lshl_b32 s46, s47, 7
    s_add_u32 s46, s46, s28
    s_mul_i32 s47, s47, 245760
    s_add_u32 m0, s35, 81920
    s_add_u32 s47, s47, s29
    buffer_load_dwordx4 v4, s[12:15], s46 offen lds
    buffer_load_dwordx4 v5, s[12:15], s46 offen offset:1024 lds
    buffer_load_dwordx4 v6, s[12:15], s46 offen offset:2048 lds
    buffer_load_dwordx4 v7, s[12:15], s46 offen offset:3072 lds
    v_mul_u32_u24 v54, 1280, v13
    v_and_b32 v14, 15, v2
    v_lshl_add_u32 v54, v14, 4, v54
    v_lshlrev_b32 v53, 2, v13
    v_and_b32 v14, 15, v2
    v_lshl_add_u32 v53, v14, 25, v53
    v_lshlrev_b32 v55, 25, v2
    v_mov_b32 v52, 1
    s_and_b32 s54, s26, 7
    s_lshl2_add_u32 s54, s54, s24
    s_mul_i32 s57, s54, 5120
    s_mul_i32 s52, s25, 163840
    s_add_u32 s57, s57, s52
    s_lshl_b32 s58, s25, 9
    s_lshl4_add_u32 s58, s54, s58
    s_add_u32 s58, s58, 27402240
    s_lshl_b32 s56, s25, 8
    s_add_u32 s56, s56, 27168768
    s_cmp_ge_u32 s26, 8
    s_cselect_b32 s57, s57, 0x40000000
    s_cselect_b32 s58, s58, 0x2000000
    s_cselect_b32 s55, s56, 0x2000000
    s_add_u32 s59, s58, 8192
    s_cmp_eq_u32 s24, 0
    s_cselect_b32 s55, s55, 0x2000000
    s_mov_b32 s40, 1065369472
    v_mov_b32 v1, 0
    v_lshrrev_b32 v12, 5, v2
    v_and_b32 v13, 31, v2
    v_bfe_u32 v17, v2, 2, 2
    v_lshlrev_b32 v14, 8, v17
    v_bfe_u32 v15, v2, 4, 1
    v_lshl_add_u32 v14, v15, 5, v14
    v_and_b32 v15, 3, v2
    v_bfrev_b32 v16, v15
    v_lshrrev_b32 v16, 30, v16
    s_cmp_lt_u32 s26, 10
    s_cselect_b64 vcc, -1, 0
    v_cndmask_b32 v15, v15, v16, vcc
    v_lshl_add_u32 v14, v15, 3, v14
    v_lshl_add_u32 v14, v12, 11, v14
    v_xor_b32 v15, s24, v17
    v_lshl_add_u32 v176, v15, 6, v14
    v_xor_b32 v15, 1, v15
    v_lshl_add_u32 v177, v15, 6, v14
    v_bfe_u32 v15, v2, 1, 3
    v_xor_b32 v15, v15, v12
    v_lshlrev_b32 v16, 7, v13
    s_and_b32 s33, s24, 1
    s_lshl_b32 s38, s33, 13
    s_add_u32 s38, s38, 65536
    v_add_u32 v16, s38, v16
    v_xor_b32 v17, 0, v15
    v_lshl_add_u32 v24, v17, 4, v16
    v_xor_b32 v17, 2, v15
    v_lshl_add_u32 v25, v17, 4, v16
    v_xor_b32 v17, 4, v15
    v_lshl_add_u32 v26, v17, 4, v16
    v_xor_b32 v17, 6, v15
    v_lshl_add_u32 v27, v17, 4, v16
    v_lshrrev_b32 v17, 2, v2
    v_xor_b32 v17, v17, v2
    v_and_b32 v17, 4, v17
    v_cmp_eq_u32 vcc, 0, v17
    v_mov_b32 v17, 1065369472
    s_nop 0
    v_cndmask_b32 v56, 0, v17, vcc
    v_mov_b32 v57, v56
    v_mov_b32 v58, v56
    v_mov_b32 v59, v56
    v_lshlrev_b32 v14, 4, v13
    v_lshlrev_b32 v22, 2, v13
    s_lshl_b32 s36, s24, 7
    s_add_u32 s36, s36, 131072
    v_add_u32 v21, s36, v22
    v_xor_b32 v20, 128, v21
    v_lshlrev_b32 v23, 4, v12
    v_mov_b32 v165, 0
    v_mov_b32 v169, 0
    v_mov_b32 v171, 0
    s_lshl1_add_u32 s34, s25, s33
    buffer_load_dwordx4 v[224:227], v54, s[12:15], s57 offen offset:0
    buffer_load_dwordx4 v[228:231], v54, s[12:15], s57 offen offset:256
    buffer_load_dwordx4 v[232:235], v54, s[12:15], s57 offen offset:512
    buffer_load_dwordx4 v[236:239], v54, s[12:15], s57 offen offset:768
    buffer_load_dwordx4 v[240:243], v54, s[12:15], s57 offen offset:1024
    s_lshl_b32 s41, s34, 8
    s_add_u32 s41, s41, 27402240
    s_add_u32 s42, s41, 8192
    s_cmp_ge_u32 s26, 10
    s_cbranch_scc0 L_qloop
L_vloop:
    s_sub_u32 s37, s26, 10
    s_lshl2_add_u32 s37, s37, s24
    s_lshl_b32 s37, s37, 17
    s_lshl_b32 s38, s34, 12
    s_add_u32 s37, s37, s38
    s_xor_b32 s38, s37, 0x20000
    s_add_u32 s60, s37, 5242880
    s_add_u32 s61, s38, 5242880
    v_lshlrev_b32 v19, 4, v2
    s_waitcnt vmcnt(9)
    s_barrier
    ds_read_b128 v[40:43], v24 offset:0
    ds_read_b64_tr_b16 v[32:33], v176 offset:0
    ds_read_b64_tr_b16 v[34:35], v176 offset:1024
    ds_read_b128 v[44:47], v24 offset:4096
    ds_read_b64_tr_b16 v[36:37], v177 offset:0
    ds_read_b64_tr_b16 v[38:39], v177 offset:1024
    s_waitcnt lgkmcnt(3)
    v_mfma_f32_32x32x16_bf16 v[64:79], v[40:43], v[32:35], 0
    ds_read_b128 v[136:139], v25 offset:0
    ds_read_b64_tr_b16 v[128:129], v176 offset:4096
    ds_read_b64_tr_b16 v[130:131], v176 offset:5120
    s_waitcnt lgkmcnt(5)
    v_mfma_f32_32x32x16_bf16 v[80:95], v[44:47], v[32:35], 0
    ds_read_b128 v[140:143], v25 offset:4096
    ds_read_b64_tr_b16 v[132:133], v177 offset:4096
    ds_read_b64_tr_b16 v[134:135], v177 offset:5120
    s_add_u32 m0, s35, 16384
    s_nop 0
    buffer_load_dwordx4 v8, s[16:19], s47 offen lds
    s_waitcnt lgkmcnt(6)
    v_mfma_f32_32x32x16_bf16 v[96:111], v[40:43], v[36:39], 0
    buffer_load_dwordx4 v9, s[16:19], s47 offen offset:1024 lds
    v_mfma_f32_32x32x16_bf16 v[112:127], v[44:47], v[36:39], 0
    buffer_load_dwordx4 v10, s[16:19], s47 offen offset:2048 lds
    v_mfma_f32_16x16x32_bf16 v[160:163], v[56:59], v[32:35], 0
    s_waitcnt lgkmcnt(3)
    v_mfma_f32_32x32x16_bf16 v[64:79], v[136:139], v[128:131], v[64:79]
    ds_read_b128 v[40:43], v26 offset:0
    ds_read_b64_tr_b16 v[32:33], v176 offset:8192
    ds_read_b64_tr_b16 v[34:35], v176 offset:9216
    s_waitcnt lgkmcnt(5)
    v_mfma_f32_32x32x16_bf16 v[80:95], v[140:143], v[128:131], v[80:95]
    ds_read_b128 v[44:47], v26 offset:4096
    ds_read_b64_tr_b16 v[36:37], v177 offset:8192
    ds_read_b64_tr_b16 v[38:39], v177 offset:9216
    buffer_load_dwordx4 v11, s[16:19], s47 offen offset:3072 lds
    s_waitcnt lgkmcnt(6)
    v_mfma_f32_32x32x16_bf16 v[96:111], v[136:139], v[132:135], v[96:111]
    s_cmp_eq_u32 s53, 0
    s_cselect_b32 s47, 2, 3
    s_add_u32 s47, s47, s64
    s_sub_u32 s46, s47, 10
    s_cselect_b32 s47, s47, s46
    s_lshl_b32 s46, s47, 7
    s_add_u32 s46, s46, s28
    s_mul_i32 s47, s47, 245760
    s_add_u32 m0, s35, 98304
    s_add_u32 s47, s47, s29
    buffer_load_dwordx4 v4, s[12:15], s46 offen lds
    v_mfma_f32_32x32x16_bf16 v[112:127], v[140:143], v[132:135], v[112:127]
    buffer_load_dwordx4 v5, s[12:15], s46 offen offset:1024 lds
    v_mfma_f32_16x16x32_bf16 v[160:163], v[56:59], v[128:131], v[160:163]
    s_waitcnt lgkmcnt(3)
    v_mfma_f32_32x32x16_bf16 v[64:79], v[40:43], v[32:35], v[64:79]
    ds_read_b128 v[136:139], v27 offset:0
    ds_read_b64_tr_b16 v[128:129], v176 offset:12288
    ds_read_b64_tr_b16 v[130:131], v176 offset:13312
    s_waitcnt lgkmcnt(5)
    v_mfma_f32_32x32x16_bf16 v[80:95], v[44:47], v[32:35], v[80:95]
    ds_read_b128 v[140:143], v27 offset:4096
    ds_read_b64_tr_b16 v[132:133], v177 offset:12288
    ds_read_b64_tr_b16 v[134:135], v177 offset:13312
    buffer_load_dwordx4 v6, s[12:15], s46 offen offset:2048 lds
    s_waitcnt lgkmcnt(6)
    v_mfma_f32_32x32x16_bf16 v[96:111], v[40:43], v[36:39], v[96:111]
    buffer_load_dwordx4 v7, s[12:15], s46 offen offset:3072 lds
    v_mfma_f32_32x32x16_bf16 v[112:127], v[44:47], v[36:39], v[112:127]
    s_add_u32 m0, s35, 32768
    s_nop 0
    buffer_load_dwordx4 v8, s[16:19], s47 offen lds
    v_mfma_f32_16x16x32_bf16 v[160:163], v[56:59], v[32:35], v[160:163]
    s_waitcnt vmcnt(5)
    s_barrier
    s_waitcnt lgkmcnt(3)
    v_mfma_f32_32x32x16_bf16 v[64:79], v[136:139], v[128:131], v[64:79]
    ds_read_b128 v[40:43], v24 offset:16384
    ds_read_b64_tr_b16 v[32:33], v176 offset:16384
    ds_read_b64_tr_b16 v[34:35], v176 offset:17408
    s_waitcnt lgkmcnt(5)
    v_mfma_f32_32x32x16_bf16 v[80:95], v[140:143], v[128:131], v[80:95]
    ds_read_b128 v[44:47], v24 offset:20480
    ds_read_b64_tr_b16 v[36:37], v177 offset:16384
    ds_read_b64_tr_b16 v[38:39], v177 offset:17408
    buffer_load_dwordx4 v9, s[16:19], s47 offen offset:1024 lds
    s_waitcnt lgkmcnt(6)
    v_mfma_f32_32x32x16_bf16 v[96:111], v[136:139], v[132:135], v[96:111]
    buffer_load_dwordx4 v10, s[16:19], s47 offen offset:2048 lds
    v_mfma_f32_32x32x16_bf16 v[112:127], v[140:143], v[132:135], v[112:127]
    buffer_load_dwordx4 v11, s[16:19], s47 offen offset:3072 lds
    v_mfma_f32_16x16x32_bf16 v[160:163], v[56:59], v[128:131], v[160:163]
    s_waitcnt lgkmcnt(3)
    v_mfma_f32_32x32x16_bf16 v[64:79], v[40:43], v[32:35], v[64:79]
    ds_read_b128 v[136:139], v25 offset:16384
    ds_read_b64_tr_b16 v[128:129], v176 offset:20480
    ds_read_b64_tr_b16 v[130:131], v176 offset:21504
    s_waitcnt lgkmcnt(5)
    v_mfma_f32_32x32x16_bf16 v[80:95], v[44:47], v[32:35], v[80:95]
    ds_read_b128 v[140:143], v25 offset:20480
    ds_read_b64_tr_b16 v[132:133], v177 offset:20480
    ds_read_b64_tr_b16 v[134:135], v177 offset:21504
    s_cmp_eq_u32 s53, 0
    s_cselect_b32 s47, 3, 2
    s_add_u32 s47, s47, s64
    s_sub_u32 s46, s47, 10
    s_cselect_b32 s47, s47, s46
    s_lshl_b32 s46, s47, 7
    s_add_u32 s46, s46, s28
    s_mul_i32 s47, s47, 245760
    s_add_u32 m0, s35, 114688
    s_add_u32 s47, s47, s29
    buffer_load_dwordx4 v4, s[12:15], s46 offen lds
    s_waitcnt lgkmcnt(6)
    v_mfma_f32_32x32x16_bf16 v[96:111], v[40:43], v[36:39], v[96:111]
    buffer_load_dwordx4 v5, s[12:15], s46 offen offset:1024 lds
    v_mfma_f32_32x32x16_bf16 v[112:127], v[44:47], v[36:39], v[112:127]
    buffer_load_dwordx4 v6, s[12:15], s46 offen offset:2048 lds
    v_mov_b32 v60, 0
    v_mov_b32 v61, 0
    v_dot2c_f32_bf16 v60, s40, v224
    v_dot2c_f32_bf16 v61, v224, v224
    v_dot2c_f32_bf16 v60, s40, v225
    v_dot2c_f32_bf16 v61, v225, v225
    v_dot2c_f32_bf16 v60, s40, v226
    v_dot2c_f32_bf16 v61, v226, v226
    v_dot2c_f32_bf16 v60, s40, v227
    v_dot2c_f32_bf16 v61, v227, v227
    v_dot2c_f32_bf16 v60, s40, v228
    v_dot2c_f32_bf16 v61, v228, v228
    v_dot2c_f32_bf16 v60, s40, v229
    v_dot2c_f32_bf16 v61, v229, v229
    v_dot2c_f32_bf16 v60, s40, v230
    v_dot2c_f32_bf16 v61, v230, v230
    v_mfma_f32_16x16x32_bf16 v[160:163], v[56:59], v[32:35], v[160:163]
    s_waitcnt lgkmcnt(3)
    v_mfma_f32_32x32x16_bf16 v[64:79], v[136:139], v[128:131], v[64:79]
    ds_read_b128 v[40:43], v26 offset:16384
    ds_read_b64_tr_b16 v[32:33], v176 offset:24576
    ds_read_b64_tr_b16 v[34:35], v176 offset:25600
    s_waitcnt lgkmcnt(5)
    v_mfma_f32_32x32x16_bf16 v[80:95], v[140:143], v[128:131], v[80:95]
    ds_read_b128 v[44:47], v26 offset:20480
    ds_read_b64_tr_b16 v[36:37], v177 offset:24576
    ds_read_b64_tr_b16 v[38:39], v177 offset:25600
    buffer_load_dwordx4 v7, s[12:15], s46 offen offset:3072 lds
    s_waitcnt lgkmcnt(6)
    v_mfma_f32_32x32x16_bf16 v[96:111], v[136:139], v[132:135], v[96:111]
    s_add_u32 m0, s35, 49152
    s_nop 0
    buffer_load_dwordx4 v8, s[16:19], s47 offen lds
    v_mfma_f32_32x32x16_bf16 v[112:127], v[140:143], v[132:135], v[112:127]
    buffer_load_dwordx4 v9, s[16:19], s47 offen offset:1024 lds
    v_dot2c_f32_bf16 v60, s40, v231
    v_dot2c_f32_bf16 v61, v231, v231
    v_dot2c_f32_bf16 v60, s40, v232
    v_dot2c_f32_bf16 v61, v232, v232
    v_dot2c_f32_bf16 v60, s40, v233
    v_dot2c_f32_bf16 v61, v233, v233
    v_dot2c_f32_bf16 v60, s40, v234
    v_dot2c_f32_bf16 v61, v234, v234
    v_dot2c_f32_bf16 v60, s40, v235
    v_dot2c_f32_bf16 v61, v235, v235
    v_dot2c_f32_bf16 v60, s40, v236
    v_dot2c_f32_bf16 v61, v236, v236
    v_dot2c_f32_bf16 v60, s40, v237
    v_dot2c_f32_bf16 v61, v237, v237
    v_dot2c_f32_bf16 v60, s40, v238
    v_dot2c_f32_bf16 v61, v238, v238
    v_mfma_f32_16x16x32_bf16 v[160:163], v[56:59], v[128:131], v[160:163]
    s_branch L_vrest
L_aux:
    v_mov_b32 v6, 0
    v_lshlrev_b32 v5, 4, v2
    s_mul_i32 s40, s27, 3072
    s_add_u32 s40, s40, 27164672
    v_mov_b32 v20, 0
    v_mov_b32 v21, 0
    v_mov_b32 v22, 0
    v_mov_b32 v23, 0
    s_waitcnt lgkmcnt(0)
    buffer_store_dwordx4 v[20:23], v5, s[20:23], s40 offen offset:0 sc1
    buffer_store_dwordx4 v[20:23], v5, s[20:23], s40 offen offset:1024 sc1
    buffer_store_dwordx4 v[20:23], v5, s[20:23], s40 offen offset:2048 sc1
    s_cmp_lg_u32 s27, 0
    s_cbranch_scc1 L_aux2
    v_mov_b32 v8, 1065369472
    v_mov_b32 v9, 1065369472
    v_mov_b32 v10, 1065369472
    v_mov_b32 v11, 1065369472
    v_lshlrev_b32 v5, 10, v2
    s_mov_b32 s40, 27369472
    s_mov_b64 exec, 0xffffffff
    buffer_store_dwordx4 v[8:11], v5, s[20:23], s40 offen sc1
    v_mov_b32 v16, 1065369472
    v_mov_b32 v17, 0x3f80
    v_lshlrev_b32 v5, 9, v2
    s_mov_b32 s40, 27361280
    s_mov_b64 exec, 0xffff
    buffer_store_dwordx2 v[16:17], v5, s[20:23], s40 offen sc1
    s_mov_b64 exec, -1
L_aux2:
    v_mov_b32 v7, 1
    s_lshl_b32 s40, s24, 12
    s_waitcnt vmcnt(0)
    s_barrier
    s_mov_b64 exec, 1
    buffer_atomic_add v7, v6, s[48:51], s40 offen sc1
    s_mov_b64 exec, -1
    v_mul_u32_u24 v54, 1280, v13
    v_and_b32 v14, 15, v2
    v_lshl_add_u32 v54, v14, 4, v54
    v_lshlrev_b32 v53, 2, v13
    v_and_b32 v14, 15, v2
    v_lshl_add_u32 v53, v14, 25, v53
    v_lshlrev_b32 v55, 25, v2
    v_mov_b32 v52, 1
    s_and_b32 s54, s26, 7
    s_lshl2_add_u32 s54, s54, s24
    s_mul_i32 s57, s54, 5120
    s_mul_i32 s52, s25, 163840
    s_add_u32 s57, s57, s52
    s_lshl_b32 s58, s25, 9
    s_lshl4_add_u32 s58, s54, s58
    s_add_u32 s58, s58, 27402240
    s_lshl_b32 s56, s25, 8
    s_add_u32 s56, s56, 27168768
    s_cmp_ge_u32 s26, 8
    s_cselect_b32 s57, s57, 0x40000000
    s_cselect_b32 s58, s58, 0x2000000
    s_cselect_b32 s55, s56, 0x2000000
    s_add_u32 s59, s58, 8192
    s_cmp_eq_u32 s24, 0
    s_cselect_b32 s55, s55, 0x2000000
    s_mov_b32 s40, 1065369472
    v_mov_b32 v1, 0
    buffer_load_dwordx4 v[224:227], v54, s[12:15], s57 offen offset:0
    buffer_load_dwordx4 v[228:231], v54, s[12:15], s57 offen offset:256
    buffer_load_dwordx4 v[232:235], v54, s[12:15], s57 offen offset:512
    buffer_load_dwordx4 v[236:239], v54, s[12:15], s57 offen offset:768
    buffer_load_dwordx4 v[240:243], v54, s[12:15], s57 offen offset:1024
    v_mov_b32 v60, 0
    v_mov_b32 v61, 0
    s_waitcnt vmcnt(4)
    v_dot2c_f32_bf16 v60, s40, v224
    v_dot2c_f32_bf16 v61, v224, v224
    v_dot2c_f32_bf16 v60, s40, v225
    v_dot2c_f32_bf16 v61, v225, v225
    v_dot2c_f32_bf16 v60, s40, v226
    v_dot2c_f32_bf16 v61, v226, v226
    v_dot2c_f32_bf16 v60, s40, v227
    v_dot2c_f32_bf16 v61, v227, v227
    s_waitcnt vmcnt(3)
    v_dot2c_f32_bf16 v60, s40, v228
    v_dot2c_f32_bf16 v61, v228, v228
    v_dot2c_f32_bf16 v60, s40, v229
    v_dot2c_f32_bf16 v61, v229, v229
    v_dot2c_f32_bf16 v60, s40, v230
    v_dot2c_f32_bf16 v61, v230, v230
    v_dot2c_f32_bf16 v60, s40, v231
    v_dot2c_f32_bf16 v61, v231, v231
    s_waitcnt vmcnt(2)
    v_dot2c_f32_bf16 v60, s40, v232
    v_dot2c_f32_bf16 v61, v232, v232
    v_dot2c_f32_bf16 v60, s40, v233
    v_dot2c_f32_bf16 v61, v233, v233
    v_dot2c_f32_bf16 v60, s40, v234
    v_dot2c_f32_bf16 v61, v234, v234
    v_dot2c_f32_bf16 v60, s40, v235
    v_dot2c_f32_bf16 v61, v235, v235
    s_waitcnt vmcnt(1)
    v_dot2c_f32_bf16 v60, s40, v236
    v_dot2c_f32_bf16 v61, v236, v236
    v_dot2c_f32_bf16 v60, s40, v237
    v_dot2c_f32_bf16 v61, v237, v237
    v_dot2c_f32_bf16 v60, s40, v238
    v_dot2c_f32_bf16 v61, v238, v238
    v_dot2c_f32_bf16 v60, s40, v239
    v_dot2c_f32_bf16 v61, v239, v239
    s_waitcnt vmcnt(0)
    v_dot2c_f32_bf16 v60, s40, v240
    v_dot2c_f32_bf16 v61, v240, v240
    v_dot2c_f32_bf16 v60, s40, v241
    v_dot2c_f32_bf16 v61, v241, v241
    v_dot2c_f32_bf16 v60, s40, v242
    v_dot2c_f32_bf16 v61, v242, v242
    v_dot2c_f32_bf16 v60, s40, v243
    v_dot2c_f32_bf16 v61, v243, v243
    s_nop 1
    v_add_f32_dpp v60, v60, v60 row_ror:8 row_mask:0xf bank_mask:0xf
    v_add_f32_dpp v61, v61, v61 row_ror:8 row_mask:0xf bank_mask:0xf
    s_nop 0
    v_add_f32_dpp v60, v60, v60 row_ror:4 row_mask:0xf bank_mask:0xf
    v_add_f32_dpp v61, v61, v61 row_ror:4 row_mask:0xf bank_mask:0xf
    s_nop 0
    v_add_f32_dpp v60, v60, v60 row_ror:2 row_mask:0xf bank_mask:0xf
    v_add_f32_dpp v61, v61, v61 row_ror:2 row_mask:0xf bank_mask:0xf
    s_nop 0
    v_add_f32_dpp v60, v60, v60 row_ror:1 row_mask:0xf bank_mask:0xf
    v_add_f32_dpp v61, v61, v61 row_ror:1 row_mask:0xf bank_mask:0xf
    v_mul_f32 v60, 0x3acccccd, v60
    v_mul_f32 v61, 0x3acccccd, v61
    v_fma_f32 v62, -v60, v60, v61
    v_max_f32 v62, 0, v62
    v_cvt_pk_bf16_f32 v63, v60, v60
    v_and_b32 v63, 0xffff0000, v63
    v_cvt_pk_bf16_f32 v62, v62, v62
    v_and_b32 v62, 0xffff0000, v62
    v_add_f32 v62, 0x3727c5ac, v62
    v_cvt_pk_bf16_f32 v62, v62, v62
    v_and_b32 v62, 0xffff0000, v62
    v_sqrt_f32 v62, v62
    s_nop 0
    v_cvt_pk_bf16_f32 v61, v62, v62
    v_and_b32 v61, 0xffff0000, v61
    v_rcp_f32 v61, v61
    v_cvt_pk_bf16_f32 v63, -v63, -v63
    buffer_store_dword v63, v53, s[20:23], s58 offen sc1
    buffer_store_dword v61, v53, s[20:23], s59 offen sc1
    s_mov_b32 s44, 200000
    s_waitcnt vmcnt(0)
    s_cmp_lg_u32 s24, 0
    s_cbranch_scc1 L_auxd
L_auxp:
    buffer_load_dword v3, v1, s[48:51], 0 offen sc0 sc1
    s_waitcnt vmcnt(0)
    v_cmp_le_u32 vcc, 16, v3
    s_nop 0
    s_cmp_eq_u64 vcc, -1
    s_cbranch_scc1 L_auxd
    s_sub_u32 s44, s44, 1
    s_cmp_lg_u32 s44, 0
    s_cbranch_scc1 L_auxp
L_auxd:
    s_barrier
    buffer_atomic_add v52, v55, s[20:23], s55 offen sc1
    s_branch L_qdone
L_qloop:
    v_lshl_add_u32 v19, v12, 15, v14
    s_lshl2_add_u32 s37, s26, s24
    s_lshl_b32 s37, s37, 17
    s_lshl_b32 s38, s34, 10
    s_add_u32 s60, s37, s38
    s_add_u32 s61, s60, 65536
    s_xor_b32 s62, s60, 0x20000
    s_xor_b32 s63, s61, 0x20000
    s_mov_b32 s39, 0x3ea52b5c
    s_cmp_lt_u32 s26, 5
    s_cselect_b32 s39, s39, 1.0
    s_waitcnt vmcnt(9)
    s_barrier
    ds_read_b128 v[40:43], v24 offset:0
    ds_read_b64_tr_b16 v[32:33], v176 offset:0
    ds_read_b64_tr_b16 v[34:35], v176 offset:1024
    ds_read_b128 v[44:47], v24 offset:4096
    ds_read_b64_tr_b16 v[36:37], v177 offset:0
    ds_read_b64_tr_b16 v[38:39], v177 offset:1024
    s_waitcnt lgkmcnt(3)
    v_mfma_f32_32x32x16_bf16 v[64:79], v[32:35], v[40:43], 0
    ds_read_b128 v[136:139], v25 offset:0
    ds_read_b64_tr_b16 v[128:129], v176 offset:4096
    ds_read_b64_tr_b16 v[130:131], v176 offset:5120
    s_waitcnt lgkmcnt(5)
    v_mfma_f32_32x32x16_bf16 v[80:95], v[32:35], v[44:47], 0
    ds_read_b128 v[140:143], v25 offset:4096
    ds_read_b64_tr_b16 v[132:133], v177 offset:4096
    ds_read_b64_tr_b16 v[134:135], v177 offset:5120
    s_add_u32 m0, s35, 16384
    s_nop 0
    buffer_load_dwordx4 v8, s[16:19], s47 offen lds
    s_waitcnt lgkmcnt(6)
    v_mfma_f32_32x32x16_bf16 v[96:111], v[36:39], v[40:43], 0
    buffer_load_dwordx4 v9, s[16:19], s47 offen offset:1024 lds
    v_mfma_f32_32x32x16_bf16 v[112:127], v[36:39], v[44:47], 0
    buffer_load_dwordx4 v10, s[16:19], s47 offen offset:2048 lds
    v_mfma_f32_16x16x32_bf16 v[160:163], v[56:59], v[32:35], 0
    s_waitcnt lgkmcnt(3)
    v_mfma_f32_32x32x16_bf16 v[64:79], v[128:131], v[136:139], v[64:79]
    ds_read_b128 v[40:43], v26 offset:0
    ds_read_b64_tr_b16 v[32:33], v176 offset:8192
    ds_read_b64_tr_b16 v[34:35], v176 offset:9216
    s_waitcnt lgkmcnt(5)
    v_mfma_f32_32x32x16_bf16 v[80:95], v[128:131], v[140:143], v[80:95]
    ds_read_b128 v[44:47], v26 offset:4096
    ds_read_b64_tr_b16 v[36:37], v177 offset:8192
    ds_read_b64_tr_b16 v[38:39], v177 offset:9216
    buffer_load_dwordx4 v11, s[16:19], s47 offen offset:3072 lds
    s_waitcnt lgkmcnt(6)
    v_mfma_f32_32x32x16_bf16 v[96:111], v[132:135], v[136:139], v[96:111]
    s_cmp_eq_u32 s53, 0
    s_cselect_b32 s47, 2, 3
    s_add_u32 s47, s47, s64
    s_sub_u32 s46, s47, 10
    s_cselect_b32 s47, s47, s46
    s_lshl_b32 s46, s47, 7
    s_add_u32 s46, s46, s28
    s_mul_i32 s47, s47, 245760
    s_add_u32 m0, s35, 98304
    s_add_u32 s47, s47, s29
    buffer_load_dwordx4 v4, s[12:15], s46 offen lds
    v_mfma_f32_32x32x16_bf16 v[112:127], v[132:135], v[140:143], v[112:127]
    buffer_load_dwordx4 v5, s[12:15], s46 offen offset:1024 lds
    v_mfma_f32_16x16x32_bf16 v[160:163], v[56:59], v[128:131], v[160:163]
    s_waitcnt lgkmcnt(3)
    v_mfma_f32_32x32x16_bf16 v[64:79], v[32:35], v[40:43], v[64:79]
    ds_read_b128 v[136:139], v27 offset:0
    ds_read_b64_tr_b16 v[128:129], v176 offset:12288
    ds_read_b64_tr_b16 v[130:131], v176 offset:13312
    s_waitcnt lgkmcnt(5)
    v_mfma_f32_32x32x16_bf16 v[80:95], v[32:35], v[44:47], v[80:95]
    ds_read_b128 v[140:143], v27 offset:4096
    ds_read_b64_tr_b16 v[132:133], v177 offset:12288
    ds_read_b64_tr_b16 v[134:135], v177 offset:13312
    buffer_load_dwordx4 v6, s[12:15], s46 offen offset:2048 lds
    s_waitcnt lgkmcnt(6)
    v_mfma_f32_32x32x16_bf16 v[96:111], v[36:39], v[40:43], v[96:111]
    buffer_load_dwordx4 v7, s[12:15], s46 offen offset:3072 lds
    v_mfma_f32_32x32x16_bf16 v[112:127], v[36:39], v[44:47], v[112:127]
    s_add_u32 m0, s35, 32768
    s_nop 0
    buffer_load_dwordx4 v8, s[16:19], s47 offen lds
    v_mfma_f32_16x16x32_bf16 v[160:163], v[56:59], v[32:35], v[160:163]
    s_waitcnt vmcnt(5)
    s_barrier
    s_waitcnt lgkmcnt(3)
    v_mfma_f32_32x32x16_bf16 v[64:79], v[128:131], v[136:139], v[64:79]
    ds_read_b128 v[40:43], v24 offset:16384
    ds_read_b64_tr_b16 v[32:33], v176 offset:16384
    ds_read_b64_tr_b16 v[34:35], v176 offset:17408
    s_waitcnt lgkmcnt(5)
    v_mfma_f32_32x32x16_bf16 v[80:95], v[128:131], v[140:143], v[80:95]
    ds_read_b128 v[44:47], v24 offset:20480
    ds_read_b64_tr_b16 v[36:37], v177 offset:16384
    ds_read_b64_tr_b16 v[38:39], v177 offset:17408
    buffer_load_dwordx4 v9, s[16:19], s47 offen offset:1024 lds
    s_waitcnt lgkmcnt(6)
    v_mfma_f32_32x32x16_bf16 v[96:111], v[132:135], v[136:139], v[96:111]
    buffer_load_dwordx4 v10, s[16:19], s47 offen offset:2048 lds
    v_mfma_f32_32x32x16_bf16 v[112:127], v[132:135], v[140:143], v[112:127]
    buffer_load_dwordx4 v11, s[16:19], s47 offen offset:3072 lds
    v_mfma_f32_16x16x32_bf16 v[160:163], v[56:59], v[128:131], v[160:163]
    s_waitcnt lgkmcnt(3)
    v_mfma_f32_32x32x16_bf16 v[64:79], v[32:35], v[40:43], v[64:79]
    ds_read_b128 v[136:139], v25 offset:16384
    ds_read_b64_tr_b16 v[128:129], v176 offset:20480
    ds_read_b64_tr_b16 v[130:131], v176 offset:21504
    s_waitcnt lgkmcnt(5)
    v_mfma_f32_32x32x16_bf16 v[80:95], v[32:35], v[44:47], v[80:95]
    ds_read_b128 v[140:143], v25 offset:20480
    ds_read_b64_tr_b16 v[132:133], v177 offset:20480
    ds_read_b64_tr_b16 v[134:135], v177 offset:21504
    s_cmp_eq_u32 s53, 0
    s_cselect_b32 s47, 3, 2
    s_add_u32 s47, s47, s64
    s_sub_u32 s46, s47, 10
    s_cselect_b32 s47, s47, s46
    s_lshl_b32 s46, s47, 7
    s_add_u32 s46, s46, s28
    s_mul_i32 s47, s47, 245760
    s_add_u32 m0, s35, 114688
    s_add_u32 s47, s47, s29
    buffer_load_dwordx4 v4, s[12:15], s46 offen lds
    s_waitcnt lgkmcnt(6)
    v_mfma_f32_32x32x16_bf16 v[96:111], v[36:39], v[40:43], v[96:111]
    buffer_load_dwordx4 v5, s[12:15], s46 offen offset:1024 lds
    v_mfma_f32_32x32x16_bf16 v[112:127], v[36:39], v[44:47], v[112:127]
    buffer_load_dwordx4 v6, s[12:15], s46 offen offset:2048 lds
    s_cmp_lt_u32 s26, 8
    s_cbranch_scc1 L_sk4
    v_mov_b32 v60, 0
    v_mov_b32 v61, 0
    v_dot2c_f32_bf16 v60, s40, v224
    v_dot2c_f32_bf16 v61, v224, v224
    v_dot2c_f32_bf16 v60, s40, v225
    v_dot2c_f32_bf16 v61, v225, v225
    v_dot2c_f32_bf16 v60, s40, v226
    v_dot2c_f32_bf16 v61, v226, v226
    v_dot2c_f32_bf16 v60, s40, v227
    v_dot2c_f32_bf16 v61, v227, v227
    v_dot2c_f32_bf16 v60, s40, v228
    v_dot2c_f32_bf16 v61, v228, v228
    v_dot2c_f32_bf16 v60, s40, v229
    v_dot2c_f32_bf16 v61, v229, v229
    v_dot2c_f32_bf16 v60, s40, v230
    v_dot2c_f32_bf16 v61, v230, v230
L_sk4:
    v_mfma_f32_16x16x32_bf16 v[160:163], v[56:59], v[32:35], v[160:163]
    s_waitcnt lgkmcnt(3)
    v_mfma_f32_32x32x16_bf16 v[64:79], v[128:131], v[136:139], v[64:79]
    ds_read_b128 v[40:43], v26 offset:16384
    ds_read_b64_tr_b16 v[32:33], v176 offset:24576
    ds_read_b64_tr_b16 v[34:35], v176 offset:25600
    s_waitcnt lgkmcnt(5)
    v_mfma_f32_32x32x16_bf16 v[80:95], v[128:131], v[140:143], v[80:95]
    ds_read_b128 v[44:47], v26 offset:20480
    ds_read_b64_tr_b16 v[36:37], v177 offset:24576
    ds_read_b64_tr_b16 v[38:39], v177 offset:25600
    buffer_load_dwordx4 v7, s[12:15], s46 offen offset:3072 lds
    s_waitcnt lgkmcnt(6)
    v_mfma_f32_32x32x16_bf16 v[96:111], v[132:135], v[136:139], v[96:111]
    s_add_u32 m0, s35, 49152
    s_nop 0
    buffer_load_dwordx4 v8, s[16:19], s47 offen lds
    v_mfma_f32_32x32x16_bf16 v[112:127], v[132:135], v[140:143], v[112:127]
    buffer_load_dwordx4 v9, s[16:19], s47 offen offset:1024 lds
    s_cmp_lt_u32 s26, 8
    s_cbranch_scc1 L_sk5
    v_dot2c_f32_bf16 v60, s40, v231
    v_dot2c_f32_bf16 v61, v231, v231
    v_dot2c_f32_bf16 v60, s40, v232
    v_dot2c_f32_bf16 v61, v232, v232
    v_dot2c_f32_bf16 v60, s40, v233
    v_dot2c_f32_bf16 v61, v233, v233
    v_dot2c_f32_bf16 v60, s40, v234
    v_dot2c_f32_bf16 v61, v234, v234
    v_dot2c_f32_bf16 v60, s40, v235
    v_dot2c_f32_bf16 v61, v235, v235
    v_dot2c_f32_bf16 v60, s40, v236
    v_dot2c_f32_bf16 v61, v236, v236
    v_dot2c_f32_bf16 v60, s40, v237
    v_dot2c_f32_bf16 v61, v237, v237
    v_dot2c_f32_bf16 v60, s40, v238
    v_dot2c_f32_bf16 v61, v238, v238
L_sk5:
    v_mfma_f32_16x16x32_bf16 v[160:163], v[56:59], v[128:131], v[160:163]
    s_waitcnt lgkmcnt(3)
    v_mfma_f32_32x32x16_bf16 v[64:79], v[32:35], v[40:43], v[64:79]
    ds_read_b128 v[136:139], v27 offset:16384
    ds_read_b64_tr_b16 v[128:129], v176 offset:28672
    ds_read_b64_tr_b16 v[130:131], v176 offset:29696
    s_waitcnt lgkmcnt(5)
    v_mfma_f32_32x32x16_bf16 v[80:95], v[32:35], v[44:47], v[80:95]
    ds_read_b128 v[140:143], v27 offset:20480
    ds_read_b64_tr_b16 v[132:133], v177 offset:28672
    ds_read_b64_tr_b16 v[134:135], v177 offset:29696
    buffer_load_dwordx4 v10, s[16:19], s47 offen offset:2048 lds
    s_waitcnt lgkmcnt(6)
    v_mfma_f32_32x32x16_bf16 v[96:111], v[36:39], v[40:43], v[96:111]
    buffer_load_dwordx4 v11, s[16:19], s47 offen offset:3072 lds
    v_mfma_f32_32x32x16_bf16 v[112:127], v[36:39], v[44:47], v[112:127]
    s_cmp_lt_u32 s26, 8
    s_cbranch_scc1 L_sk6
    v_dot2c_f32_bf16 v60, s40, v239
    v_dot2c_f32_bf16 v61, v239, v239
    v_dot2c_f32_bf16 v60, s40, v240
    v_dot2c_f32_bf16 v61, v240, v240
    v_dot2c_f32_bf16 v60, s40, v241
    v_dot2c_f32_bf16 v61, v241, v241
    v_dot2c_f32_bf16 v60, s40, v242
    v_dot2c_f32_bf16 v61, v242, v242
    v_dot2c_f32_bf16 v60, s40, v243
    v_dot2c_f32_bf16 v61, v243, v243
    s_nop 1
    v_add_f32_dpp v60, v60, v60 row_ror:8 row_mask:0xf bank_mask:0xf
    v_add_f32_dpp v61, v61, v61 row_ror:8 row_mask:0xf bank_mask:0xf
    s_nop 0
    v_add_f32_dpp v60, v60, v60 row_ror:4 row_mask:0xf bank_mask:0xf
    v_add_f32_dpp v61, v61, v61 row_ror:4 row_mask:0xf bank_mask:0xf
    s_nop 0
    v_add_f32_dpp v60, v60, v60 row_ror:2 row_mask:0xf bank_mask:0xf
    v_add_f32_dpp v61, v61, v61 row_ror:2 row_mask:0xf bank_mask:0xf
L_sk6:
    v_mfma_f32_16x16x32_bf16 v[160:163], v[56:59], v[32:35], v[160:163]
    s_waitcnt vmcnt(8)
    s_barrier
    s_waitcnt lgkmcnt(3)
    v_mfma_f32_32x32x16_bf16 v[64:79], v[128:131], v[136:139], v[64:79]
    ds_read_b128 v[40:43], v24 offset:32768
    ds_read_b64_tr_b16 v[32:33], v176 offset:32768
    ds_read_b64_tr_b16 v[34:35], v176 offset:33792
    s_waitcnt lgkmcnt(5)
    v_mfma_f32_32x32x16_bf16 v[80:95], v[128:131], v[140:143], v[80:95]
    ds_read_b128 v[44:47], v24 offset:36864
    ds_read_b64_tr_b16 v[36:37], v177 offset:32768
    ds_read_b64_tr_b16 v[38:39], v177 offset:33792
    s_cmp_eq_u32 s53, 0
    s_cselect_b32 s47, 4, 5
    s_add_u32 s47, s47, s64
    s_sub_u32 s46, s47, 10
    s_cselect_b32 s47, s47, s46
    s_lshl_b32 s46, s47, 7
    s_add_u32 s46, s46, s28
    s_mul_i32 s47, s47, 245760
    s_add_u32 m0, s35, 65536
    s_add_u32 s47, s47, s29
    buffer_load_dwordx4 v4, s[12:15], s46 offen lds
    s_waitcnt lgkmcnt(6)
    v_mfma_f32_32x32x16_bf16 v[96:111], v[132:135], v[136:139], v[96:111]
    buffer_load_dwordx4 v5, s[12:15], s46 offen offset:1024 lds
    v_mfma_f32_32x32x16_bf16 v[112:127], v[132:135], v[140:143], v[112:127]
    buffer_load_dwordx4 v6, s[12:15], s46 offen offset:2048 lds
    s_cmp_lt_u32 s26, 8
    s_cbranch_scc1 L_sk7
    v_add_f32_dpp v60, v60, v60 row_ror:1 row_mask:0xf bank_mask:0xf
    v_add_f32_dpp v61, v61, v61 row_ror:1 row_mask:0xf bank_mask:0xf
    v_mul_f32 v60, 0x3acccccd, v60
    v_mul_f32 v61, 0x3acccccd, v61
    v_fma_f32 v62, -v60, v60, v61
    v_max_f32 v62, 0, v62
    v_cvt_pk_bf16_f32 v63, v60, v60
    v_and_b32 v63, 0xffff0000, v63
    v_cvt_pk_bf16_f32 v62, v62, v62
    v_and_b32 v62, 0xffff0000, v62
    v_add_f32 v62, 0x3727c5ac, v62
    v_cvt_pk_bf16_f32 v62, v62, v62
    v_and_b32 v62, 0xffff0000, v62
    v_sqrt_f32 v62, v62
    s_nop 0
    v_cvt_pk_bf16_f32 v61, v62, v62
    v_and_b32 v61, 0xffff0000, v61
L_sk7:
    v_mfma_f32_16x16x32_bf16 v[160:163], v[56:59], v[128:131], v[160:163]
    s_waitcnt lgkmcnt(3)
    v_mfma_f32_32x32x16_bf16 v[64:79], v[32:35], v[40:43], v[64:79]
    ds_read_b128 v[136:139], v25 offset:32768
    ds_read_b64_tr_b16 v[128:129], v176 offset:36864
    ds_read_b64_tr_b16 v[130:131], v176 offset:37888
    s_waitcnt lgkmcnt(5)
    v_mfma_f32_32x32x16_bf16 v[80:95], v[32:35], v[44:47], v[80:95]
    ds_read_b128 v[140:143], v25 offset:36864
    ds_read_b64_tr_b16 v[132:133], v177 offset:36864
    ds_read_b64_tr_b16 v[134:135], v177 offset:37888
    buffer_load_dwordx4 v7, s[12:15], s46 offen offset:3072 lds
    s_waitcnt lgkmcnt(6)
    v_mfma_f32_32x32x16_bf16 v[96:111], v[36:39], v[40:43], v[96:111]
    s_add_u32 m0, s35, 0
    s_nop 0
    buffer_load_dwordx4 v8, s[16:19], s47 offen lds
    v_mfma_f32_32x32x16_bf16 v[112:127], v[36:39], v[44:47], v[112:127]
    buffer_load_dwordx4 v9, s[16:19], s47 offen offset:1024 lds
    s_cmp_lt_u32 s26, 8
    s_cbranch_scc1 L_sk8
    v_rcp_f32 v61, v61
    v_cvt_pk_bf16_f32 v63, -v63, -v63
L_sk8:
    buffer_store_dword v63, v53, s[20:23], s58 offen sc1
    buffer_store_dword v61, v53, s[20:23], s59 offen sc1
    v_mfma_f32_16x16x32_bf16 v[160:163], v[56:59], v[32:35], v[160:163]
    buffer_load_dword v3, v1, s[48:51], 0 offen sc0 sc1
    s_waitcnt lgkmcnt(3)
    v_mfma_f32_32x32x16_bf16 v[64:79], v[128:131], v[136:139], v[64:79]
    ds_read_b128 v[40:43], v26 offset:32768
    ds_read_b64_tr_b16 v[32:33], v176 offset:40960
    ds_read_b64_tr_b16 v[34:35], v176 offset:41984
    s_waitcnt lgkmcnt(5)
    v_mfma_f32_32x32x16_bf16 v[80:95], v[128:131], v[140:143], v[80:95]
    ds_read_b128 v[44:47], v26 offset:36864
    ds_read_b64_tr_b16 v[36:37], v177 offset:40960
    ds_read_b64_tr_b16 v[38:39], v177 offset:41984
    buffer_load_dwordx4 v10, s[16:19], s47 offen offset:2048 lds
    s_waitcnt lgkmcnt(6)
    v_mfma_f32_32x32x16_bf16 v[96:111], v[132:135], v[136:139], v[96:111]
    buffer_load_dwordx4 v11, s[16:19], s47 offen offset:3072 lds
    v_mfma_f32_32x32x16_bf16 v[112:127], v[132:135], v[140:143], v[112:127]
    v_mfma_f32_16x16x32_bf16 v[160:163], v[56:59], v[128:131], v[160:163]
    s_waitcnt lgkmcnt(3)
    v_mfma_f32_32x32x16_bf16 v[64:79], v[32:35], v[40:43], v[64:79]
    ds_read_b128 v[136:139], v27 offset:32768
    ds_read_b64_tr_b16 v[128:129], v176 offset:45056
    ds_read_b64_tr_b16 v[130:131], v176 offset:46080
    s_waitcnt lgkmcnt(5)
    v_mfma_f32_32x32x16_bf16 v[80:95], v[32:35], v[44:47], v[80:95]
    ds_read_b128 v[140:143], v27 offset:36864
    ds_read_b64_tr_b16 v[132:133], v177 offset:45056
    ds_read_b64_tr_b16 v[134:135], v177 offset:46080
    s_waitcnt lgkmcnt(6)
    v_mfma_f32_32x32x16_bf16 v[96:111], v[36:39], v[40:43], v[96:111]
    v_mfma_f32_32x32x16_bf16 v[112:127], v[36:39], v[44:47], v[112:127]
    v_mfma_f32_16x16x32_bf16 v[160:163], v[56:59], v[32:35], v[160:163]
    s_waitcnt vmcnt(11)
    s_barrier
    s_waitcnt lgkmcnt(3)
    v_mfma_f32_32x32x16_bf16 v[64:79], v[128:131], v[136:139], v[64:79]
    ds_read_b128 v[40:43], v24 offset:49152
    ds_read_b64_tr_b16 v[32:33], v176 offset:49152
    ds_read_b64_tr_b16 v[34:35], v176 offset:50176
    s_waitcnt lgkmcnt(5)
    v_mfma_f32_32x32x16_bf16 v[80:95], v[128:131], v[140:143], v[80:95]
    ds_read_b128 v[44:47], v24 offset:53248
    ds_read_b64_tr_b16 v[36:37], v177 offset:49152
    ds_read_b64_tr_b16 v[38:39], v177 offset:50176
    s_cmp_eq_u32 s53, 0
    s_cselect_b32 s47, 5, 4
    s_add_u32 s47, s47, s64
    s_sub_u32 s46, s47, 10
    s_cselect_b32 s47, s47, s46
    s_lshl_b32 s46, s47, 7
    s_add_u32 s46, s46, s28
    s_mul_i32 s47, s47, 245760
    s_add_u32 m0, s35, 81920
    s_add_u32 s47, s47, s29
    buffer_load_dwordx4 v4, s[12:15], s46 offen lds
    s_waitcnt lgkmcnt(6)
    v_mfma_f32_32x32x16_bf16 v[96:111], v[132:135], v[136:139], v[96:111]
    buffer_load_dwordx4 v5, s[12:15], s46 offen offset:1024 lds
    v_mfma_f32_32x32x16_bf16 v[112:127], v[132:135], v[140:143], v[112:127]
    buffer_load_dwordx4 v6, s[12:15], s46 offen offset:2048 lds
    v_mfma_f32_16x16x32_bf16 v[160:163], v[56:59], v[128:131], v[160:163]
    s_waitcnt lgkmcnt(3)
    v_mfma_f32_32x32x16_bf16 v[64:79], v[32:35], v[40:43], v[64:79]
    ds_read_b128 v[136:139], v25 offset:49152
    ds_read_b64_tr_b16 v[128:129], v176 offset:53248
    ds_read_b64_tr_b16 v[130:131], v176 offset:54272
    s_waitcnt lgkmcnt(5)
    v_mfma_f32_32x32x16_bf16 v[80:95], v[32:35], v[44:47], v[80:95]
    ds_read_b128 v[140:143], v25 offset:53248
    ds_read_b64_tr_b16 v[132:133], v177 offset:53248
    ds_read_b64_tr_b16 v[134:135], v177 offset:54272
    s_waitcnt lgkmcnt(6)
    v_mfma_f32_32x32x16_bf16 v[96:111], v[36:39], v[40:43], v[96:111]
    buffer_load_dwordx4 v7, s[12:15], s46 offen offset:3072 lds
    v_mfma_f32_32x32x16_bf16 v[112:127], v[36:39], v[44:47], v[112:127]
    s_add_u32 m0, s35, 16384
    s_nop 0
    buffer_load_dwordx4 v8, s[16:19], s47 offen lds
    v_mfma_f32_16x16x32_bf16 v[160:163], v[56:59], v[32:35], v[160:163]
    s_waitcnt lgkmcnt(3)
    v_mfma_f32_32x32x16_bf16 v[64:79], v[128:131], v[136:139], v[64:79]
    ds_read_b128 v[40:43], v26 offset:49152
    ds_read_b64_tr_b16 v[32:33], v176 offset:57344
    ds_read_b64_tr_b16 v[34:35], v176 offset:58368
    s_waitcnt lgkmcnt(5)
    v_mfma_f32_32x32x16_bf16 v[80:95], v[128:131], v[140:143], v[80:95]
    ds_read_b128 v[44:47], v26 offset:53248
    ds_read_b64_tr_b16 v[36:37], v177 offset:57344
    ds_read_b64_tr_b16 v[38:39], v177 offset:58368
    s_waitcnt lgkmcnt(6)
    v_mfma_f32_32x32x16_bf16 v[96:111], v[132:135], v[136:139], v[96:111]
    buffer_load_dwordx4 v9, s[16:19], s47 offen offset:1024 lds
    v_mfma_f32_32x32x16_bf16 v[112:127], v[132:135], v[140:143], v[112:127]
    buffer_load_dwordx4 v10, s[16:19], s47 offen offset:2048 lds
    v_mfma_f32_16x16x32_bf16 v[160:163], v[56:59], v[128:131], v[160:163]
    s_waitcnt lgkmcnt(3)
    v_mfma_f32_32x32x16_bf16 v[64:79], v[32:35], v[40:43], v[64:79]
    ds_read_b128 v[136:139], v27 offset:49152
    ds_read_b64_tr_b16 v[128:129], v176 offset:61440
    ds_read_b64_tr_b16 v[130:131], v176 offset:62464
    s_waitcnt lgkmcnt(5)
    v_mfma_f32_32x32x16_bf16 v[80:95], v[32:35], v[44:47], v[80:95]
    ds_read_b128 v[140:143], v27 offset:53248
    ds_read_b64_tr_b16 v[132:133], v177 offset:61440
    ds_read_b64_tr_b16 v[134:135], v177 offset:62464
    s_waitcnt lgkmcnt(6)
    v_mfma_f32_32x32x16_bf16 v[96:111], v[36:39], v[40:43], v[96:111]
    buffer_load_dwordx4 v11, s[16:19], s47 offen offset:3072 lds
    v_mfma_f32_32x32x16_bf16 v[112:127], v[36:39], v[44:47], v[112:127]
    v_mfma_f32_16x16x32_bf16 v[160:163], v[56:59], v[32:35], v[160:163]
    s_waitcnt vmcnt(8)
    s_barrier
    v_readfirstlane_b32 s45, v3
    s_nop 0
    s_cmp_ge_u32 s45, 16
    s_cbranch_scc1 L_qid
    s_mov_b32 s44, 200000
L_qil:
    buffer_load_dword v3, v1, s[48:51], 0 offen sc0 sc1
    s_waitcnt vmcnt(0)
    v_readfirstlane_b32 s45, v3
    s_nop 0
    s_cmp_ge_u32 s45, 16
    s_cbranch_scc1 L_qid
    s_sub_u32 s44, s44, 1
    s_cmp_lg_u32 s44, 0
    s_cbranch_scc1 L_qil
L_qid:
    buffer_atomic_add v52, v55, s[20:23], s55 offen sc1
    s_waitcnt lgkmcnt(3)
    v_mfma_f32_32x32x16_bf16 v[64:79], v[128:131], v[136:139], v[64:79]
    ds_read_b128 v[40:43], v24 offset:0
    ds_read_b64_tr_b16 v[32:33], v176 offset:0
    ds_read_b64_tr_b16 v[34:35], v176 offset:1024
    s_waitcnt lgkmcnt(5)
    v_mfma_f32_32x32x16_bf16 v[80:95], v[128:131], v[140:143], v[80:95]
    ds_read_b128 v[44:47], v24 offset:4096
    ds_read_b64_tr_b16 v[36:37], v177 offset:0
    ds_read_b64_tr_b16 v[38:39], v177 offset:1024
    s_waitcnt lgkmcnt(6)
    v_mfma_f32_32x32x16_bf16 v[96:111], v[132:135], v[136:139], v[96:111]
    s_cmp_eq_u32 s53, 0
    s_cselect_b32 s47, 6, 7
    s_add_u32 s47, s47, s64
    s_sub_u32 s46, s47, 10
    s_cselect_b32 s47, s47, s46
    s_lshl_b32 s46, s47, 7
    s_add_u32 s46, s46, s28
    s_mul_i32 s47, s47, 245760
    s_add_u32 m0, s35, 98304
    s_add_u32 s47, s47, s29
    buffer_load_dwordx4 v4, s[12:15], s46 offen lds
    v_mfma_f32_32x32x16_bf16 v[112:127], v[132:135], v[140:143], v[112:127]
    buffer_load_dwordx4 v5, s[12:15], s46 offen offset:1024 lds
    v_mfma_f32_16x16x32_bf16 v[160:163], v[56:59], v[128:131], v[160:163]
    s_waitcnt lgkmcnt(3)
    v_mfma_f32_32x32x16_bf16 v[64:79], v[32:35], v[40:43], v[64:79]
    ds_read_b128 v[136:139], v25 offset:0
    ds_read_b64_tr_b16 v[128:129], v176 offset:4096
    ds_read_b64_tr_b16 v[130:131], v176 offset:5120
    s_waitcnt lgkmcnt(5)
    v_mfma_f32_32x32x16_bf16 v[80:95], v[32:35], v[44:47], v[80:95]
    ds_read_b128 v[140:143], v25 offset:4096
    ds_read_b64_tr_b16 v[132:133], v177 offset:4096
    ds_read_b64_tr_b16 v[134:135], v177 offset:5120
    s_waitcnt lgkmcnt(6)
    v_mfma_f32_32x32x16_bf16 v[96:111], v[36:39], v[40:43], v[96:111]
    buffer_load_dwordx4 v6, s[12:15], s46 offen offset:2048 lds
    v_mfma_f32_32x32x16_bf16 v[112:127], v[36:39], v[44:47], v[112:127]
    buffer_load_dwordx4 v7, s[12:15], s46 offen offset:3072 lds
    v_mfma_f32_16x16x32_bf16 v[160:163], v[56:59], v[32:35], v[160:163]
    s_waitcnt lgkmcnt(3)
    v_mfma_f32_32x32x16_bf16 v[64:79], v[128:131], v[136:139], v[64:79]
    ds_read_b128 v[40:43], v26 offset:0
    ds_read_b64_tr_b16 v[32:33], v176 offset:8192
    ds_read_b64_tr_b16 v[34:35], v176 offset:9216
    s_waitcnt lgkmcnt(5)
    v_mfma_f32_32x32x16_bf16 v[80:95], v[128:131], v[140:143], v[80:95]
    ds_read_b128 v[44:47], v26 offset:4096
    ds_read_b64_tr_b16 v[36:37], v177 offset:8192
    ds_read_b64_tr_b16 v[38:39], v177 offset:9216
    s_waitcnt lgkmcnt(6)
    v_mfma_f32_32x32x16_bf16 v[96:111], v[132:135], v[136:139], v[96:111]
    s_add_u32 m0, s35, 32768
    s_nop 0
    buffer_load_dwordx4 v8, s[16:19], s47 offen lds
    v_mfma_f32_32x32x16_bf16 v[112:127], v[132:135], v[140:143], v[112:127]
    buffer_load_dwordx4 v9, s[16:19], s47 offen offset:1024 lds
    v_mfma_f32_16x16x32_bf16 v[160:163], v[56:59], v[128:131], v[160:163]
    s_waitcnt lgkmcnt(3)
    v_mfma_f32_32x32x16_bf16 v[64:79], v[32:35], v[40:43], v[64:79]
    ds_read_b128 v[136:139], v27 offset:0
    ds_read_b64_tr_b16 v[128:129], v176 offset:12288
    ds_read_b64_tr_b16 v[130:131], v176 offset:13312
    s_waitcnt lgkmcnt(5)
    v_mfma_f32_32x32x16_bf16 v[80:95], v[32:35], v[44:47], v[80:95]
    ds_read_b128 v[140:143], v27 offset:4096
    ds_read_b64_tr_b16 v[132:133], v177 offset:12288
    ds_read_b64_tr_b16 v[134:135], v177 offset:13312
    s_waitcnt lgkmcnt(6)
    v_mfma_f32_32x32x16_bf16 v[96:111], v[36:39], v[40:43], v[96:111]
    buffer_load_dwordx4 v10, s[16:19], s47 offen offset:2048 lds
    v_mfma_f32_32x32x16_bf16 v[112:127], v[36:39], v[44:47], v[112:127]
    buffer_load_dwordx4 v11, s[16:19], s47 offen offset:3072 lds
    v_mfma_f32_16x16x32_bf16 v[160:163], v[56:59], v[32:35], v[160:163]
    s_waitcnt vmcnt(9)
    s_barrier
    s_waitcnt lgkmcnt(3)
    v_mfma_f32_32x32x16_bf16 v[64:79], v[128:131], v[136:139], v[64:79]
    ds_read_b128 v[40:43], v24 offset:16384
    ds_read_b64_tr_b16 v[32:33], v176 offset:16384
    ds_read_b64_tr_b16 v[34:35], v176 offset:17408
    s_waitcnt lgkmcnt(5)
    v_mfma_f32_32x32x16_bf16 v[80:95], v[128:131], v[140:143], v[80:95]
    ds_read_b128 v[44:47], v24 offset:20480
    ds_read_b64_tr_b16 v[36:37], v177 offset:16384
    ds_read_b64_tr_b16 v[38:39], v177 offset:17408
    s_waitcnt lgkmcnt(6)
    v_mfma_f32_32x32x16_bf16 v[96:111], v[132:135], v[136:139], v[96:111]
    s_cmp_eq_u32 s53, 0
    s_cselect_b32 s47, 7, 6
    s_add_u32 s47, s47, s64
    s_sub_u32 s46, s47, 10
    s_cselect_b32 s47, s47, s46
    s_lshl_b32 s46, s47, 7
    s_add_u32 s46, s46, s28
    s_mul_i32 s47, s47, 245760
    s_add_u32 m0, s35, 114688
    s_add_u32 s47, s47, s29
    buffer_load_dwordx4 v4, s[12:15], s46 offen lds
    v_mfma_f32_32x32x16_bf16 v[112:127], v[132:135], v[140:143], v[112:127]
    buffer_load_dwordx4 v5, s[12:15], s46 offen offset:1024 lds
    v_mfma_f32_16x16x32_bf16 v[160:163], v[56:59], v[128:131], v[160:163]
    s_waitcnt lgkmcnt(3)
    v_mfma_f32_32x32x16_bf16 v[64:79], v[32:35], v[40:43], v[64:79]
    ds_read_b128 v[136:139], v25 offset:16384
    ds_read_b64_tr_b16 v[128:129], v176 offset:20480
    ds_read_b64_tr_b16 v[130:131], v176 offset:21504
    s_waitcnt lgkmcnt(5)
    v_mfma_f32_32x32x16_bf16 v[80:95], v[32:35], v[44:47], v[80:95]
    ds_read_b128 v[140:143], v25 offset:20480
    ds_read_b64_tr_b16 v[132:133], v177 offset:20480
    ds_read_b64_tr_b16 v[134:135], v177 offset:21504
    s_waitcnt lgkmcnt(6)
    v_mfma_f32_32x32x16_bf16 v[96:111], v[36:39], v[40:43], v[96:111]
    buffer_load_dwordx4 v6, s[12:15], s46 offen offset:2048 lds
    v_mfma_f32_32x32x16_bf16 v[112:127], v[36:39], v[44:47], v[112:127]
    buffer_load_dwordx4 v7, s[12:15], s46 offen offset:3072 lds
    v_mfma_f32_16x16x32_bf16 v[160:163], v[56:59], v[32:35], v[160:163]
    s_waitcnt lgkmcnt(3)
    v_mfma_f32_32x32x16_bf16 v[64:79], v[128:131], v[136:139], v[64:79]
    ds_read_b128 v[40:43], v26 offset:16384
    ds_read_b64_tr_b16 v[32:33], v176 offset:24576
    ds_read_b64_tr_b16 v[34:35], v176 offset:25600
    s_waitcnt lgkmcnt(5)
    v_mfma_f32_32x32x16_bf16 v[80:95], v[128:131], v[140:143], v[80:95]
    ds_read_b128 v[44:47], v26 offset:20480
    ds_read_b64_tr_b16 v[36:37], v177 offset:24576
    ds_read_b64_tr_b16 v[38:39], v177 offset:25600
    s_waitcnt lgkmcnt(6)
    v_mfma_f32_32x32x16_bf16 v[96:111], v[132:135], v[136:139], v[96:111]
    s_add_u32 m0, s35, 49152
    s_nop 0
    buffer_load_dwordx4 v8, s[16:19], s47 offen lds
    v_mfma_f32_32x32x16_bf16 v[112:127], v[132:135], v[140:143], v[112:127]
    buffer_load_dwordx4 v9, s[16:19], s47 offen offset:1024 lds
    v_mfma_f32_16x16x32_bf16 v[160:163], v[56:59], v[128:131], v[160:163]
    s_waitcnt lgkmcnt(3)
    v_mfma_f32_32x32x16_bf16 v[64:79], v[32:35], v[40:43], v[64:79]
    ds_read_b128 v[136:139], v27 offset:16384
    ds_read_b64_tr_b16 v[128:129], v176 offset:28672
    ds_read_b64_tr_b16 v[130:131], v176 offset:29696
    s_waitcnt lgkmcnt(5)
    v_mfma_f32_32x32x16_bf16 v[80:95], v[32:35], v[44:47], v[80:95]
    ds_read_b128 v[140:143], v27 offset:20480
    ds_read_b64_tr_b16 v[132:133], v177 offset:28672
    ds_read_b64_tr_b16 v[134:135], v177 offset:29696
    s_waitcnt lgkmcnt(6)
    v_mfma_f32_32x32x16_bf16 v[96:111], v[36:39], v[40:43], v[96:111]
    buffer_load_dwordx4 v10, s[16:19], s47 offen offset:2048 lds
    v_mfma_f32_32x32x16_bf16 v[112:127], v[36:39], v[44:47], v[112:127]
    buffer_load_dwordx4 v11, s[16:19], s47 offen offset:3072 lds
    v_mfma_f32_16x16x32_bf16 v[160:163], v[56:59], v[32:35], v[160:163]
    s_waitcnt vmcnt(8)
    s_barrier
    s_waitcnt lgkmcnt(3)
    v_mfma_f32_32x32x16_bf16 v[64:79], v[128:131], v[136:139], v[64:79]
    ds_read_b128 v[40:43], v24 offset:32768
    ds_read_b64_tr_b16 v[32:33], v176 offset:32768
    ds_read_b64_tr_b16 v[34:35], v176 offset:33792
    s_waitcnt lgkmcnt(5)
    v_mfma_f32_32x32x16_bf16 v[80:95], v[128:131], v[140:143], v[80:95]
    ds_read_b128 v[44:47], v24 offset:36864
    ds_read_b64_tr_b16 v[36:37], v177 offset:32768
    ds_read_b64_tr_b16 v[38:39], v177 offset:33792
    s_waitcnt lgkmcnt(6)
    v_mfma_f32_32x32x16_bf16 v[96:111], v[132:135], v[136:139], v[96:111]
    s_cmp_eq_u32 s53, 0
    s_cselect_b32 s47, 8, 9
    s_add_u32 s47, s47, s64
    s_sub_u32 s46, s47, 10
    s_cselect_b32 s47, s47, s46
    s_lshl_b32 s46, s47, 7
    s_add_u32 s46, s46, s28
    s_mul_i32 s47, s47, 245760
    s_add_u32 m0, s35, 65536
    s_add_u32 s47, s47, s29
    buffer_load_dwordx4 v4, s[12:15], s46 offen lds
    v_mfma_f32_32x32x16_bf16 v[112:127], v[132:135], v[140:143], v[112:127]
    buffer_load_dwordx4 v5, s[12:15], s46 offen offset:1024 lds
    v_mfma_f32_16x16x32_bf16 v[160:163], v[56:59], v[128:131], v[160:163]
    s_waitcnt lgkmcnt(3)
    v_mfma_f32_32x32x16_bf16 v[64:79], v[32:35], v[40:43], v[64:79]
    ds_read_b128 v[136:139], v25 offset:32768
    ds_read_b64_tr_b16 v[128:129], v176 offset:36864
    ds_read_b64_tr_b16 v[130:131], v176 offset:37888
    s_waitcnt lgkmcnt(5)
    v_mfma_f32_32x32x16_bf16 v[80:95], v[32:35], v[44:47], v[80:95]
    ds_read_b128 v[140:143], v25 offset:36864
    ds_read_b64_tr_b16 v[132:133], v177 offset:36864
    ds_read_b64_tr_b16 v[134:135], v177 offset:37888
    s_waitcnt lgkmcnt(6)
    v_mfma_f32_32x32x16_bf16 v[96:111], v[36:39], v[40:43], v[96:111]
    buffer_load_dwordx4 v6, s[12:15], s46 offen offset:2048 lds
    v_mfma_f32_32x32x16_bf16 v[112:127], v[36:39], v[44:47], v[112:127]
    buffer_load_dwordx4 v7, s[12:15], s46 offen offset:3072 lds
    v_mfma_f32_16x16x32_bf16 v[160:163], v[56:59], v[32:35], v[160:163]
    buffer_load_dword v3, v1, s[20:23], s56 offen sc0 sc1
    s_waitcnt lgkmcnt(3)
    v_mfma_f32_32x32x16_bf16 v[64:79], v[128:131], v[136:139], v[64:79]
    ds_read_b128 v[40:43], v26 offset:32768
    ds_read_b64_tr_b16 v[32:33], v176 offset:40960
    ds_read_b64_tr_b16 v[34:35], v176 offset:41984
    s_waitcnt lgkmcnt(5)
    v_mfma_f32_32x32x16_bf16 v[80:95], v[128:131], v[140:143], v[80:95]
    ds_read_b128 v[44:47], v26 offset:36864
    ds_read_b64_tr_b16 v[36:37], v177 offset:40960
    ds_read_b64_tr_b16 v[38:39], v177 offset:41984
    s_waitcnt lgkmcnt(6)
    v_mfma_f32_32x32x16_bf16 v[96:111], v[132:135], v[136:139], v[96:111]
    s_add_u32 m0, s35, 0
    s_nop 0
    buffer_load_dwordx4 v8, s[16:19], s47 offen lds
    v_mfma_f32_32x32x16_bf16 v[112:127], v[132:135], v[140:143], v[112:127]
    buffer_load_dwordx4 v9, s[16:19], s47 offen offset:1024 lds
    v_mfma_f32_16x16x32_bf16 v[160:163], v[56:59], v[128:131], v[160:163]
    s_waitcnt lgkmcnt(3)
    v_mfma_f32_32x32x16_bf16 v[64:79], v[32:35], v[40:43], v[64:79]
    ds_read_b128 v[136:139], v27 offset:32768
    ds_read_b64_tr_b16 v[128:129], v176 offset:45056
    ds_read_b64_tr_b16 v[130:131], v176 offset:46080
    s_waitcnt lgkmcnt(5)
    v_mfma_f32_32x32x16_bf16 v[80:95], v[32:35], v[44:47], v[80:95]
    ds_read_b128 v[140:143], v27 offset:36864
    ds_read_b64_tr_b16 v[132:133], v177 offset:45056
    ds_read_b64_tr_b16 v[134:135], v177 offset:46080
    s_waitcnt lgkmcnt(6)
    v_mfma_f32_32x32x16_bf16 v[96:111], v[36:39], v[40:43], v[96:111]
    buffer_load_dwordx4 v10, s[16:19], s47 offen offset:2048 lds
    v_mfma_f32_32x32x16_bf16 v[112:127], v[36:39], v[44:47], v[112:127]
    buffer_load_dwordx4 v11, s[16:19], s47 offen offset:3072 lds
    v_mfma_f32_16x16x32_bf16 v[160:163], v[56:59], v[32:35], v[160:163]
    s_waitcnt vmcnt(9)
    s_barrier
    s_waitcnt lgkmcnt(3)
    v_mfma_f32_32x32x16_bf16 v[64:79], v[128:131], v[136:139], v[64:79]
    ds_read_b128 v[40:43], v24 offset:49152
    ds_read_b64_tr_b16 v[32:33], v176 offset:49152
    ds_read_b64_tr_b16 v[34:35], v176 offset:50176
    s_waitcnt lgkmcnt(5)
    v_mfma_f32_32x32x16_bf16 v[80:95], v[128:131], v[140:143], v[80:95]
    ds_read_b128 v[44:47], v24 offset:53248
    ds_read_b64_tr_b16 v[36:37], v177 offset:49152
    ds_read_b64_tr_b16 v[38:39], v177 offset:50176
    s_waitcnt lgkmcnt(6)
    v_mfma_f32_32x32x16_bf16 v[96:111], v[132:135], v[136:139], v[96:111]
    s_cmp_eq_u32 s53, 0
    s_cselect_b32 s47, 9, 8
    s_add_u32 s47, s47, s64
    s_sub_u32 s46, s47, 10
    s_cselect_b32 s47, s47, s46
    s_lshl_b32 s46, s47, 7
    s_add_u32 s46, s46, s28
    s_mul_i32 s47, s47, 245760
    s_add_u32 m0, s35, 81920
    s_add_u32 s47, s47, s29
    buffer_load_dwordx4 v4, s[12:15], s46 offen lds
    v_mfma_f32_32x32x16_bf16 v[112:127], v[132:135], v[140:143], v[112:127]
    buffer_load_dwordx4 v5, s[12:15], s46 offen offset:1024 lds
    v_mfma_f32_16x16x32_bf16 v[160:163], v[56:59], v[128:131], v[160:163]
    s_waitcnt lgkmcnt(3)
    v_mfma_f32_32x32x16_bf16 v[64:79], v[32:35], v[40:43], v[64:79]
    ds_read_b128 v[136:139], v25 offset:49152
    ds_read_b64_tr_b16 v[128:129], v176 offset:53248
    ds_read_b64_tr_b16 v[130:131], v176 offset:54272
    s_waitcnt lgkmcnt(5)
    v_mfma_f32_32x32x16_bf16 v[80:95], v[32:35], v[44:47], v[80:95]
    ds_read_b128 v[140:143], v25 offset:53248
    ds_read_b64_tr_b16 v[132:133], v177 offset:53248
    ds_read_b64_tr_b16 v[134:135], v177 offset:54272
    s_waitcnt lgkmcnt(6)
    v_mfma_f32_32x32x16_bf16 v[96:111], v[36:39], v[40:43], v[96:111]
    buffer_load_dwordx4 v6, s[12:15], s46 offen offset:2048 lds
    v_mfma_f32_32x32x16_bf16 v[112:127], v[36:39], v[44:47], v[112:127]
    buffer_load_dwordx4 v7, s[12:15], s46 offen offset:3072 lds
    v_mfma_f32_16x16x32_bf16 v[160:163], v[56:59], v[32:35], v[160:163]
    s_waitcnt lgkmcnt(3)
    v_mfma_f32_32x32x16_bf16 v[64:79], v[128:131], v[136:139], v[64:79]
    ds_read_b128 v[40:43], v26 offset:49152
    ds_read_b64_tr_b16 v[32:33], v176 offset:57344
    ds_read_b64_tr_b16 v[34:35], v176 offset:58368
    s_waitcnt lgkmcnt(5)
    v_mfma_f32_32x32x16_bf16 v[80:95], v[128:131], v[140:143], v[80:95]
    ds_read_b128 v[44:47], v26 offset:53248
    ds_read_b64_tr_b16 v[36:37], v177 offset:57344
    ds_read_b64_tr_b16 v[38:39], v177 offset:58368
    s_waitcnt lgkmcnt(6)
    v_mfma_f32_32x32x16_bf16 v[96:111], v[132:135], v[136:139], v[96:111]
    s_add_u32 m0, s35, 16384
    s_nop 0
    buffer_load_dwordx4 v8, s[16:19], s47 offen lds
    v_mfma_f32_32x32x16_bf16 v[112:127], v[132:135], v[140:143], v[112:127]
    buffer_load_dwordx4 v9, s[16:19], s47 offen offset:1024 lds
    v_mfma_f32_16x16x32_bf16 v[160:163], v[56:59], v[128:131], v[160:163]
    s_waitcnt vmcnt(10)
    v_readfirstlane_b32 s45, v3
    s_nop 0
    s_cmp_ge_u32 s45, 8
    s_cbranch_scc1 L_qsd
    s_mov_b32 s44, 200000
L_qsl:
    buffer_load_dword v3, v1, s[20:23], s56 offen sc0 sc1
    s_waitcnt vmcnt(0)
    v_readfirstlane_b32 s45, v3
    s_nop 0
    s_cmp_ge_u32 s45, 8
    s_cbranch_scc1 L_qsd
    s_sub_u32 s44, s44, 1
    s_cmp_lg_u32 s44, 0
    s_cbranch_scc1 L_qsl
L_qsd:
    buffer_load_dword v168, v22, s[20:23], s41 offen offset:0 sc1
    buffer_load_dword v170, v22, s[20:23], s41 offen offset:128 sc1
    buffer_load_dword v188, v22, s[20:23], s42 offen offset:0 sc1
    buffer_load_dword v190, v22, s[20:23], s42 offen offset:128 sc1
    s_waitcnt lgkmcnt(3)
    v_mfma_f32_32x32x16_bf16 v[64:79], v[32:35], v[40:43], v[64:79]
    ds_read_b128 v[136:139], v27 offset:49152
    ds_read_b64_tr_b16 v[128:129], v176 offset:61440
    ds_read_b64_tr_b16 v[130:131], v176 offset:62464
    s_waitcnt lgkmcnt(5)
    v_mfma_f32_32x32x16_bf16 v[80:95], v[32:35], v[44:47], v[80:95]
    ds_read_b128 v[140:143], v27 offset:53248
    ds_read_b64_tr_b16 v[132:133], v177 offset:61440
    ds_read_b64_tr_b16 v[134:135], v177 offset:62464
    s_waitcnt lgkmcnt(6)
    v_mfma_f32_32x32x16_bf16 v[96:111], v[36:39], v[40:43], v[96:111]
    buffer_load_dwordx4 v10, s[16:19], s47 offen offset:2048 lds
    v_mfma_f32_32x32x16_bf16 v[112:127], v[36:39], v[44:47], v[112:127]
    buffer_load_dwordx4 v11, s[16:19], s47 offen offset:3072 lds
    v_mfma_f32_16x16x32_bf16 v[160:163], v[56:59], v[32:35], v[160:163]
    s_waitcnt vmcnt(12)
    s_barrier
    s_waitcnt lgkmcnt(3)
    v_mfma_f32_32x32x16_bf16 v[64:79], v[128:131], v[136:139], v[64:79]
    ds_read_b128 v[40:43], v24 offset:0
    ds_read_b64_tr_b16 v[32:33], v176 offset:0
    ds_read_b64_tr_b16 v[34:35], v176 offset:1024
    s_waitcnt lgkmcnt(5)
    v_mfma_f32_32x32x16_bf16 v[80:95], v[128:131], v[140:143], v[80:95]
    ds_read_b128 v[44:47], v24 offset:4096
    ds_read_b64_tr_b16 v[36:37], v177 offset:0
    ds_read_b64_tr_b16 v[38:39], v177 offset:1024
    s_waitcnt lgkmcnt(6)
    v_mfma_f32_32x32x16_bf16 v[96:111], v[132:135], v[136:139], v[96:111]
    v_mfma_f32_32x32x16_bf16 v[112:127], v[132:135], v[140:143], v[112:127]
    v_mfma_f32_16x16x32_bf16 v[160:163], v[56:59], v[128:131], v[160:163]
    s_waitcnt lgkmcnt(3)
    v_mfma_f32_32x32x16_bf16 v[64:79], v[32:35], v[40:43], v[64:79]
    ds_read_b128 v[136:139], v25 offset:0
    ds_read_b64_tr_b16 v[128:129], v176 offset:4096
    ds_read_b64_tr_b16 v[130:131], v176 offset:5120
    s_waitcnt lgkmcnt(5)
    v_mfma_f32_32x32x16_bf16 v[80:95], v[32:35], v[44:47], v[80:95]
    ds_read_b128 v[140:143], v25 offset:4096
    ds_read_b64_tr_b16 v[132:133], v177 offset:4096
    ds_read_b64_tr_b16 v[134:135], v177 offset:5120
    s_waitcnt lgkmcnt(6)
    v_mfma_f32_32x32x16_bf16 v[96:111], v[36:39], v[40:43], v[96:111]
    v_mfma_f32_32x32x16_bf16 v[112:127], v[36:39], v[44:47], v[112:127]
    v_mfma_f32_16x16x32_bf16 v[160:163], v[56:59], v[32:35], v[160:163]
    s_waitcnt lgkmcnt(3)
    v_mfma_f32_32x32x16_bf16 v[64:79], v[128:131], v[136:139], v[64:79]
    ds_read_b128 v[40:43], v26 offset:0
    ds_read_b64_tr_b16 v[32:33], v176 offset:8192
    ds_read_b64_tr_b16 v[34:35], v176 offset:9216
    s_waitcnt lgkmcnt(5)
    v_mfma_f32_32x32x16_bf16 v[80:95], v[128:131], v[140:143], v[80:95]
    ds_read_b128 v[44:47], v26 offset:4096
    ds_read_b64_tr_b16 v[36:37], v177 offset:8192
    ds_read_b64_tr_b16 v[38:39], v177 offset:9216
    s_waitcnt lgkmcnt(6)
    v_mfma_f32_32x32x16_bf16 v[96:111], v[132:135], v[136:139], v[96:111]
    v_mfma_f32_32x32x16_bf16 v[112:127], v[132:135], v[140:143], v[112:127]
    v_mfma_f32_16x16x32_bf16 v[160:163], v[56:59], v[128:131], v[160:163]
    s_waitcnt lgkmcnt(3)
    v_mfma_f32_32x32x16_bf16 v[64:79], v[32:35], v[40:43], v[64:79]
    ds_read_b128 v[136:139], v27 offset:0
    ds_read_b64_tr_b16 v[128:129], v176 offset:12288
    ds_read_b64_tr_b16 v[130:131], v176 offset:13312
    s_waitcnt lgkmcnt(5)
    v_mfma_f32_32x32x16_bf16 v[80:95], v[32:35], v[44:47], v[80:95]
    ds_read_b128 v[140:143], v27 offset:4096
    ds_read_b64_tr_b16 v[132:133], v177 offset:12288
    ds_read_b64_tr_b16 v[134:135], v177 offset:13312
    s_waitcnt lgkmcnt(6)
    v_mfma_f32_32x32x16_bf16 v[96:111], v[36:39], v[40:43], v[96:111]
    v_mfma_f32_32x32x16_bf16 v[112:127], v[36:39], v[44:47], v[112:127]
    v_mfma_f32_16x16x32_bf16 v[160:163], v[56:59], v[32:35], v[160:163]
    s_waitcnt vmcnt(0)
    s_barrier
    s_waitcnt lgkmcnt(3)
    v_mfma_f32_32x32x16_bf16 v[64:79], v[128:131], v[136:139], v[64:79]
    ds_read_b64_tr_b16 a[0:1], v176 offset:16384
    ds_read_b64_tr_b16 a[2:3], v176 offset:17408
    ds_read_b128 a[16:19], v24 offset:16384
    s_waitcnt lgkmcnt(5)
    v_mfma_f32_32x32x16_bf16 v[80:95], v[128:131], v[140:143], v[80:95]
    ds_read_b128 a[32:35], v24 offset:20480
    ds_read_b64_tr_b16 a[4:5], v176 offset:20480
    ds_read_b64_tr_b16 a[6:7], v176 offset:21504
    s_waitcnt lgkmcnt(6)
    v_mfma_f32_32x32x16_bf16 v[96:111], v[132:135], v[136:139], v[96:111]
    ds_read_b64_tr_b16 a[8:9], v176 offset:24576
    ds_read_b64_tr_b16 a[10:11], v176 offset:25600
    ds_read_b64_tr_b16 a[12:13], v176 offset:28672
    v_mfma_f32_32x32x16_bf16 v[112:127], v[132:135], v[140:143], v[112:127]
    v_mfma_f32_16x16x32_bf16 v[160:163], v[56:59], v[128:131], v[160:163]
    ds_read_b64_tr_b16 a[14:15], v176 offset:29696
    ds_read_b128 a[20:23], v25 offset:16384
    ds_read_b128 a[36:39], v25 offset:20480
    s_waitcnt lgkmcnt(9)
    v_mfma_f32_32x32x16_bf16 v[64:79], a[0:3], a[16:19], v[64:79]
    ds_read_b128 a[24:27], v26 offset:16384
    ds_read_b128 a[40:43], v26 offset:20480
    ds_read_b128 a[28:31], v27 offset:16384
    v_mfma_f32_16x16x32_bf16 v[160:163], v[56:59], a[0:3], v[160:163]
    s_waitcnt lgkmcnt(11)
    v_mfma_f32_32x32x16_bf16 v[80:95], a[0:3], a[32:35], v[80:95]
    ds_read_b128 a[44:47], v27 offset:20480
    ds_read_b64_tr_b16 a[48:49], v177 offset:16384
    ds_read_b64_tr_b16 a[50:51], v177 offset:17408
    s_waitcnt lgkmcnt(12)
    v_mfma_f32_16x16x32_bf16 v[160:163], v[56:59], a[4:7], v[160:163]
    s_waitcnt lgkmcnt(7)
    v_mfma_f32_32x32x16_bf16 v[64:79], a[4:7], a[20:23], v[64:79]
    ds_read_b64_tr_b16 a[52:53], v177 offset:20480
    ds_read_b64_tr_b16 a[54:55], v177 offset:21504
    ds_read_b64_tr_b16 a[56:57], v177 offset:24576
    v_mfma_f32_16x16x32_bf16 v[160:163], v[56:59], a[8:11], v[160:163]
    s_waitcnt lgkmcnt(9)
    v_mfma_f32_32x32x16_bf16 v[80:95], a[4:7], a[36:39], v[80:95]
    ds_read_b64_tr_b16 a[58:59], v177 offset:25600
    ds_read_b64_tr_b16 a[60:61], v177 offset:28672
    ds_read_b64_tr_b16 a[62:63], v177 offset:29696
    v_mfma_f32_16x16x32_bf16 v[160:163], v[56:59], a[12:15], v[160:163]
    s_waitcnt lgkmcnt(11)
    v_mfma_f32_32x32x16_bf16 v[64:79], a[8:11], a[24:27], v[64:79]
    v_cmp_eq_u32 vcc, 0, v12
    v_mul_f32 v188, s39, v188
    v_mul_f32 v190, s39, v190
    v_cndmask_b32 v168, 0, v168, vcc
    v_cndmask_b32 v170, 0, v170, vcc
    s_waitcnt lgkmcnt(10)
    v_mfma_f32_32x32x16_bf16 v[80:95], a[8:11], a[40:43], v[80:95]
    v_cvt_pk_bf16_f32 v161, v160, v160
    v_and_b32 v161, 0xffff0000, v161
    v_sub_f32 v160, v160, v161
    v_cvt_pk_bf16_f32 v160, v161, v160
    s_waitcnt lgkmcnt(9)
    v_mfma_f32_32x32x16_bf16 v[64:79], a[12:15], a[28:31], v[64:79]
    ds_write_b32 v21, v160
    v_mov_b32 v161, 0
    s_waitcnt lgkmcnt(9)
    v_mfma_f32_32x32x16_bf16 v[80:95], a[12:15], a[44:47], v[80:95]
    v_mfma_f32_32x32x8_bf16 v[64:79], v[160:161], v[168:169], v[64:79]
    v_mfma_f32_32x32x8_bf16 v[80:95], v[160:161], v[170:171], v[80:95]
    s_waitcnt lgkmcnt(7)
    v_mfma_f32_32x32x16_bf16 v[96:111], a[48:51], a[16:19], v[96:111]
    s_waitcnt lgkmcnt(0)
    s_barrier
    ds_read_b32 v164, v20
    v_mfma_f32_32x32x16_bf16 v[112:127], a[48:51], a[32:35], v[112:127]
    s_nop 4
    v_mul_f32 v64, v188, v64
    v_mul_f32 v65, v188, v65
    v_mul_f32 v66, v188, v66
    v_mul_f32 v67, v188, v67
    v_mul_f32 v68, v188, v68
    v_mul_f32 v69, v188, v69
    v_mul_f32 v70, v188, v70
    v_mul_f32 v71, v188, v71
    v_mfma_f32_32x32x16_bf16 v[96:111], a[52:55], a[20:23], v[96:111]
    v_cvt_pk_bf16_f32 v64, v64, v65
    v_cvt_pk_bf16_f32 v65, v66, v67
    v_cvt_pk_bf16_f32 v66, v68, v69
    v_cvt_pk_bf16_f32 v67, v70, v71
    buffer_store_dwordx4 v[64:67], v19, s[20:23], s60 offen offset:0 sc1
    v_mul_f32 v72, v188, v72
    v_mul_f32 v73, v188, v73
    v_mul_f32 v74, v188, v74
    v_mfma_f32_32x32x16_bf16 v[112:127], a[52:55], a[36:39], v[112:127]
    v_mul_f32 v75, v188, v75
    v_mul_f32 v76, v188, v76
    v_mul_f32 v77, v188, v77
    v_mul_f32 v78, v188, v78
    v_mul_f32 v79, v188, v79
    v_cvt_pk_bf16_f32 v72, v72, v73
    v_cvt_pk_bf16_f32 v73, v74, v75
    v_cvt_pk_bf16_f32 v74, v76, v77
    v_mfma_f32_32x32x16_bf16 v[96:111], a[56:59], a[24:27], v[96:111]
    v_cvt_pk_bf16_f32 v75, v78, v79
    buffer_store_dwordx4 v[72:75], v19, s[20:23], s61 offen offset:0 sc1
    v_mul_f32 v80, v190, v80
    v_mul_f32 v81, v190, v81
    v_mul_f32 v82, v190, v82
    v_mul_f32 v83, v190, v83
    v_mul_f32 v84, v190, v84
    v_mul_f32 v85, v190, v85
    v_mfma_f32_32x32x16_bf16 v[112:127], a[56:59], a[40:43], v[112:127]
    v_mul_f32 v86, v190, v86
    v_mul_f32 v87, v190, v87
    v_cvt_pk_bf16_f32 v80, v80, v81
    v_cvt_pk_bf16_f32 v81, v82, v83
    v_cvt_pk_bf16_f32 v82, v84, v85
    v_cvt_pk_bf16_f32 v83, v86, v87
    buffer_store_dwordx4 v[80:83], v19, s[20:23], s60 offen offset:512 sc1
    v_mul_f32 v88, v190, v88
    v_mfma_f32_32x32x16_bf16 v[96:111], a[60:63], a[28:31], v[96:111]
    v_mul_f32 v89, v190, v89
    v_mul_f32 v90, v190, v90
    v_mul_f32 v91, v190, v91
    v_mul_f32 v92, v190, v92
    v_mul_f32 v93, v190, v93
    v_mul_f32 v94, v190, v94
    v_mul_f32 v95, v190, v95
    v_cvt_pk_bf16_f32 v88, v88, v89
    v_mfma_f32_32x32x16_bf16 v[112:127], a[60:63], a[44:47], v[112:127]
    v_cvt_pk_bf16_f32 v89, v90, v91
    v_cvt_pk_bf16_f32 v90, v92, v93
    v_cvt_pk_bf16_f32 v91, v94, v95
    buffer_store_dwordx4 v[88:91], v19, s[20:23], s61 offen offset:512 sc1
    s_waitcnt lgkmcnt(0)
    v_mfma_f32_32x32x8_bf16 v[96:111], v[164:165], v[168:169], v[96:111]
    v_mfma_f32_32x32x8_bf16 v[112:127], v[164:165], v[170:171], v[112:127]
    s_nop 10
    v_pk_mul_f32 v[96:97], v[96:97], v[188:189] op_sel_hi:[1,0]
    v_pk_mul_f32 v[98:99], v[98:99], v[188:189] op_sel_hi:[1,0]
    v_pk_mul_f32 v[100:101], v[100:101], v[188:189] op_sel_hi:[1,0]
    v_pk_mul_f32 v[102:103], v[102:103], v[188:189] op_sel_hi:[1,0]
    v_cvt_pk_bf16_f32 v96, v96, v97
    v_cvt_pk_bf16_f32 v97, v98, v99
    v_cvt_pk_bf16_f32 v98, v100, v101
    v_cvt_pk_bf16_f32 v99, v102, v103
    buffer_store_dwordx4 v[96:99], v19, s[20:23], s62 offen offset:0 sc1
    v_pk_mul_f32 v[104:105], v[104:105], v[188:189] op_sel_hi:[1,0]
    v_pk_mul_f32 v[106:107], v[106:107], v[188:189] op_sel_hi:[1,0]
    v_pk_mul_f32 v[108:109], v[108:109], v[188:189] op_sel_hi:[1,0]
    v_pk_mul_f32 v[110:111], v[110:111], v[188:189] op_sel_hi:[1,0]
    v_cvt_pk_bf16_f32 v104, v104, v105
    v_cvt_pk_bf16_f32 v105, v106, v107
    v_cvt_pk_bf16_f32 v106, v108, v109
    v_cvt_pk_bf16_f32 v107, v110, v111
    buffer_store_dwordx4 v[104:107], v19, s[20:23], s63 offen offset:0 sc1
    v_pk_mul_f32 v[112:113], v[112:113], v[190:191] op_sel_hi:[1,0]
    v_pk_mul_f32 v[114:115], v[114:115], v[190:191] op_sel_hi:[1,0]
    v_pk_mul_f32 v[116:117], v[116:117], v[190:191] op_sel_hi:[1,0]
    v_pk_mul_f32 v[118:119], v[118:119], v[190:191] op_sel_hi:[1,0]
    v_cvt_pk_bf16_f32 v112, v112, v113
    v_cvt_pk_bf16_f32 v113, v114, v115
    v_cvt_pk_bf16_f32 v114, v116, v117
    v_cvt_pk_bf16_f32 v115, v118, v119
    buffer_store_dwordx4 v[112:115], v19, s[20:23], s62 offen offset:512 sc1
    v_pk_mul_f32 v[120:121], v[120:121], v[190:191] op_sel_hi:[1,0]
    v_pk_mul_f32 v[122:123], v[122:123], v[190:191] op_sel_hi:[1,0]
    v_pk_mul_f32 v[124:125], v[124:125], v[190:191] op_sel_hi:[1,0]
    v_pk_mul_f32 v[126:127], v[126:127], v[190:191] op_sel_hi:[1,0]
    v_cvt_pk_bf16_f32 v120, v120, v121
    v_cvt_pk_bf16_f32 v121, v122, v123
    v_cvt_pk_bf16_f32 v122, v124, v125
    v_cvt_pk_bf16_f32 v123, v126, v127
    buffer_store_dwordx4 v[120:123], v19, s[20:23], s63 offen offset:512 sc1
    s_branch L_qdone
L_vrest:
    s_waitcnt lgkmcnt(3)
    v_mfma_f32_32x32x16_bf16 v[64:79], v[40:43], v[32:35], v[64:79]
    ds_read_b128 v[136:139], v27 offset:16384
    ds_read_b64_tr_b16 v[128:129], v176 offset:28672
    ds_read_b64_tr_b16 v[130:131], v176 offset:29696
    s_waitcnt lgkmcnt(5)
    v_mfma_f32_32x32x16_bf16 v[80:95], v[44:47], v[32:35], v[80:95]
    ds_read_b128 v[140:143], v27 offset:20480
    ds_read_b64_tr_b16 v[132:133], v177 offset:28672
    ds_read_b64_tr_b16 v[134:135], v177 offset:29696
    buffer_load_dwordx4 v10, s[16:19], s47 offen offset:2048 lds
    s_waitcnt lgkmcnt(6)
    v_mfma_f32_32x32x16_bf16 v[96:111], v[40:43], v[36:39], v[96:111]
    buffer_load_dwordx4 v11, s[16:19], s47 offen offset:3072 lds
    v_mfma_f32_32x32x16_bf16 v[112:127], v[44:47], v[36:39], v[112:127]
    v_dot2c_f32_bf16 v60, s40, v239
    v_dot2c_f32_bf16 v61, v239, v239
    v_dot2c_f32_bf16 v60, s40, v240
    v_dot2c_f32_bf16 v61, v240, v240
    v_dot2c_f32_bf16 v60, s40, v241
    v_dot2c_f32_bf16 v61, v241, v241
    v_dot2c_f32_bf16 v60, s40, v242
    v_dot2c_f32_bf16 v61, v242, v242
    v_dot2c_f32_bf16 v60, s40, v243
    v_dot2c_f32_bf16 v61, v243, v243
    s_nop 1
    v_add_f32_dpp v60, v60, v60 row_ror:8 row_mask:0xf bank_mask:0xf
    v_add_f32_dpp v61, v61, v61 row_ror:8 row_mask:0xf bank_mask:0xf
    s_nop 0
    v_add_f32_dpp v60, v60, v60 row_ror:4 row_mask:0xf bank_mask:0xf
    v_add_f32_dpp v61, v61, v61 row_ror:4 row_mask:0xf bank_mask:0xf
    s_nop 0
    v_add_f32_dpp v60, v60, v60 row_ror:2 row_mask:0xf bank_mask:0xf
    v_add_f32_dpp v61, v61, v61 row_ror:2 row_mask:0xf bank_mask:0xf
    v_mfma_f32_16x16x32_bf16 v[160:163], v[56:59], v[32:35], v[160:163]
    s_waitcnt vmcnt(8)
    s_barrier
    s_waitcnt lgkmcnt(3)
    v_mfma_f32_32x32x16_bf16 v[64:79], v[136:139], v[128:131], v[64:79]
    ds_read_b128 v[40:43], v24 offset:32768
    ds_read_b64_tr_b16 v[32:33], v176 offset:32768
    ds_read_b64_tr_b16 v[34:35], v176 offset:33792
    s_waitcnt lgkmcnt(5)
    v_mfma_f32_32x32x16_bf16 v[80:95], v[140:143], v[128:131], v[80:95]
    ds_read_b128 v[44:47], v24 offset:36864
    ds_read_b64_tr_b16 v[36:37], v177 offset:32768
    ds_read_b64_tr_b16 v[38:39], v177 offset:33792
    s_cmp_eq_u32 s53, 0
    s_cselect_b32 s47, 4, 5
    s_add_u32 s47, s47, s64
    s_sub_u32 s46, s47, 10
    s_cselect_b32 s47, s47, s46
    s_lshl_b32 s46, s47, 7
    s_add_u32 s46, s46, s28
    s_mul_i32 s47, s47, 245760
    s_add_u32 m0, s35, 65536
    s_add_u32 s47, s47, s29
    buffer_load_dwordx4 v4, s[12:15], s46 offen lds
    s_waitcnt lgkmcnt(6)
    v_mfma_f32_32x32x16_bf16 v[96:111], v[136:139], v[132:135], v[96:111]
    buffer_load_dwordx4 v5, s[12:15], s46 offen offset:1024 lds
    v_mfma_f32_32x32x16_bf16 v[112:127], v[140:143], v[132:135], v[112:127]
    buffer_load_dwordx4 v6, s[12:15], s46 offen offset:2048 lds
    v_add_f32_dpp v60, v60, v60 row_ror:1 row_mask:0xf bank_mask:0xf
    v_add_f32_dpp v61, v61, v61 row_ror:1 row_mask:0xf bank_mask:0xf
    v_mul_f32 v60, 0x3acccccd, v60
    v_mul_f32 v61, 0x3acccccd, v61
    v_fma_f32 v62, -v60, v60, v61
    v_max_f32 v62, 0, v62
    v_cvt_pk_bf16_f32 v63, v60, v60
    v_and_b32 v63, 0xffff0000, v63
    v_cvt_pk_bf16_f32 v62, v62, v62
    v_and_b32 v62, 0xffff0000, v62
    v_add_f32 v62, 0x3727c5ac, v62
    v_cvt_pk_bf16_f32 v62, v62, v62
    v_and_b32 v62, 0xffff0000, v62
    v_sqrt_f32 v62, v62
    s_nop 0
    v_cvt_pk_bf16_f32 v61, v62, v62
    v_and_b32 v61, 0xffff0000, v61
    v_mfma_f32_16x16x32_bf16 v[160:163], v[56:59], v[128:131], v[160:163]
    s_waitcnt lgkmcnt(3)
    v_mfma_f32_32x32x16_bf16 v[64:79], v[40:43], v[32:35], v[64:79]
    ds_read_b128 v[136:139], v25 offset:32768
    ds_read_b64_tr_b16 v[128:129], v176 offset:36864
    ds_read_b64_tr_b16 v[130:131], v176 offset:37888
    s_waitcnt lgkmcnt(5)
    v_mfma_f32_32x32x16_bf16 v[80:95], v[44:47], v[32:35], v[80:95]
    ds_read_b128 v[140:143], v25 offset:36864
    ds_read_b64_tr_b16 v[132:133], v177 offset:36864
    ds_read_b64_tr_b16 v[134:135], v177 offset:37888
    buffer_load_dwordx4 v7, s[12:15], s46 offen offset:3072 lds
    s_waitcnt lgkmcnt(6)
    v_mfma_f32_32x32x16_bf16 v[96:111], v[40:43], v[36:39], v[96:111]
    s_add_u32 m0, s35, 0
    s_nop 0
    buffer_load_dwordx4 v8, s[16:19], s47 offen lds
    v_mfma_f32_32x32x16_bf16 v[112:127], v[44:47], v[36:39], v[112:127]
    buffer_load_dwordx4 v9, s[16:19], s47 offen offset:1024 lds
    v_rcp_f32 v61, v61
    v_cvt_pk_bf16_f32 v63, -v63, -v63
    buffer_store_dword v63, v53, s[20:23], s58 offen sc1
    buffer_store_dword v61, v53, s[20:23], s59 offen sc1
    v_mfma_f32_16x16x32_bf16 v[160:163], v[56:59], v[32:35], v[160:163]
    buffer_load_dword v3, v1, s[48:51], 0 offen sc0 sc1
    s_waitcnt lgkmcnt(3)
    v_mfma_f32_32x32x16_bf16 v[64:79], v[136:139], v[128:131], v[64:79]
    ds_read_b128 v[40:43], v26 offset:32768
    ds_read_b64_tr_b16 v[32:33], v176 offset:40960
    ds_read_b64_tr_b16 v[34:35], v176 offset:41984
    s_waitcnt lgkmcnt(5)
    v_mfma_f32_32x32x16_bf16 v[80:95], v[140:143], v[128:131], v[80:95]
    ds_read_b128 v[44:47], v26 offset:36864
    ds_read_b64_tr_b16 v[36:37], v177 offset:40960
    ds_read_b64_tr_b16 v[38:39], v177 offset:41984
    buffer_load_dwordx4 v10, s[16:19], s47 offen offset:2048 lds
    s_waitcnt lgkmcnt(6)
    v_mfma_f32_32x32x16_bf16 v[96:111], v[136:139], v[132:135], v[96:111]
    buffer_load_dwordx4 v11, s[16:19], s47 offen offset:3072 lds
    v_mfma_f32_32x32x16_bf16 v[112:127], v[140:143], v[132:135], v[112:127]
    v_mfma_f32_16x16x32_bf16 v[160:163], v[56:59], v[128:131], v[160:163]
    s_waitcnt lgkmcnt(3)
    v_mfma_f32_32x32x16_bf16 v[64:79], v[40:43], v[32:35], v[64:79]
    ds_read_b128 v[136:139], v27 offset:32768
    ds_read_b64_tr_b16 v[128:129], v176 offset:45056
    ds_read_b64_tr_b16 v[130:131], v176 offset:46080
    s_waitcnt lgkmcnt(5)
    v_mfma_f32_32x32x16_bf16 v[80:95], v[44:47], v[32:35], v[80:95]
    ds_read_b128 v[140:143], v27 offset:36864
    ds_read_b64_tr_b16 v[132:133], v177 offset:45056
    ds_read_b64_tr_b16 v[134:135], v177 offset:46080
    s_waitcnt lgkmcnt(6)
    v_mfma_f32_32x32x16_bf16 v[96:111], v[40:43], v[36:39], v[96:111]
    v_mfma_f32_32x32x16_bf16 v[112:127], v[44:47], v[36:39], v[112:127]
    v_mfma_f32_16x16x32_bf16 v[160:163], v[56:59], v[32:35], v[160:163]
    s_waitcnt vmcnt(11)
    s_barrier
    s_waitcnt lgkmcnt(3)
    v_mfma_f32_32x32x16_bf16 v[64:79], v[136:139], v[128:131], v[64:79]
    ds_read_b128 v[40:43], v24 offset:49152
    ds_read_b64_tr_b16 v[32:33], v176 offset:49152
    ds_read_b64_tr_b16 v[34:35], v176 offset:50176
    s_waitcnt lgkmcnt(5)
    v_mfma_f32_32x32x16_bf16 v[80:95], v[140:143], v[128:131], v[80:95]
    ds_read_b128 v[44:47], v24 offset:53248
    ds_read_b64_tr_b16 v[36:37], v177 offset:49152
    ds_read_b64_tr_b16 v[38:39], v177 offset:50176
    s_cmp_eq_u32 s53, 0
    s_cselect_b32 s47, 5, 4
    s_add_u32 s47, s47, s64
    s_sub_u32 s46, s47, 10
    s_cselect_b32 s47, s47, s46
    s_lshl_b32 s46, s47, 7
    s_add_u32 s46, s46, s28
    s_mul_i32 s47, s47, 245760
    s_add_u32 m0, s35, 81920
    s_add_u32 s47, s47, s29
    buffer_load_dwordx4 v4, s[12:15], s46 offen lds
    s_waitcnt lgkmcnt(6)
    v_mfma_f32_32x32x16_bf16 v[96:111], v[136:139], v[132:135], v[96:111]
    buffer_load_dwordx4 v5, s[12:15], s46 offen offset:1024 lds
    v_mfma_f32_32x32x16_bf16 v[112:127], v[140:143], v[132:135], v[112:127]
    buffer_load_dwordx4 v6, s[12:15], s46 offen offset:2048 lds
    v_mfma_f32_16x16x32_bf16 v[160:163], v[56:59], v[128:131], v[160:163]
    s_waitcnt lgkmcnt(3)
    v_mfma_f32_32x32x16_bf16 v[64:79], v[40:43], v[32:35], v[64:79]
    ds_read_b128 v[136:139], v25 offset:49152
    ds_read_b64_tr_b16 v[128:129], v176 offset:53248
    ds_read_b64_tr_b16 v[130:131], v176 offset:54272
    s_waitcnt lgkmcnt(5)
    v_mfma_f32_32x32x16_bf16 v[80:95], v[44:47], v[32:35], v[80:95]
    ds_read_b128 v[140:143], v25 offset:53248
    ds_read_b64_tr_b16 v[132:133], v177 offset:53248
    ds_read_b64_tr_b16 v[134:135], v177 offset:54272
    s_waitcnt lgkmcnt(6)
    v_mfma_f32_32x32x16_bf16 v[96:111], v[40:43], v[36:39], v[96:111]
    buffer_load_dwordx4 v7, s[12:15], s46 offen offset:3072 lds
    v_mfma_f32_32x32x16_bf16 v[112:127], v[44:47], v[36:39], v[112:127]
    s_add_u32 m0, s35, 16384
    s_nop 0
    buffer_load_dwordx4 v8, s[16:19], s47 offen lds
    v_mfma_f32_16x16x32_bf16 v[160:163], v[56:59], v[32:35], v[160:163]
    s_waitcnt lgkmcnt(3)
    v_mfma_f32_32x32x16_bf16 v[64:79], v[136:139], v[128:131], v[64:79]
    ds_read_b128 v[40:43], v26 offset:49152
    ds_read_b64_tr_b16 v[32:33], v176 offset:57344
    ds_read_b64_tr_b16 v[34:35], v176 offset:58368
    s_waitcnt lgkmcnt(5)
    v_mfma_f32_32x32x16_bf16 v[80:95], v[140:143], v[128:131], v[80:95]
    ds_read_b128 v[44:47], v26 offset:53248
    ds_read_b64_tr_b16 v[36:37], v177 offset:57344
    ds_read_b64_tr_b16 v[38:39], v177 offset:58368
    s_waitcnt lgkmcnt(6)
    v_mfma_f32_32x32x16_bf16 v[96:111], v[136:139], v[132:135], v[96:111]
    buffer_load_dwordx4 v9, s[16:19], s47 offen offset:1024 lds
    v_mfma_f32_32x32x16_bf16 v[112:127], v[140:143], v[132:135], v[112:127]
    buffer_load_dwordx4 v10, s[16:19], s47 offen offset:2048 lds
    v_mfma_f32_16x16x32_bf16 v[160:163], v[56:59], v[128:131], v[160:163]
    s_waitcnt lgkmcnt(3)
    v_mfma_f32_32x32x16_bf16 v[64:79], v[40:43], v[32:35], v[64:79]
    ds_read_b128 v[136:139], v27 offset:49152
    ds_read_b64_tr_b16 v[128:129], v176 offset:61440
    ds_read_b64_tr_b16 v[130:131], v176 offset:62464
    s_waitcnt lgkmcnt(5)
    v_mfma_f32_32x32x16_bf16 v[80:95], v[44:47], v[32:35], v[80:95]
    ds_read_b128 v[140:143], v27 offset:53248
    ds_read_b64_tr_b16 v[132:133], v177 offset:61440
    ds_read_b64_tr_b16 v[134:135], v177 offset:62464
    s_waitcnt lgkmcnt(6)
    v_mfma_f32_32x32x16_bf16 v[96:111], v[40:43], v[36:39], v[96:111]
    buffer_load_dwordx4 v11, s[16:19], s47 offen offset:3072 lds
    v_mfma_f32_32x32x16_bf16 v[112:127], v[44:47], v[36:39], v[112:127]
    v_mfma_f32_16x16x32_bf16 v[160:163], v[56:59], v[32:35], v[160:163]
    s_waitcnt vmcnt(8)
    s_barrier
    v_readfirstlane_b32 s45, v3
    s_nop 0
    s_cmp_ge_u32 s45, 16
    s_cbranch_scc1 L_vid
    s_mov_b32 s44, 200000
L_vil:
    buffer_load_dword v3, v1, s[48:51], 0 offen sc0 sc1
    s_waitcnt vmcnt(0)
    v_readfirstlane_b32 s45, v3
    s_nop 0
    s_cmp_ge_u32 s45, 16
    s_cbranch_scc1 L_vid
    s_sub_u32 s44, s44, 1
    s_cmp_lg_u32 s44, 0
    s_cbranch_scc1 L_vil
L_vid:
    buffer_atomic_add v52, v55, s[20:23], s55 offen sc1
    s_waitcnt lgkmcnt(3)
    v_mfma_f32_32x32x16_bf16 v[64:79], v[136:139], v[128:131], v[64:79]
    ds_read_b128 v[40:43], v24 offset:0
    ds_read_b64_tr_b16 v[32:33], v176 offset:0
    ds_read_b64_tr_b16 v[34:35], v176 offset:1024
    s_waitcnt lgkmcnt(5)
    v_mfma_f32_32x32x16_bf16 v[80:95], v[140:143], v[128:131], v[80:95]
    ds_read_b128 v[44:47], v24 offset:4096
    ds_read_b64_tr_b16 v[36:37], v177 offset:0
    ds_read_b64_tr_b16 v[38:39], v177 offset:1024
    s_waitcnt lgkmcnt(6)
    v_mfma_f32_32x32x16_bf16 v[96:111], v[136:139], v[132:135], v[96:111]
    s_cmp_eq_u32 s53, 0
    s_cselect_b32 s47, 6, 7
    s_add_u32 s47, s47, s64
    s_sub_u32 s46, s47, 10
    s_cselect_b32 s47, s47, s46
    s_lshl_b32 s46, s47, 7
    s_add_u32 s46, s46, s28
    s_mul_i32 s47, s47, 245760
    s_add_u32 m0, s35, 98304
    s_add_u32 s47, s47, s29
    buffer_load_dwordx4 v4, s[12:15], s46 offen lds
    v_mfma_f32_32x32x16_bf16 v[112:127], v[140:143], v[132:135], v[112:127]
    buffer_load_dwordx4 v5, s[12:15], s46 offen offset:1024 lds
    v_mfma_f32_16x16x32_bf16 v[160:163], v[56:59], v[128:131], v[160:163]
    s_waitcnt lgkmcnt(3)
    v_mfma_f32_32x32x16_bf16 v[64:79], v[40:43], v[32:35], v[64:79]
    ds_read_b128 v[136:139], v25 offset:0
    ds_read_b64_tr_b16 v[128:129], v176 offset:4096
    ds_read_b64_tr_b16 v[130:131], v176 offset:5120
    s_waitcnt lgkmcnt(5)
    v_mfma_f32_32x32x16_bf16 v[80:95], v[44:47], v[32:35], v[80:95]
    ds_read_b128 v[140:143], v25 offset:4096
    ds_read_b64_tr_b16 v[132:133], v177 offset:4096
    ds_read_b64_tr_b16 v[134:135], v177 offset:5120
    s_waitcnt lgkmcnt(6)
    v_mfma_f32_32x32x16_bf16 v[96:111], v[40:43], v[36:39], v[96:111]
    buffer_load_dwordx4 v6, s[12:15], s46 offen offset:2048 lds
    v_mfma_f32_32x32x16_bf16 v[112:127], v[44:47], v[36:39], v[112:127]
    buffer_load_dwordx4 v7, s[12:15], s46 offen offset:3072 lds
    v_mfma_f32_16x16x32_bf16 v[160:163], v[56:59], v[32:35], v[160:163]
    s_waitcnt lgkmcnt(3)
    v_mfma_f32_32x32x16_bf16 v[64:79], v[136:139], v[128:131], v[64:79]
    ds_read_b128 v[40:43], v26 offset:0
    ds_read_b64_tr_b16 v[32:33], v176 offset:8192
    ds_read_b64_tr_b16 v[34:35], v176 offset:9216
    s_waitcnt lgkmcnt(5)
    v_mfma_f32_32x32x16_bf16 v[80:95], v[140:143], v[128:131], v[80:95]
    ds_read_b128 v[44:47], v26 offset:4096
    ds_read_b64_tr_b16 v[36:37], v177 offset:8192
    ds_read_b64_tr_b16 v[38:39], v177 offset:9216
    s_waitcnt lgkmcnt(6)
    v_mfma_f32_32x32x16_bf16 v[96:111], v[136:139], v[132:135], v[96:111]
    s_add_u32 m0, s35, 32768
    s_nop 0
    buffer_load_dwordx4 v8, s[16:19], s47 offen lds
    v_mfma_f32_32x32x16_bf16 v[112:127], v[140:143], v[132:135], v[112:127]
    buffer_load_dwordx4 v9, s[16:19], s47 offen offset:1024 lds
    v_mfma_f32_16x16x32_bf16 v[160:163], v[56:59], v[128:131], v[160:163]
    s_waitcnt lgkmcnt(3)
    v_mfma_f32_32x32x16_bf16 v[64:79], v[40:43], v[32:35], v[64:79]
    ds_read_b128 v[136:139], v27 offset:0
    ds_read_b64_tr_b16 v[128:129], v176 offset:12288
    ds_read_b64_tr_b16 v[130:131], v176 offset:13312
    s_waitcnt lgkmcnt(5)
    v_mfma_f32_32x32x16_bf16 v[80:95], v[44:47], v[32:35], v[80:95]
    ds_read_b128 v[140:143], v27 offset:4096
    ds_read_b64_tr_b16 v[132:133], v177 offset:12288
    ds_read_b64_tr_b16 v[134:135], v177 offset:13312
    s_waitcnt lgkmcnt(6)
    v_mfma_f32_32x32x16_bf16 v[96:111], v[40:43], v[36:39], v[96:111]
    buffer_load_dwordx4 v10, s[16:19], s47 offen offset:2048 lds
    v_mfma_f32_32x32x16_bf16 v[112:127], v[44:47], v[36:39], v[112:127]
    buffer_load_dwordx4 v11, s[16:19], s47 offen offset:3072 lds
    v_mfma_f32_16x16x32_bf16 v[160:163], v[56:59], v[32:35], v[160:163]
    s_waitcnt vmcnt(9)
    s_barrier
    s_waitcnt lgkmcnt(3)
    v_mfma_f32_32x32x16_bf16 v[64:79], v[136:139], v[128:131], v[64:79]
    ds_read_b128 v[40:43], v24 offset:16384
    ds_read_b64_tr_b16 v[32:33], v176 offset:16384
    ds_read_b64_tr_b16 v[34:35], v176 offset:17408
    s_waitcnt lgkmcnt(5)
    v_mfma_f32_32x32x16_bf16 v[80:95], v[140:143], v[128:131], v[80:95]
    ds_read_b128 v[44:47], v24 offset:20480
    ds_read_b64_tr_b16 v[36:37], v177 offset:16384
    ds_read_b64_tr_b16 v[38:39], v177 offset:17408
    s_waitcnt lgkmcnt(6)
    v_mfma_f32_32x32x16_bf16 v[96:111], v[136:139], v[132:135], v[96:111]
    s_cmp_eq_u32 s53, 0
    s_cselect_b32 s47, 7, 6
    s_add_u32 s47, s47, s64
    s_sub_u32 s46, s47, 10
    s_cselect_b32 s47, s47, s46
    s_lshl_b32 s46, s47, 7
    s_add_u32 s46, s46, s28
    s_mul_i32 s47, s47, 245760
    s_add_u32 m0, s35, 114688
    s_add_u32 s47, s47, s29
    buffer_load_dwordx4 v4, s[12:15], s46 offen lds
    v_mfma_f32_32x32x16_bf16 v[112:127], v[140:143], v[132:135], v[112:127]
    buffer_load_dwordx4 v5, s[12:15], s46 offen offset:1024 lds
    v_mfma_f32_16x16x32_bf16 v[160:163], v[56:59], v[128:131], v[160:163]
    s_waitcnt lgkmcnt(3)
    v_mfma_f32_32x32x16_bf16 v[64:79], v[40:43], v[32:35], v[64:79]
    ds_read_b128 v[136:139], v25 offset:16384
    ds_read_b64_tr_b16 v[128:129], v176 offset:20480
    ds_read_b64_tr_b16 v[130:131], v176 offset:21504
    s_waitcnt lgkmcnt(5)
    v_mfma_f32_32x32x16_bf16 v[80:95], v[44:47], v[32:35], v[80:95]
    ds_read_b128 v[140:143], v25 offset:20480
    ds_read_b64_tr_b16 v[132:133], v177 offset:20480
    ds_read_b64_tr_b16 v[134:135], v177 offset:21504
    s_waitcnt lgkmcnt(6)
    v_mfma_f32_32x32x16_bf16 v[96:111], v[40:43], v[36:39], v[96:111]
    buffer_load_dwordx4 v6, s[12:15], s46 offen offset:2048 lds
    v_mfma_f32_32x32x16_bf16 v[112:127], v[44:47], v[36:39], v[112:127]
    buffer_load_dwordx4 v7, s[12:15], s46 offen offset:3072 lds
    v_mfma_f32_16x16x32_bf16 v[160:163], v[56:59], v[32:35], v[160:163]
    s_waitcnt lgkmcnt(3)
    v_mfma_f32_32x32x16_bf16 v[64:79], v[136:139], v[128:131], v[64:79]
    ds_read_b128 v[40:43], v26 offset:16384
    ds_read_b64_tr_b16 v[32:33], v176 offset:24576
    ds_read_b64_tr_b16 v[34:35], v176 offset:25600
    s_waitcnt lgkmcnt(5)
    v_mfma_f32_32x32x16_bf16 v[80:95], v[140:143], v[128:131], v[80:95]
    ds_read_b128 v[44:47], v26 offset:20480
    ds_read_b64_tr_b16 v[36:37], v177 offset:24576
    ds_read_b64_tr_b16 v[38:39], v177 offset:25600
    s_waitcnt lgkmcnt(6)
    v_mfma_f32_32x32x16_bf16 v[96:111], v[136:139], v[132:135], v[96:111]
    s_add_u32 m0, s35, 49152
    s_nop 0
    buffer_load_dwordx4 v8, s[16:19], s47 offen lds
    v_mfma_f32_32x32x16_bf16 v[112:127], v[140:143], v[132:135], v[112:127]
    buffer_load_dwordx4 v9, s[16:19], s47 offen offset:1024 lds
    v_mfma_f32_16x16x32_bf16 v[160:163], v[56:59], v[128:131], v[160:163]
    s_waitcnt lgkmcnt(3)
    v_mfma_f32_32x32x16_bf16 v[64:79], v[40:43], v[32:35], v[64:79]
    ds_read_b128 v[136:139], v27 offset:16384
    ds_read_b64_tr_b16 v[128:129], v176 offset:28672
    ds_read_b64_tr_b16 v[130:131], v176 offset:29696
    s_waitcnt lgkmcnt(5)
    v_mfma_f32_32x32x16_bf16 v[80:95], v[44:47], v[32:35], v[80:95]
    ds_read_b128 v[140:143], v27 offset:20480
    ds_read_b64_tr_b16 v[132:133], v177 offset:28672
    ds_read_b64_tr_b16 v[134:135], v177 offset:29696
    s_waitcnt lgkmcnt(6)
    v_mfma_f32_32x32x16_bf16 v[96:111], v[40:43], v[36:39], v[96:111]
    buffer_load_dwordx4 v10, s[16:19], s47 offen offset:2048 lds
    v_mfma_f32_32x32x16_bf16 v[112:127], v[44:47], v[36:39], v[112:127]
    buffer_load_dwordx4 v11, s[16:19], s47 offen offset:3072 lds
    v_mfma_f32_16x16x32_bf16 v[160:163], v[56:59], v[32:35], v[160:163]
    s_waitcnt vmcnt(8)
    s_barrier
    s_waitcnt lgkmcnt(3)
    v_mfma_f32_32x32x16_bf16 v[64:79], v[136:139], v[128:131], v[64:79]
    ds_read_b128 v[40:43], v24 offset:32768
    ds_read_b64_tr_b16 v[32:33], v176 offset:32768
    ds_read_b64_tr_b16 v[34:35], v176 offset:33792
    s_waitcnt lgkmcnt(5)
    v_mfma_f32_32x32x16_bf16 v[80:95], v[140:143], v[128:131], v[80:95]
    ds_read_b128 v[44:47], v24 offset:36864
    ds_read_b64_tr_b16 v[36:37], v177 offset:32768
    ds_read_b64_tr_b16 v[38:39], v177 offset:33792
    s_waitcnt lgkmcnt(6)
    v_mfma_f32_32x32x16_bf16 v[96:111], v[136:139], v[132:135], v[96:111]
    s_cmp_eq_u32 s53, 0
    s_cselect_b32 s47, 8, 9
    s_add_u32 s47, s47, s64
    s_sub_u32 s46, s47, 10
    s_cselect_b32 s47, s47, s46
    s_lshl_b32 s46, s47, 7
    s_add_u32 s46, s46, s28
    s_mul_i32 s47, s47, 245760
    s_add_u32 m0, s35, 65536
    s_add_u32 s47, s47, s29
    buffer_load_dwordx4 v4, s[12:15], s46 offen lds
    v_mfma_f32_32x32x16_bf16 v[112:127], v[140:143], v[132:135], v[112:127]
    buffer_load_dwordx4 v5, s[12:15], s46 offen offset:1024 lds
    v_mfma_f32_16x16x32_bf16 v[160:163], v[56:59], v[128:131], v[160:163]
    s_waitcnt lgkmcnt(3)
    v_mfma_f32_32x32x16_bf16 v[64:79], v[40:43], v[32:35], v[64:79]
    ds_read_b128 v[136:139], v25 offset:32768
    ds_read_b64_tr_b16 v[128:129], v176 offset:36864
    ds_read_b64_tr_b16 v[130:131], v176 offset:37888
    s_waitcnt lgkmcnt(5)
    v_mfma_f32_32x32x16_bf16 v[80:95], v[44:47], v[32:35], v[80:95]
    ds_read_b128 v[140:143], v25 offset:36864
    ds_read_b64_tr_b16 v[132:133], v177 offset:36864
    ds_read_b64_tr_b16 v[134:135], v177 offset:37888
    s_waitcnt lgkmcnt(6)
    v_mfma_f32_32x32x16_bf16 v[96:111], v[40:43], v[36:39], v[96:111]
    buffer_load_dwordx4 v6, s[12:15], s46 offen offset:2048 lds
    v_mfma_f32_32x32x16_bf16 v[112:127], v[44:47], v[36:39], v[112:127]
    buffer_load_dwordx4 v7, s[12:15], s46 offen offset:3072 lds
    v_mfma_f32_16x16x32_bf16 v[160:163], v[56:59], v[32:35], v[160:163]
    buffer_load_dword v3, v1, s[20:23], s56 offen sc0 sc1
    s_waitcnt lgkmcnt(3)
    v_mfma_f32_32x32x16_bf16 v[64:79], v[136:139], v[128:131], v[64:79]
    ds_read_b128 v[40:43], v26 offset:32768
    ds_read_b64_tr_b16 v[32:33], v176 offset:40960
    ds_read_b64_tr_b16 v[34:35], v176 offset:41984
    s_waitcnt lgkmcnt(5)
    v_mfma_f32_32x32x16_bf16 v[80:95], v[140:143], v[128:131], v[80:95]
    ds_read_b128 v[44:47], v26 offset:36864
    ds_read_b64_tr_b16 v[36:37], v177 offset:40960
    ds_read_b64_tr_b16 v[38:39], v177 offset:41984
    s_waitcnt lgkmcnt(6)
    v_mfma_f32_32x32x16_bf16 v[96:111], v[136:139], v[132:135], v[96:111]
    s_add_u32 m0, s35, 0
    s_nop 0
    buffer_load_dwordx4 v8, s[16:19], s47 offen lds
    v_mfma_f32_32x32x16_bf16 v[112:127], v[140:143], v[132:135], v[112:127]
    buffer_load_dwordx4 v9, s[16:19], s47 offen offset:1024 lds
    v_mfma_f32_16x16x32_bf16 v[160:163], v[56:59], v[128:131], v[160:163]
    s_waitcnt lgkmcnt(3)
    v_mfma_f32_32x32x16_bf16 v[64:79], v[40:43], v[32:35], v[64:79]
    ds_read_b128 v[136:139], v27 offset:32768
    ds_read_b64_tr_b16 v[128:129], v176 offset:45056
    ds_read_b64_tr_b16 v[130:131], v176 offset:46080
    s_waitcnt lgkmcnt(5)
    v_mfma_f32_32x32x16_bf16 v[80:95], v[44:47], v[32:35], v[80:95]
    ds_read_b128 v[140:143], v27 offset:36864
    ds_read_b64_tr_b16 v[132:133], v177 offset:45056
    ds_read_b64_tr_b16 v[134:135], v177 offset:46080
    s_waitcnt lgkmcnt(6)
    v_mfma_f32_32x32x16_bf16 v[96:111], v[40:43], v[36:39], v[96:111]
    buffer_load_dwordx4 v10, s[16:19], s47 offen offset:2048 lds
    v_mfma_f32_32x32x16_bf16 v[112:127], v[44:47], v[36:39], v[112:127]
    buffer_load_dwordx4 v11, s[16:19], s47 offen offset:3072 lds
    v_mfma_f32_16x16x32_bf16 v[160:163], v[56:59], v[32:35], v[160:163]
    s_waitcnt vmcnt(9)
    s_barrier
    s_waitcnt lgkmcnt(3)
    v_mfma_f32_32x32x16_bf16 v[64:79], v[136:139], v[128:131], v[64:79]
    ds_read_b128 v[40:43], v24 offset:49152
    ds_read_b64_tr_b16 v[32:33], v176 offset:49152
    ds_read_b64_tr_b16 v[34:35], v176 offset:50176
    s_waitcnt lgkmcnt(5)
    v_mfma_f32_32x32x16_bf16 v[80:95], v[140:143], v[128:131], v[80:95]
    ds_read_b128 v[44:47], v24 offset:53248
    ds_read_b64_tr_b16 v[36:37], v177 offset:49152
    ds_read_b64_tr_b16 v[38:39], v177 offset:50176
    s_waitcnt lgkmcnt(6)
    v_mfma_f32_32x32x16_bf16 v[96:111], v[136:139], v[132:135], v[96:111]
    s_cmp_eq_u32 s53, 0
    s_cselect_b32 s47, 9, 8
    s_add_u32 s47, s47, s64
    s_sub_u32 s46, s47, 10
    s_cselect_b32 s47, s47, s46
    s_lshl_b32 s46, s47, 7
    s_add_u32 s46, s46, s28
    s_mul_i32 s47, s47, 245760
    s_add_u32 m0, s35, 81920
    s_add_u32 s47, s47, s29
    buffer_load_dwordx4 v4, s[12:15], s46 offen lds
    v_mfma_f32_32x32x16_bf16 v[112:127], v[140:143], v[132:135], v[112:127]
    buffer_load_dwordx4 v5, s[12:15], s46 offen offset:1024 lds
    v_mfma_f32_16x16x32_bf16 v[160:163], v[56:59], v[128:131], v[160:163]
    s_waitcnt lgkmcnt(3)
    v_mfma_f32_32x32x16_bf16 v[64:79], v[40:43], v[32:35], v[64:79]
    ds_read_b128 v[136:139], v25 offset:49152
    ds_read_b64_tr_b16 v[128:129], v176 offset:53248
    ds_read_b64_tr_b16 v[130:131], v176 offset:54272
    s_waitcnt lgkmcnt(5)
    v_mfma_f32_32x32x16_bf16 v[80:95], v[44:47], v[32:35], v[80:95]
    ds_read_b128 v[140:143], v25 offset:53248
    ds_read_b64_tr_b16 v[132:133], v177 offset:53248
    ds_read_b64_tr_b16 v[134:135], v177 offset:54272
    s_waitcnt lgkmcnt(6)
    v_mfma_f32_32x32x16_bf16 v[96:111], v[40:43], v[36:39], v[96:111]
    buffer_load_dwordx4 v6, s[12:15], s46 offen offset:2048 lds
    v_mfma_f32_32x32x16_bf16 v[112:127], v[44:47], v[36:39], v[112:127]
    buffer_load_dwordx4 v7, s[12:15], s46 offen offset:3072 lds
    v_mfma_f32_16x16x32_bf16 v[160:163], v[56:59], v[32:35], v[160:163]
    s_waitcnt lgkmcnt(3)
    v_mfma_f32_32x32x16_bf16 v[64:79], v[136:139], v[128:131], v[64:79]
    ds_read_b128 v[40:43], v26 offset:49152
    ds_read_b64_tr_b16 v[32:33], v176 offset:57344
    ds_read_b64_tr_b16 v[34:35], v176 offset:58368
    s_waitcnt lgkmcnt(5)
    v_mfma_f32_32x32x16_bf16 v[80:95], v[140:143], v[128:131], v[80:95]
    ds_read_b128 v[44:47], v26 offset:53248
    ds_read_b64_tr_b16 v[36:37], v177 offset:57344
    ds_read_b64_tr_b16 v[38:39], v177 offset:58368
    s_waitcnt lgkmcnt(6)
    v_mfma_f32_32x32x16_bf16 v[96:111], v[136:139], v[132:135], v[96:111]
    s_add_u32 m0, s35, 16384
    s_nop 0
    buffer_load_dwordx4 v8, s[16:19], s47 offen lds
    v_mfma_f32_32x32x16_bf16 v[112:127], v[140:143], v[132:135], v[112:127]
    buffer_load_dwordx4 v9, s[16:19], s47 offen offset:1024 lds
    v_mfma_f32_16x16x32_bf16 v[160:163], v[56:59], v[128:131], v[160:163]
    s_waitcnt vmcnt(10)
    v_readfirstlane_b32 s45, v3
    s_nop 0
    s_cmp_ge_u32 s45, 8
    s_cbranch_scc1 L_vsd
    s_mov_b32 s44, 200000
L_vsl:
    buffer_load_dword v3, v1, s[20:23], s56 offen sc0 sc1
    s_waitcnt vmcnt(0)
    v_readfirstlane_b32 s45, v3
    s_nop 0
    s_cmp_ge_u32 s45, 8
    s_cbranch_scc1 L_vsd
    s_sub_u32 s44, s44, 1
    s_cmp_lg_u32 s44, 0
    s_cbranch_scc1 L_vsl
L_vsd:
    buffer_load_dword v168, v22, s[20:23], s41 offen offset:0 sc1
    buffer_load_dword v170, v22, s[20:23], s41 offen offset:128 sc1
    buffer_load_dwordx4 v[188:191], v23, s[20:23], s42 offen offset:0 sc1
    buffer_load_dwordx4 v[192:195], v23, s[20:23], s42 offen offset:32 sc1
    buffer_load_dwordx4 v[196:199], v23, s[20:23], s42 offen offset:64 sc1
    buffer_load_dwordx4 v[200:203], v23, s[20:23], s42 offen offset:96 sc1
    buffer_load_dwordx4 v[204:207], v23, s[20:23], s42 offen offset:128 sc1
    buffer_load_dwordx4 v[208:211], v23, s[20:23], s42 offen offset:160 sc1
    buffer_load_dwordx4 v[212:215], v23, s[20:23], s42 offen offset:192 sc1
    buffer_load_dwordx4 v[216:219], v23, s[20:23], s42 offen offset:224 sc1
    s_waitcnt lgkmcnt(3)
    v_mfma_f32_32x32x16_bf16 v[64:79], v[40:43], v[32:35], v[64:79]
    ds_read_b128 v[136:139], v27 offset:49152
    ds_read_b64_tr_b16 v[128:129], v176 offset:61440
    ds_read_b64_tr_b16 v[130:131], v176 offset:62464
    s_waitcnt lgkmcnt(5)
    v_mfma_f32_32x32x16_bf16 v[80:95], v[44:47], v[32:35], v[80:95]
    ds_read_b128 v[140:143], v27 offset:53248
    ds_read_b64_tr_b16 v[132:133], v177 offset:61440
    ds_read_b64_tr_b16 v[134:135], v177 offset:62464
    s_waitcnt lgkmcnt(6)
    v_mfma_f32_32x32x16_bf16 v[96:111], v[40:43], v[36:39], v[96:111]
    buffer_load_dwordx4 v10, s[16:19], s47 offen offset:2048 lds
    v_mfma_f32_32x32x16_bf16 v[112:127], v[44:47], v[36:39], v[112:127]
    buffer_load_dwordx4 v11, s[16:19], s47 offen offset:3072 lds
    v_mfma_f32_16x16x32_bf16 v[160:163], v[56:59], v[32:35], v[160:163]
    s_waitcnt vmcnt(18)
    s_barrier
    s_waitcnt lgkmcnt(3)
    v_mfma_f32_32x32x16_bf16 v[64:79], v[136:139], v[128:131], v[64:79]
    ds_read_b128 v[40:43], v24 offset:0
    ds_read_b64_tr_b16 v[32:33], v176 offset:0
    ds_read_b64_tr_b16 v[34:35], v176 offset:1024
    s_waitcnt lgkmcnt(5)
    v_mfma_f32_32x32x16_bf16 v[80:95], v[140:143], v[128:131], v[80:95]
    ds_read_b128 v[44:47], v24 offset:4096
    ds_read_b64_tr_b16 v[36:37], v177 offset:0
    ds_read_b64_tr_b16 v[38:39], v177 offset:1024
    s_waitcnt lgkmcnt(6)
    v_mfma_f32_32x32x16_bf16 v[96:111], v[136:139], v[132:135], v[96:111]
    v_mfma_f32_32x32x16_bf16 v[112:127], v[140:143], v[132:135], v[112:127]
    v_mfma_f32_16x16x32_bf16 v[160:163], v[56:59], v[128:131], v[160:163]
    s_waitcnt lgkmcnt(3)
    v_mfma_f32_32x32x16_bf16 v[64:79], v[40:43], v[32:35], v[64:79]
    ds_read_b128 v[136:139], v25 offset:0
    ds_read_b64_tr_b16 v[128:129], v176 offset:4096
    ds_read_b64_tr_b16 v[130:131], v176 offset:5120
    s_waitcnt lgkmcnt(5)
    v_mfma_f32_32x32x16_bf16 v[80:95], v[44:47], v[32:35], v[80:95]
    ds_read_b128 v[140:143], v25 offset:4096
    ds_read_b64_tr_b16 v[132:133], v177 offset:4096
    ds_read_b64_tr_b16 v[134:135], v177 offset:5120
    s_waitcnt lgkmcnt(6)
    v_mfma_f32_32x32x16_bf16 v[96:111], v[40:43], v[36:39], v[96:111]
    v_mfma_f32_32x32x16_bf16 v[112:127], v[44:47], v[36:39], v[112:127]
    v_mfma_f32_16x16x32_bf16 v[160:163], v[56:59], v[32:35], v[160:163]
    s_waitcnt lgkmcnt(3)
    v_mfma_f32_32x32x16_bf16 v[64:79], v[136:139], v[128:131], v[64:79]
    ds_read_b128 v[40:43], v26 offset:0
    ds_read_b64_tr_b16 v[32:33], v176 offset:8192
    ds_read_b64_tr_b16 v[34:35], v176 offset:9216
    s_waitcnt lgkmcnt(5)
    v_mfma_f32_32x32x16_bf16 v[80:95], v[140:143], v[128:131], v[80:95]
    ds_read_b128 v[44:47], v26 offset:4096
    ds_read_b64_tr_b16 v[36:37], v177 offset:8192
    ds_read_b64_tr_b16 v[38:39], v177 offset:9216
    s_waitcnt lgkmcnt(6)
    v_mfma_f32_32x32x16_bf16 v[96:111], v[136:139], v[132:135], v[96:111]
    v_mfma_f32_32x32x16_bf16 v[112:127], v[140:143], v[132:135], v[112:127]
    v_mfma_f32_16x16x32_bf16 v[160:163], v[56:59], v[128:131], v[160:163]
    s_waitcnt lgkmcnt(3)
    v_mfma_f32_32x32x16_bf16 v[64:79], v[40:43], v[32:35], v[64:79]
    ds_read_b128 v[136:139], v27 offset:0
    ds_read_b64_tr_b16 v[128:129], v176 offset:12288
    ds_read_b64_tr_b16 v[130:131], v176 offset:13312
    s_waitcnt lgkmcnt(5)
    v_mfma_f32_32x32x16_bf16 v[80:95], v[44:47], v[32:35], v[80:95]
    ds_read_b128 v[140:143], v27 offset:4096
    ds_read_b64_tr_b16 v[132:133], v177 offset:12288
    ds_read_b64_tr_b16 v[134:135], v177 offset:13312
    s_waitcnt lgkmcnt(6)
    v_mfma_f32_32x32x16_bf16 v[96:111], v[40:43], v[36:39], v[96:111]
    v_mfma_f32_32x32x16_bf16 v[112:127], v[44:47], v[36:39], v[112:127]
    v_mfma_f32_16x16x32_bf16 v[160:163], v[56:59], v[32:35], v[160:163]
    s_waitcnt vmcnt(0)
    s_barrier
    s_waitcnt lgkmcnt(3)
    v_mfma_f32_32x32x16_bf16 v[64:79], v[136:139], v[128:131], v[64:79]
    ds_read_b64_tr_b16 a[0:1], v176 offset:16384
    ds_read_b64_tr_b16 a[2:3], v176 offset:17408
    ds_read_b128 a[16:19], v24 offset:16384
    s_waitcnt lgkmcnt(5)
    v_mfma_f32_32x32x16_bf16 v[80:95], v[140:143], v[128:131], v[80:95]
    ds_read_b128 a[32:35], v24 offset:20480
    ds_read_b64_tr_b16 a[4:5], v176 offset:20480
    ds_read_b64_tr_b16 a[6:7], v176 offset:21504
    s_waitcnt lgkmcnt(6)
    v_mfma_f32_32x32x16_bf16 v[96:111], v[136:139], v[132:135], v[96:111]
    ds_read_b64_tr_b16 a[8:9], v176 offset:24576
    ds_read_b64_tr_b16 a[10:11], v176 offset:25600
    ds_read_b64_tr_b16 a[12:13], v176 offset:28672
    v_mfma_f32_32x32x16_bf16 v[112:127], v[140:143], v[132:135], v[112:127]
    v_mfma_f32_16x16x32_bf16 v[160:163], v[56:59], v[128:131], v[160:163]
    ds_read_b64_tr_b16 a[14:15], v176 offset:29696
    ds_read_b128 a[20:23], v25 offset:16384
    ds_read_b128 a[36:39], v25 offset:20480
    s_waitcnt lgkmcnt(9)
    v_mfma_f32_32x32x16_bf16 v[64:79], a[16:19], a[0:3], v[64:79]
    ds_read_b128 a[24:27], v26 offset:16384
    ds_read_b128 a[40:43], v26 offset:20480
    ds_read_b128 a[28:31], v27 offset:16384
    v_mfma_f32_16x16x32_bf16 v[160:163], v[56:59], a[0:3], v[160:163]
    s_waitcnt lgkmcnt(11)
    v_mfma_f32_32x32x16_bf16 v[80:95], a[32:35], a[0:3], v[80:95]
    ds_read_b128 a[44:47], v27 offset:20480
    ds_read_b64_tr_b16 a[48:49], v177 offset:16384
    ds_read_b64_tr_b16 a[50:51], v177 offset:17408
    s_waitcnt lgkmcnt(12)
    v_mfma_f32_16x16x32_bf16 v[160:163], v[56:59], a[4:7], v[160:163]
    s_waitcnt lgkmcnt(7)
    v_mfma_f32_32x32x16_bf16 v[64:79], a[20:23], a[4:7], v[64:79]
    ds_read_b64_tr_b16 a[52:53], v177 offset:20480
    ds_read_b64_tr_b16 a[54:55], v177 offset:21504
    ds_read_b64_tr_b16 a[56:57], v177 offset:24576
    v_mfma_f32_16x16x32_bf16 v[160:163], v[56:59], a[8:11], v[160:163]
    s_waitcnt lgkmcnt(9)
    v_mfma_f32_32x32x16_bf16 v[80:95], a[36:39], a[4:7], v[80:95]
    ds_read_b64_tr_b16 a[58:59], v177 offset:25600
    ds_read_b64_tr_b16 a[60:61], v177 offset:28672
    ds_read_b64_tr_b16 a[62:63], v177 offset:29696
    v_mfma_f32_16x16x32_bf16 v[160:163], v[56:59], a[12:15], v[160:163]
    s_waitcnt lgkmcnt(11)
    v_mfma_f32_32x32x16_bf16 v[64:79], a[24:27], a[8:11], v[64:79]
    v_cmp_eq_u32 vcc, 0, v12
    s_nop 1
    v_cndmask_b32 v168, 0, v168, vcc
    v_cndmask_b32 v170, 0, v170, vcc
    s_waitcnt lgkmcnt(10)
    v_mfma_f32_32x32x16_bf16 v[80:95], a[40:43], a[8:11], v[80:95]
    v_cvt_pk_bf16_f32 v161, v160, v160
    v_and_b32 v161, 0xffff0000, v161
    v_sub_f32 v160, v160, v161
    v_cvt_pk_bf16_f32 v160, v161, v160
    s_waitcnt lgkmcnt(9)
    v_mfma_f32_32x32x16_bf16 v[64:79], a[28:31], a[12:15], v[64:79]
    ds_write_b32 v21, v160
    v_mov_b32 v161, 0
    s_waitcnt lgkmcnt(9)
    v_mfma_f32_32x32x16_bf16 v[80:95], a[44:47], a[12:15], v[80:95]
    v_mfma_f32_32x32x8_bf16 v[64:79], v[168:169], v[160:161], v[64:79]
    v_mfma_f32_32x32x8_bf16 v[80:95], v[170:171], v[160:161], v[80:95]
    s_waitcnt lgkmcnt(7)
    v_mfma_f32_32x32x16_bf16 v[96:111], a[16:19], a[48:51], v[96:111]
    s_waitcnt lgkmcnt(0)
    s_barrier
    ds_read_b32 v164, v20
    v_mfma_f32_32x32x16_bf16 v[112:127], a[32:35], a[48:51], v[112:127]
    s_nop 4
    v_mul_f32 v64, v188, v64
    v_mul_f32 v65, v189, v65
    v_mul_f32 v66, v190, v66
    v_mul_f32 v67, v191, v67
    v_mul_f32 v68, v192, v68
    v_mul_f32 v69, v193, v69
    v_mul_f32 v70, v194, v70
    v_mul_f32 v71, v195, v71
    v_mfma_f32_32x32x16_bf16 v[96:111], a[20:23], a[52:55], v[96:111]
    v_cvt_pk_bf16_f32 v64, v64, v65
    v_cvt_pk_bf16_f32 v65, v66, v67
    v_cvt_pk_bf16_f32 v66, v68, v69
    v_cvt_pk_bf16_f32 v67, v70, v71
    buffer_store_dwordx4 v[64:67], v19, s[20:23], s60 offen offset:0 sc1
    v_mul_f32 v72, v196, v72
    v_mul_f32 v73, v197, v73
    v_mul_f32 v74, v198, v74
    v_mfma_f32_32x32x16_bf16 v[112:127], a[36:39], a[52:55], v[112:127]
    v_mul_f32 v75, v199, v75
    v_mul_f32 v76, v200, v76
    v_mul_f32 v77, v201, v77
    v_mul_f32 v78, v202, v78
    v_mul_f32 v79, v203, v79
    v_cvt_pk_bf16_f32 v72, v72, v73
    v_cvt_pk_bf16_f32 v73, v74, v75
    v_cvt_pk_bf16_f32 v74, v76, v77
    v_mfma_f32_32x32x16_bf16 v[96:111], a[24:27], a[56:59], v[96:111]
    v_cvt_pk_bf16_f32 v75, v78, v79
    buffer_store_dwordx4 v[72:75], v19, s[20:23], s60 offen offset:1024 sc1
    v_mul_f32 v80, v204, v80
    v_mul_f32 v81, v205, v81
    v_mul_f32 v82, v206, v82
    v_mul_f32 v83, v207, v83
    v_mul_f32 v84, v208, v84
    v_mul_f32 v85, v209, v85
    v_mfma_f32_32x32x16_bf16 v[112:127], a[40:43], a[56:59], v[112:127]
    v_mul_f32 v86, v210, v86
    v_mul_f32 v87, v211, v87
    v_cvt_pk_bf16_f32 v80, v80, v81
    v_cvt_pk_bf16_f32 v81, v82, v83
    v_cvt_pk_bf16_f32 v82, v84, v85
    v_cvt_pk_bf16_f32 v83, v86, v87
    buffer_store_dwordx4 v[80:83], v19, s[20:23], s60 offen offset:2048 sc1
    v_mul_f32 v88, v212, v88
    v_mfma_f32_32x32x16_bf16 v[96:111], a[28:31], a[60:63], v[96:111]
    v_mul_f32 v89, v213, v89
    v_mul_f32 v90, v214, v90
    v_mul_f32 v91, v215, v91
    v_mul_f32 v92, v216, v92
    v_mul_f32 v93, v217, v93
    v_mul_f32 v94, v218, v94
    v_mul_f32 v95, v219, v95
    v_cvt_pk_bf16_f32 v88, v88, v89
    v_mfma_f32_32x32x16_bf16 v[112:127], a[44:47], a[60:63], v[112:127]
    v_cvt_pk_bf16_f32 v89, v90, v91
    v_cvt_pk_bf16_f32 v90, v92, v93
    v_cvt_pk_bf16_f32 v91, v94, v95
    buffer_store_dwordx4 v[88:91], v19, s[20:23], s60 offen offset:3072 sc1
    s_waitcnt lgkmcnt(0)
    v_mfma_f32_32x32x8_bf16 v[96:111], v[168:169], v[164:165], v[96:111]
    v_mfma_f32_32x32x8_bf16 v[112:127], v[170:171], v[164:165], v[112:127]
    s_nop 10
    v_pk_mul_f32 v[96:97], v[96:97], v[188:189]
    v_pk_mul_f32 v[98:99], v[98:99], v[190:191]
    v_pk_mul_f32 v[100:101], v[100:101], v[192:193]
    v_pk_mul_f32 v[102:103], v[102:103], v[194:195]
    v_cvt_pk_bf16_f32 v96, v96, v97
    v_cvt_pk_bf16_f32 v97, v98, v99
    v_cvt_pk_bf16_f32 v98, v100, v101
    v_cvt_pk_bf16_f32 v99, v102, v103
    buffer_store_dwordx4 v[96:99], v19, s[20:23], s61 offen offset:0 sc1
    v_pk_mul_f32 v[104:105], v[104:105], v[196:197]
    v_pk_mul_f32 v[106:107], v[106:107], v[198:199]
    v_pk_mul_f32 v[108:109], v[108:109], v[200:201]
    v_pk_mul_f32 v[110:111], v[110:111], v[202:203]
    v_cvt_pk_bf16_f32 v104, v104, v105
    v_cvt_pk_bf16_f32 v105, v106, v107
    v_cvt_pk_bf16_f32 v106, v108, v109
    v_cvt_pk_bf16_f32 v107, v110, v111
    buffer_store_dwordx4 v[104:107], v19, s[20:23], s61 offen offset:1024 sc1
    v_pk_mul_f32 v[112:113], v[112:113], v[204:205]
    v_pk_mul_f32 v[114:115], v[114:115], v[206:207]
    v_pk_mul_f32 v[116:117], v[116:117], v[208:209]
    v_pk_mul_f32 v[118:119], v[118:119], v[210:211]
    v_cvt_pk_bf16_f32 v112, v112, v113
    v_cvt_pk_bf16_f32 v113, v114, v115
    v_cvt_pk_bf16_f32 v114, v116, v117
    v_cvt_pk_bf16_f32 v115, v118, v119
    buffer_store_dwordx4 v[112:115], v19, s[20:23], s61 offen offset:2048 sc1
    v_pk_mul_f32 v[120:121], v[120:121], v[212:213]
    v_pk_mul_f32 v[122:123], v[122:123], v[214:215]
    v_pk_mul_f32 v[124:125], v[124:125], v[216:217]
    v_pk_mul_f32 v[126:127], v[126:127], v[218:219]
    v_cvt_pk_bf16_f32 v120, v120, v121
    v_cvt_pk_bf16_f32 v121, v122, v123
    v_cvt_pk_bf16_f32 v122, v124, v125
    v_cvt_pk_bf16_f32 v123, v126, v127
    buffer_store_dwordx4 v[120:123], v19, s[20:23], s61 offen offset:3072 sc1
L_qdone:
    s_mul_i32 s40, s26, 205
    s_lshr_b32 s40, s40, 10
    s_mul_i32 s41, s40, 5
    s_sub_u32 s41, s26, s41
    s_mul_i32 s42, s41, 1639
    s_lshr_b32 s42, s42, 10
    s_mul_i32 s41, s41, 128
    s_add_u32 s41, s41, 127
    v_lshrrev_b32 v19, 4, v2
    v_add_u32 v19, s42, v19
    v_mul_u32_u24 v20, 80, v19
    s_lshl_b32 s40, s40, 3
    v_add_u32 v19, s40, v19
    v_cmp_ge_u32 vcc, s41, v20
    v_and_b32 v20, 15, v2
    v_lshl_add_u32 v19, v19, 4, v20
    v_lshlrev_b32 v19, 7, v19
    v_mov_b32 v20, 0x2000000
    v_cndmask_b32 v19, v20, v19, vcc
    s_mov_b32 s43, 27172864
    s_cmp_lt_u32 s26, 15
    s_cselect_b32 s43, s43, 0x2000000
    s_mov_b32 s71, 0
L_att:
    s_load_dwordx2 s[4:5], s[0:1], 16
    s_load_dwordx4 s[48:51], s[0:1], 32
    s_load_dwordx4 s[72:75], s[0:1], 48
    s_load_dwordx2 s[76:77], s[0:1], 0
    s_and_b32 s32, s31, 3
    s_lshl_b32 s25, s30, 2
    s_add_u32 s25, s25, s32
    s_lshr_b32 s26, s31, 2
    s_lshl_b32 s27, s26, 2
    s_add_u32 s27, s27, s24
    v_lshlrev_b32 v5, 4, v2
    v_lshrrev_b32 v6, 5, v2
    v_and_b32 v7, 31, v2
    s_lshr_b32 s33, s25, 1
    s_mul_i32 s33, s33, 5
    s_and_b32 s34, s25, 1
    s_mul_i32 s36, s34, 3
    s_add_u32 s36, s36, s33
    s_lshl_b32 s36, s36, 15
    s_add_u32 s37, s33, 2
    s_lshl_b32 s37, s37, 15
    s_lshl_b32 s34, s34, 3
    s_add_u32 s37, s37, s34
    s_lshl_b32 s38, s27, 10
    s_add_u32 s33, s36, s38
    s_add_u32 s34, s37, s38
    s_lshl_b32 s38, s24, 13
    s_add_u32 s38, s38, 2621440
    s_add_u32 s36, s36, s38
    s_add_u32 s37, s37, s38
    s_lshl_b32 s38, s24, 15
    s_add_u32 s38, s38, 5242880
    v_lshlrev_b32 v12, 4, v7
    v_lshl_add_u32 v9, v6, 15, v12
    s_sub_u32 s39, 27361280, s37
    v_mov_b32 v13, s39
    v_cmp_eq_u32 vcc, 0, v6
    s_nop 1
    v_cndmask_b32 v10, v13, v12, vcc
    s_mul_i32 s39, s25, 20
    v_add_u32 v13, s39, v7
    v_and_b32 v11, 31, v13
    v_lshlrev_b32 v11, 4, v11
    v_lshl_add_u32 v11, v6, 9, v11
    v_lshrrev_b32 v13, 5, v13
    v_lshl_add_u32 v11, v13, 17, v11
    s_sub_u32 s39, 27369472, s38
    v_mov_b32 v13, s39
    v_cmp_gt_u32 vcc, 20, v7
    s_nop 1
    v_cndmask_b32 v11, v13, v11, vcc
    v_mov_b32 v13, 0x2000000
    v_cmp_gt_u32 vcc, 21, v7
    s_nop 1
    v_cndmask_b32 v11, v13, v11, vcc
    v_mov_b32 v1, 0
    v_lshlrev_b32 v18, 14, v2
    v_lshlrev_b32 v3, 7, v2
    s_mul_i32 s39, s30, 80
    s_add_u32 s40, s39, 79
    s_lshr_b32 s39, s39, 7
    s_lshr_b32 s40, s40, 7
    s_cmp_eq_u32 s39, s40
    s_cselect_b32 s79, 16, 32
    s_cmp_eq_u32 s24, 0
    s_cselect_b32 s43, s43, 0x2000000
    v_mov_b32 v8, 1
    s_lshr_b32 s82, s31, 1
    s_lshl4_add_u32 s82, s30, s82
    s_lshl_b32 s82, s82, 7
    s_add_u32 s82, s82, 27172864
    s_cmp_eq_u32 s24, 0
    s_cselect_b32 s82, s82, 0x2000000
    v_mov_b32 v4, 0
    s_waitcnt vmcnt(0)
    s_barrier
    buffer_atomic_add v8, v19, s[20:23], s43 offen sc1
    s_mov_b64 exec, 7
    buffer_atomic_add v4, v18, s[20:23], s82 offen sc0 sc1
    s_mov_b64 exec, -1
    s_lshl_b32 s52, s2, 2
    s_add_u32 s52, s52, s24
    s_sub_u32 s53, s52, 204
    s_cmp_ge_u32 s52, 820
    s_cselect_b32 s52, s53, s52
    s_cselect_b32 s95, 0x2000000, 0
    v_and_b32 v13, 3, v2
    v_bfe_u32 v14, v2, 2, 2
    v_bfe_u32 v15, v2, 4, 1
    v_lshl_add_u32 v14, v6, 2, v14
    v_lshlrev_b32 v14, 7, v14
    s_lshl_b32 s54, s24, 13
    s_add_u32 s54, s54, 0
    v_add_u32 v14, s54, v14
    v_lshrrev_b32 v16, 3, v2
    v_and_b32 v17, 7, v2
    v_lshlrev_b32 v17, 4, v17
    s_cmp_ge_u32 s52, 480
    s_cbranch_scc1 L_rp_wd
    s_mul_i32 s55, s52, 2731
    s_lshr_b32 s55, s55, 16
    s_mul_i32 s56, s55, 24
    s_sub_u32 s56, s52, s56
    s_waitcnt lgkmcnt(0)
    s_mov_b32 s12, s48
    s_mov_b32 s13, s49
    s_mov_b32 s14, 1966080
    s_mov_b32 s15, 0x00020000
    s_mov_b32 s16, s50
    s_mov_b32 s17, s51
    s_mov_b32 s18, 1966080
    s_mov_b32 s19, 0x00020000
    s_mul_i32 s57, s55, 98304
    s_lshl_b32 s58, s56, 7
    s_add_u32 s57, s57, s58
    s_mov_b32 s58, s57
    s_mov_b32 s59, 49152
    v_and_b32 v124, 4, v16
    v_add_u32 v124, v124, v16
    v_mul_u32_u24 v124, 3072, v124
    v_add_u32 v124, v124, v17
    v_add_u32 v125, 11264, v124
    v_lshrrev_b32 v16, 1, v13
    v_lshl_add_u32 v14, v16, 11, v14
    v_lshl_add_u32 v14, v15, 4, v14
    v_and_b32 v16, 1, v13
    v_lshl_add_u32 v116, v16, 3, v14
    v_add_u32 v117, 32, v116
    v_add_u32 v118, 64, v116
    v_add_u32 v119, 96, v116
    s_lshl_b32 s64, s56, 2
    s_add_u32 s64, s64, 0
    s_mul_i32 s65, s64, 43
    s_lshr_b32 s65, s65, 8
    s_mul_i32 s66, s65, 6
    s_sub_u32 s66, s64, s66
    s_cmp_lt_u32 s66, 4
    s_movk_i32 s60, 2048
    s_cselect_b32 s60, 4096, s60
    s_cselect_b32 s67, 0, 159744
    s_mul_i32 s65, s65, 245760
    s_lshl_b32 s66, s66, 10
    s_add_u32 s65, s65, s66
    s_add_u32 s65, s65, s67
    s_mul_i32 s66, s55, s60
    s_lshl_b32 s66, s66, 1
    s_add_u32 s65, s65, s66
    s_add_u32 s65, s65, 23232512
    v_add_u32 v120, s65, v5
    s_lshl_b32 s64, s56, 2
    s_add_u32 s64, s64, 1
    s_mul_i32 s65, s64, 43
    s_lshr_b32 s65, s65, 8
    s_mul_i32 s66, s65, 6
    s_sub_u32 s66, s64, s66
    s_cmp_lt_u32 s66, 4
    s_movk_i32 s61, 2048
    s_cselect_b32 s61, 4096, s61
    s_cselect_b32 s67, 0, 159744
    s_mul_i32 s65, s65, 245760
    s_lshl_b32 s66, s66, 10
    s_add_u32 s65, s65, s66
    s_add_u32 s65, s65, s67
    s_mul_i32 s66, s55, s61
    s_lshl_b32 s66, s66, 1
    s_add_u32 s65, s65, s66
    s_add_u32 s65, s65, 23232512
    v_add_u32 v121, s65, v5
    s_lshl_b32 s64, s56, 2
    s_add_u32 s64, s64, 2
    s_mul_i32 s65, s64, 43
    s_lshr_b32 s65, s65, 8
    s_mul_i32 s66, s65, 6
    s_sub_u32 s66, s64, s66
    s_cmp_lt_u32 s66, 4
    s_movk_i32 s62, 2048
    s_cselect_b32 s62, 4096, s62
    s_cselect_b32 s67, 0, 159744
    s_mul_i32 s65, s65, 245760
    s_lshl_b32 s66, s66, 10
    s_add_u32 s65, s65, s66
    s_add_u32 s65, s65, s67
    s_mul_i32 s66, s55, s62
    s_lshl_b32 s66, s66, 1
    s_add_u32 s65, s65, s66
    s_add_u32 s65, s65, 23232512
    v_add_u32 v122, s65, v5
    s_lshl_b32 s64, s56, 2
    s_add_u32 s64, s64, 3
    s_mul_i32 s65, s64, 43
    s_lshr_b32 s65, s65, 8
    s_mul_i32 s66, s65, 6
    s_sub_u32 s66, s64, s66
    s_cmp_lt_u32 s66, 4
    s_movk_i32 s63, 2048
    s_cselect_b32 s63, 4096, s63
    s_cselect_b32 s67, 0, 159744
    s_mul_i32 s65, s65, 245760
    s_lshl_b32 s66, s66, 10
    s_add_u32 s65, s65, s66
    s_add_u32 s65, s65, s67
    s_mul_i32 s66, s55, s63
    s_lshl_b32 s66, s66, 1
    s_add_u32 s65, s65, s66
    s_add_u32 s65, s65, 23232512
    v_add_u32 v123, s65, v5
    s_mul_i32 s70, s56, 20
    s_add_u32 s70, s70, s55
    s_lshl_b32 s70, s70, 9
    s_add_u32 s70, s70, 27418624
    s_branch L_rp_go
L_rp_wd:
    s_sub_u32 s52, s52, 480
    s_sub_u32 s55, s52, 100
    s_cmp_ge_u32 s52, 100
    s_cselect_b32 s52, s55, s52
    s_waitcnt lgkmcnt(0)
    s_cselect_b32 s12, s72, s4
    s_cselect_b32 s13, s73, s5
    s_mov_b32 s14, 819200
    s_mov_b32 s64, 102400
    s_mov_b32 s65, 20447232
    s_mov_b32 s59, 409600
    s_mov_b32 s60, 51200
    s_cselect_b32 s14, 1966080, s14
    s_cselect_b32 s64, 245760, s64
    s_cselect_b32 s65, 21266432, s65
    s_cselect_b32 s59, 20480, s59
    s_cselect_b32 s60, 2560, s60
    s_cselect_b32 s66, 1, 0
    s_mov_b32 s15, 0x00020000
    s_mov_b32 s16, s12
    s_mov_b32 s17, s13
    s_mov_b32 s18, s14
    s_mov_b32 s19, 0x00020000
    s_mov_b32 s61, s60
    s_mov_b32 s62, s60
    s_mov_b32 s63, s60
    s_mul_i32 s55, s52, 205
    s_lshr_b32 s55, s55, 10
    s_mul_i32 s56, s55, 5
    s_sub_u32 s56, s52, s56
    s_mul_i32 s67, s55, 205
    s_lshr_b32 s67, s67, 10
    s_mul_i32 s68, s67, 5
    s_sub_u32 s68, s55, s68
    s_mul_i32 s69, s68, 20
    s_cmp_eq_u32 s68, 4
    s_cselect_b32 s69, 16, s69
    s_cselect_b32 s70, 20, 4
    s_mul_i32 s67, s67, 80
    s_add_u32 s67, s67, s69
    s_lshr_b32 s68, s55, 1
    s_mul_i32 s68, s68, 6
    s_and_b32 s69, s55, 1
    s_lshl_b32 s69, s69, 1
    s_add_u32 s68, s68, s69
    s_mul_i32 s69, s55, 6
    s_sub_u32 s69, s69, 188
    s_cmp_ge_u32 s55, 32
    s_cselect_b32 s68, s69, s68
    s_lshl_b32 s68, s68, 4
    s_lshl_b32 s55, s55, s66
    s_cmp_eq_u32 s66, 1
    s_cselect_b32 s67, s68, s67
    s_cselect_b32 s70, 4, s70
    s_mul_i32 s57, s67, 1280
    s_lshl_b32 s58, s56, 8
    s_add_u32 s57, s57, s58
    s_add_u32 s58, s57, 128
    s_mul_i32 s70, s70, 1280
    v_lshrrev_b32 v124, 2, v16
    v_mul_lo_u32 v124, v124, s70
    v_and_b32 v16, 3, v16
    v_mul_u32_u24 v16, 1280, v16
    v_add3_u32 v124, v124, v16, v17
    s_lshl_b32 s70, s70, 1
    s_sub_u32 s70, s70, 1024
    v_add_u32 v125, s70, v124
    v_lshl_add_u32 v14, v15, 5, v14
    v_bfrev_b32 v13, v13
    v_lshrrev_b32 v13, 30, v13
    v_lshl_add_u32 v116, v13, 3, v14
    v_add_u32 v117, 64, v116
    v_add_u32 v118, 2048, v116
    v_add_u32 v119, 2112, v116
    s_mul_i32 s67, s55, 2560
    s_add_u32 s65, s65, s67
    s_lshl_b32 s67, s56, 3
    v_add_u32 v13, s67, v15
    v_and_b32 v16, 15, v2
    v_lshlrev_b32 v16, 4, v16
    v_lshl_add_u32 v16, v6, 8, v16
    s_add_u32 s65, s65, s95
    s_add_u32 s57, s57, s95
    s_add_u32 s58, s58, s95
    v_add_u32 v16, s65, v16
    v_add_u32 v14, 0, v13
    v_mul_u32_u24 v15, 205, v14
    v_lshrrev_b32 v15, 10, v15
    v_mul_u32_u24 v17, 5, v15
    v_sub_u32 v17, v14, v17
    v_lshl_add_u32 v17, v17, 9, v16
    v_mad_u32_u24 v120, v15, s64, v17
    v_add_u32 v14, 2, v13
    v_mul_u32_u24 v15, 205, v14
    v_lshrrev_b32 v15, 10, v15
    v_mul_u32_u24 v17, 5, v15
    v_sub_u32 v17, v14, v17
    v_lshl_add_u32 v17, v17, 9, v16
    v_mad_u32_u24 v121, v15, s64, v17
    v_add_u32 v14, 4, v13
    v_mul_u32_u24 v15, 205, v14
    v_lshrrev_b32 v15, 10, v15
    v_mul_u32_u24 v17, 5, v15
    v_sub_u32 v17, v14, v17
    v_lshl_add_u32 v17, v17, 9, v16
    v_mad_u32_u24 v122, v15, s64, v17
    v_add_u32 v14, 6, v13
    v_mul_u32_u24 v15, 205, v14
    v_lshrrev_b32 v15, 10, v15
    v_mul_u32_u24 v17, 5, v15
    v_sub_u32 v17, v14, v17
    v_lshl_add_u32 v17, v17, 9, v16
    v_mad_u32_u24 v123, v15, s64, v17
    s_mov_b32 s70, 0x2000000
L_rp_go:
    s_mov_b32 s44, 200000
    s_cmp_lg_u32 s24, 0
    s_cbranch_scc1 L_rpw
    s_waitcnt vmcnt(0)
    v_cmp_le_u32 vcc, s79, v4
    s_nop 0
    s_cmp_eq_u64 vcc, 7
    s_cbranch_scc1 L_rpd
    s_mov_b64 exec, 7
    v_mov_b32 v8, 0
    buffer_atomic_add v8, v18, s[20:23], s82 offen sc0 sc1
    s_mov_b64 exec, -1
    s_mov_b64 exec, 7
    s_mov_b32 s44, 200000
L_pp1:
    s_waitcnt vmcnt(0)
    v_cmp_le_u32 vcc, s79, v8
    s_nop 0
    s_cmp_eq_u64 vcc, 7
    s_cbranch_scc1 L_pq1
    v_mov_b32 v8, 0
    buffer_atomic_add v8, v18, s[20:23], s82 offen sc0 sc1
    s_sub_u32 s44, s44, 1
    s_cmp_lg_u32 s44, 0
    s_cbranch_scc1 L_pp1
L_pq1:
    s_mov_b64 exec, -1
    s_branch L_rpd
L_rpw:
    s_cmp_lg_u32 s24, 1
    s_cbranch_scc1 L_wa0
L_wa0:
    s_cmp_lg_u32 s24, 2
    s_cbranch_scc1 L_wa1
L_wa1:
    s_cmp_lg_u32 s24, 3
    s_cbranch_scc1 L_wa2
L_wa2:
L_rpd:
    s_barrier
    buffer_load_dwordx4 v[104:107], v9, s[20:23], s33 offen sc1
    buffer_load_dwordx2 v[112:113], v12, s[20:23], s34 offen sc1
    buffer_load_dwordx4 a[0:3], v9, s[20:23], s36 offen offset:0 sc1
    buffer_load_dwordx2 a[64:65], v10, s[20:23], s37 offen offset:0 sc1
    buffer_load_dwordx4 v[108:111], v9, s[20:23], s33 offen offset:512 sc1
    buffer_load_dwordx2 v[114:115], v12, s[20:23], s34 offen offset:512 sc1
    buffer_load_dwordx4 a[96:99], v11, s[20:23], s38 offen offset:0 sc1
    buffer_load_dwordx4 a[100:103], v11, s[20:23], s38 offen offset:1024 sc1
    buffer_load_dwordx4 a[4:7], v9, s[20:23], s36 offen offset:512 sc1
    buffer_load_dwordx2 a[66:67], v10, s[20:23], s37 offen offset:512 sc1
    buffer_load_dwordx4 a[104:107], v11, s[20:23], s38 offen offset:2048 sc1
    buffer_load_dwordx4 a[108:111], v11, s[20:23], s38 offen offset:3072 sc1
    v_and_b32 v21, 7, v2
    v_lshlrev_b32 v21, 8, v21
    v_mov_b32 v22, 1
    v_lshlrev_b32 v23, 25, v2
    v_lshlrev_b32 v25, 7, v2
    s_add_u32 s64, s24, 0
    s_and_b32 s64, s64, 3
    s_mul_i32 s40, s64, 6144
    s_add_u32 s40, s40, 102400
    v_add_u32 v248, s40, v5
    s_mul_i32 s40, s64, 3072
    s_add_u32 s40, s40, 151552
    v_add_u32 v252, s40, v5
    s_add_u32 s65, s24, 1
    s_and_b32 s65, s65, 3
    s_mul_i32 s40, s65, 6144
    s_add_u32 s40, s40, 102400
    v_add_u32 v249, s40, v5
    s_mul_i32 s40, s65, 3072
    s_add_u32 s40, s40, 151552
    v_add_u32 v253, s40, v5
    s_add_u32 s66, s24, 2
    s_and_b32 s66, s66, 3
    s_mul_i32 s40, s66, 6144
    s_add_u32 s40, s40, 102400
    v_add_u32 v250, s40, v5
    s_mul_i32 s40, s66, 3072
    s_add_u32 s40, s40, 151552
    v_add_u32 v254, s40, v5
    s_add_u32 s67, s24, 3
    s_and_b32 s67, s67, 3
    s_mul_i32 s40, s67, 6144
    s_add_u32 s40, s40, 102400
    v_add_u32 v251, s40, v5
    s_mul_i32 s40, s67, 3072
    s_add_u32 s40, s40, 151552
    v_add_u32 v255, s40, v5
    v_lshrrev_b32 v13, 2, v2
    v_xor_b32 v13, v13, v2
    v_and_b32 v13, 4, v13
    v_and_b32 v14, 3, v2
    v_or_b32 v13, v13, v14
    v_mov_b32 v14, 1065369472
    v_cmp_eq_u32 vcc, 0, v13
    s_nop 1
    v_cndmask_b32 v228, 0, v14, vcc
    v_mov_b32 v229, v228
    v_mov_b32 v230, v228
    v_mov_b32 v231, v228
    v_cmp_eq_u32 vcc, 1, v13
    s_nop 1
    v_cndmask_b32 v232, 0, v14, vcc
    v_mov_b32 v233, v232
    v_mov_b32 v234, v232
    v_mov_b32 v235, v232
    v_cmp_eq_u32 vcc, 2, v13
    s_nop 1
    v_cndmask_b32 v236, 0, v14, vcc
    v_mov_b32 v237, v236
    v_mov_b32 v238, v236
    v_mov_b32 v239, v236
    v_cmp_eq_u32 vcc, 3, v13
    s_nop 1
    v_cndmask_b32 v240, 0, v14, vcc
    v_mov_b32 v241, v240
    v_mov_b32 v242, v240
    v_mov_b32 v243, v240
    v_lshl_add_u32 v27, v6, 25, v12
    v_mul_u32_u24 v30, 1280, v7
    v_lshl_add_u32 v30, v6, 4, v30
    v_lshl_add_u32 v29, v6, 2, v12
    v_and_b32 v26, 3, v2
    v_mul_u32_u24 v26, 6144, v26
    v_add_u32 v26, 102400, v26
    v_mul_u32_u24 v28, 10240, v6
    v_add_u32 v28, v28, v12
    v_cmp_eq_u32 vcc, 0, v6
    s_waitcnt vmcnt(10)
    s_nop 0
    v_cndmask_b32 v112, 0, v112, vcc
    v_cndmask_b32 v113, 0, v113, vcc
    s_waitcnt vmcnt(6)
    v_cndmask_b32 v114, 0, v114, vcc
    v_cndmask_b32 v115, 0, v115, vcc
    v_mfma_f32_32x32x16_bf16 v[32:47], a[0:3], v[104:107], 0
    v_mfma_f32_32x32x8_bf16 v[32:47], a[64:65], v[112:113], v[32:47]
    v_mfma_f32_32x32x16_bf16 v[48:63], a[0:3], v[108:111], 0
    v_mfma_f32_32x32x8_bf16 v[48:63], a[64:65], v[114:115], v[48:63]
    buffer_load_dwordx4 a[8:11], v9, s[20:23], s36 offen offset:1024 sc1
    buffer_load_dwordx2 a[68:69], v10, s[20:23], s37 offen offset:1024 sc1
    s_add_u32 s38, s38, 4096
    buffer_load_dwordx4 a[112:115], v11, s[20:23], s38 offen offset:0 sc1
    buffer_load_dwordx4 a[116:119], v11, s[20:23], s38 offen offset:1024 sc1
    buffer_load_dwordx4 a[12:15], v9, s[20:23], s36 offen offset:1536 sc1
    buffer_load_dwordx2 a[70:71], v10, s[20:23], s37 offen offset:1536 sc1
    buffer_load_dwordx4 a[120:123], v11, s[20:23], s38 offen offset:2048 sc1
    buffer_load_dwordx4 a[124:127], v11, s[20:23], s38 offen offset:3072 sc1
    s_cmp_eq_u32 s71, 0
    s_cselect_b64 s[68:69], -1, 0
    s_or_b64 s[92:93], s[68:69], vcc
    v_max3_f32 v14, v32, v33, v34
    v_max3_f32 v16, v35, v36, v37
    v_max3_f32 v14, v14, v38, v39
    v_max3_f32 v16, v16, v40, v41
    v_max3_f32 v14, v14, v42, v43
    v_max3_f32 v16, v16, v44, v45
    v_max3_f32 v14, v14, v46, v47
    v_max_f32 v14, v14, v16
    v_cvt_pk_bf16_f32 v14, -v14, 0
    v_cndmask_b32 v14, v212, v14, s[68:69]
    v_cndmask_b32 v112, v14, v112, vcc
    v_cndmask_b32 v113, v213, v113, s[92:93]
    v_mfma_f32_32x32x16_bf16 v[32:47], a[0:3], v[104:107], 0
    s_nop 0
    v_mfma_f32_32x32x8_bf16 v[32:47], a[64:65], v[112:113], v[32:47]
    v_max3_f32 v15, v48, v49, v50
    v_max3_f32 v16, v51, v52, v53
    v_max3_f32 v15, v15, v54, v55
    v_max3_f32 v16, v16, v56, v57
    v_max3_f32 v15, v15, v58, v59
    v_max3_f32 v16, v16, v60, v61
    v_max3_f32 v15, v15, v62, v63
    v_max_f32 v15, v15, v16
    v_cvt_pk_bf16_f32 v15, -v15, 0
    v_cndmask_b32 v15, v214, v15, s[68:69]
    v_cndmask_b32 v114, v15, v114, vcc
    v_cndmask_b32 v115, v215, v115, s[92:93]
    v_exp_f32 v32, v32
    v_exp_f32 v33, v33
    v_exp_f32 v34, v34
    v_exp_f32 v35, v35
    v_mfma_f32_32x32x16_bf16 v[48:63], a[0:3], v[108:111], 0
    buffer_load_dwordx4 a[16:19], v9, s[20:23], s36 offen offset:2048 sc1
    v_exp_f32 v36, v36
    v_exp_f32 v37, v37
    v_exp_f32 v38, v38
    v_exp_f32 v39, v39
    v_cvt_pk_bf16_f32 v96, v32, v33
    v_cvt_pk_bf16_f32 v97, v34, v35
    v_mfma_f32_32x32x8_bf16 v[48:63], a[64:65], v[114:115], v[48:63]
    v_exp_f32 v40, v40
    v_exp_f32 v41, v41
    v_exp_f32 v42, v42
    v_exp_f32 v43, v43
    v_cvt_pk_bf16_f32 v98, v36, v37
    v_cvt_pk_bf16_f32 v99, v38, v39
    buffer_load_dwordx2 a[72:73], v10, s[20:23], s37 offen offset:2048 sc1
    v_exp_f32 v44, v44
    v_exp_f32 v45, v45
    v_exp_f32 v46, v46
    v_exp_f32 v47, v47
    v_cvt_pk_bf16_f32 v100, v40, v41
    v_cvt_pk_bf16_f32 v101, v42, v43
    s_waitcnt vmcnt(15)
    v_mfma_f32_32x32x16_bf16 v[64:79], a[96:99], v[96:99], 0
    s_waitcnt vmcnt(10)
    v_exp_f32 v48, v48
    v_exp_f32 v49, v49
    v_exp_f32 v50, v50
    v_exp_f32 v51, v51
    v_cvt_pk_bf16_f32 v102, v44, v45
    v_cvt_pk_bf16_f32 v103, v46, v47
    v_mfma_f32_32x32x16_bf16 v[32:47], a[4:7], v[104:107], 0
    s_add_u32 s38, s38, 4096
    v_exp_f32 v52, v52
    v_exp_f32 v53, v53
    v_exp_f32 v54, v54
    v_exp_f32 v55, v55
    v_cvt_pk_bf16_f32 v96, v48, v49
    v_cvt_pk_bf16_f32 v97, v50, v51
    v_mfma_f32_32x32x8_bf16 v[32:47], a[66:67], v[112:113], v[32:47]
    v_exp_f32 v56, v56
    v_exp_f32 v57, v57
    v_exp_f32 v58, v58
    v_exp_f32 v59, v59
    v_cvt_pk_bf16_f32 v98, v52, v53
    v_cvt_pk_bf16_f32 v99, v54, v55
    v_mfma_f32_32x32x16_bf16 v[64:79], a[100:103], v[100:103], v[64:79]
    buffer_load_dwordx4 a[128:131], v11, s[20:23], s38 offen offset:0 sc1
    v_exp_f32 v60, v60
    v_exp_f32 v61, v61
    v_exp_f32 v62, v62
    v_exp_f32 v63, v63
    v_cvt_pk_bf16_f32 v100, v56, v57
    v_cvt_pk_bf16_f32 v101, v58, v59
    v_mfma_f32_32x32x16_bf16 v[80:95], a[96:99], v[96:99], 0
    buffer_load_dwordx4 a[132:135], v11, s[20:23], s38 offen offset:1024 sc1
    v_exp_f32 v32, v32
    v_exp_f32 v33, v33
    v_exp_f32 v34, v34
    v_exp_f32 v35, v35
    v_cvt_pk_bf16_f32 v102, v60, v61
    v_cvt_pk_bf16_f32 v103, v62, v63
    v_mfma_f32_32x32x16_bf16 v[48:63], a[4:7], v[108:111], 0
    buffer_load_dwordx4 a[20:23], v9, s[20:23], s36 offen offset:2560 sc1
    v_exp_f32 v36, v36
    v_exp_f32 v37, v37
    v_exp_f32 v38, v38
    v_exp_f32 v39, v39
    v_cvt_pk_bf16_f32 v96, v32, v33
    v_cvt_pk_bf16_f32 v97, v34, v35
    v_mfma_f32_32x32x8_bf16 v[48:63], a[66:67], v[114:115], v[48:63]
    v_exp_f32 v40, v40
    v_exp_f32 v41, v41
    v_exp_f32 v42, v42
    v_exp_f32 v43, v43
    v_cvt_pk_bf16_f32 v98, v36, v37
    v_cvt_pk_bf16_f32 v99, v38, v39
    v_mfma_f32_32x32x16_bf16 v[80:95], a[100:103], v[100:103], v[80:95]
    buffer_load_dwordx2 a[74:75], v10, s[20:23], s37 offen offset:2560 sc1
    v_exp_f32 v44, v44
    v_exp_f32 v45, v45
    v_exp_f32 v46, v46
    v_exp_f32 v47, v47
    v_cvt_pk_bf16_f32 v100, v40, v41
    v_cvt_pk_bf16_f32 v101, v42, v43
    v_mfma_f32_32x32x16_bf16 v[64:79], a[104:107], v[96:99], v[64:79]
    s_waitcnt vmcnt(10)
    v_exp_f32 v48, v48
    v_exp_f32 v49, v49
    v_exp_f32 v50, v50
    v_exp_f32 v51, v51
    v_cvt_pk_bf16_f32 v102, v44, v45
    v_cvt_pk_bf16_f32 v103, v46, v47
    v_mfma_f32_32x32x16_bf16 v[32:47], a[8:11], v[104:107], 0
    buffer_load_dwordx4 a[136:139], v11, s[20:23], s38 offen offset:2048 sc1
    v_exp_f32 v52, v52
    v_exp_f32 v53, v53
    v_exp_f32 v54, v54
    v_exp_f32 v55, v55
    v_cvt_pk_bf16_f32 v96, v48, v49
    v_cvt_pk_bf16_f32 v97, v50, v51
    v_mfma_f32_32x32x8_bf16 v[32:47], a[68:69], v[112:113], v[32:47]
    v_exp_f32 v56, v56
    v_exp_f32 v57, v57
    v_exp_f32 v58, v58
    v_exp_f32 v59, v59
    v_cvt_pk_bf16_f32 v98, v52, v53
    v_cvt_pk_bf16_f32 v99, v54, v55
    v_mfma_f32_32x32x16_bf16 v[64:79], a[108:111], v[100:103], v[64:79]
    buffer_load_dwordx4 a[140:143], v11, s[20:23], s38 offen offset:3072 sc1
    v_exp_f32 v60, v60
    v_exp_f32 v61, v61
    v_exp_f32 v62, v62
    v_exp_f32 v63, v63
    v_cvt_pk_bf16_f32 v100, v56, v57
    v_cvt_pk_bf16_f32 v101, v58, v59
    v_mfma_f32_32x32x16_bf16 v[80:95], a[104:107], v[96:99], v[80:95]
    buffer_load_dwordx4 a[24:27], v9, s[20:23], s36 offen offset:3072 sc1
    v_exp_f32 v32, v32
    v_exp_f32 v33, v33
    v_exp_f32 v34, v34
    v_exp_f32 v35, v35
    v_cvt_pk_bf16_f32 v102, v60, v61
    v_cvt_pk_bf16_f32 v103, v62, v63
    v_mfma_f32_32x32x16_bf16 v[48:63], a[8:11], v[108:111], 0
    buffer_load_dwordx2 a[76:77], v10, s[20:23], s37 offen offset:3072 sc1
    v_exp_f32 v36, v36
    v_exp_f32 v37, v37
    v_exp_f32 v38, v38
    v_exp_f32 v39, v39
    v_cvt_pk_bf16_f32 v96, v32, v33
    v_cvt_pk_bf16_f32 v97, v34, v35
    v_mfma_f32_32x32x8_bf16 v[48:63], a[68:69], v[114:115], v[48:63]
    v_exp_f32 v40, v40
    v_exp_f32 v41, v41
    v_exp_f32 v42, v42
    v_exp_f32 v43, v43
    v_cvt_pk_bf16_f32 v98, v36, v37
    v_cvt_pk_bf16_f32 v99, v38, v39
    v_mfma_f32_32x32x16_bf16 v[80:95], a[108:111], v[100:103], v[80:95]
    s_add_u32 s38, s38, 4096
    v_exp_f32 v44, v44
    v_exp_f32 v45, v45
    v_exp_f32 v46, v46
    v_exp_f32 v47, v47
    v_cvt_pk_bf16_f32 v100, v40, v41
    v_cvt_pk_bf16_f32 v101, v42, v43
    v_mfma_f32_32x32x16_bf16 v[64:79], a[112:115], v[96:99], v[64:79]
    s_waitcnt vmcnt(10)
    v_exp_f32 v48, v48
    v_exp_f32 v49, v49
    v_exp_f32 v50, v50
    v_exp_f32 v51, v51
    v_cvt_pk_bf16_f32 v102, v44, v45
    v_cvt_pk_bf16_f32 v103, v46, v47
    v_mfma_f32_32x32x16_bf16 v[32:47], a[12:15], v[104:107], 0
    buffer_load_dwordx4 a[144:147], v11, s[20:23], s38 offen offset:0 sc1
    v_exp_f32 v52, v52
    v_exp_f32 v53, v53
    v_exp_f32 v54, v54
    v_exp_f32 v55, v55
    v_cvt_pk_bf16_f32 v96, v48, v49
    v_cvt_pk_bf16_f32 v97, v50, v51
    v_mfma_f32_32x32x8_bf16 v[32:47], a[70:71], v[112:113], v[32:47]
    v_exp_f32 v56, v56
    v_exp_f32 v57, v57
    v_exp_f32 v58, v58
    v_exp_f32 v59, v59
    v_cvt_pk_bf16_f32 v98, v52, v53
    v_cvt_pk_bf16_f32 v99, v54, v55
    v_mfma_f32_32x32x16_bf16 v[64:79], a[116:119], v[100:103], v[64:79]
    buffer_load_dwordx4 a[148:151], v11, s[20:23], s38 offen offset:1024 sc1
    v_exp_f32 v60, v60
    v_exp_f32 v61, v61
    v_exp_f32 v62, v62
    v_exp_f32 v63, v63
    v_cvt_pk_bf16_f32 v100, v56, v57
    v_cvt_pk_bf16_f32 v101, v58, v59
    v_mfma_f32_32x32x16_bf16 v[80:95], a[112:115], v[96:99], v[80:95]
    buffer_load_dwordx4 a[28:31], v9, s[20:23], s36 offen offset:3584 sc1
    v_exp_f32 v32, v32
    v_exp_f32 v33, v33
    v_exp_f32 v34, v34
    v_exp_f32 v35, v35
    v_cvt_pk_bf16_f32 v102, v60, v61
    v_cvt_pk_bf16_f32 v103, v62, v63
    v_mfma_f32_32x32x16_bf16 v[48:63], a[12:15], v[108:111], 0
    buffer_load_dwordx2 a[78:79], v10, s[20:23], s37 offen offset:3584 sc1
    v_exp_f32 v36, v36
    v_exp_f32 v37, v37
    v_exp_f32 v38, v38
    v_exp_f32 v39, v39
    v_cvt_pk_bf16_f32 v96, v32, v33
    v_cvt_pk_bf16_f32 v97, v34, v35
    v_mfma_f32_32x32x8_bf16 v[48:63], a[70:71], v[114:115], v[48:63]
    v_exp_f32 v40, v40
    v_exp_f32 v41, v41
    v_exp_f32 v42, v42
    v_exp_f32 v43, v43
    v_cvt_pk_bf16_f32 v98, v36, v37
    v_cvt_pk_bf16_f32 v99, v38, v39
    v_mfma_f32_32x32x16_bf16 v[80:95], a[116:119], v[100:103], v[80:95]
    buffer_load_dwordx4 a[152:155], v11, s[20:23], s38 offen offset:2048 sc1
    v_exp_f32 v44, v44
    v_exp_f32 v45, v45
    v_exp_f32 v46, v46
    v_exp_f32 v47, v47
    v_cvt_pk_bf16_f32 v100, v40, v41
    v_cvt_pk_bf16_f32 v101, v42, v43
    v_mfma_f32_32x32x16_bf16 v[64:79], a[120:123], v[96:99], v[64:79]
    s_waitcnt vmcnt(11)
    v_exp_f32 v48, v48
    v_exp_f32 v49, v49
    v_exp_f32 v50, v50
    v_exp_f32 v51, v51
    v_cvt_pk_bf16_f32 v102, v44, v45
    v_cvt_pk_bf16_f32 v103, v46, v47
    v_mfma_f32_32x32x16_bf16 v[32:47], a[16:19], v[104:107], 0
    buffer_load_dwordx4 a[156:159], v11, s[20:23], s38 offen offset:3072 sc1
    v_exp_f32 v52, v52
    v_exp_f32 v53, v53
    v_exp_f32 v54, v54
    v_exp_f32 v55, v55
    v_cvt_pk_bf16_f32 v96, v48, v49
    v_cvt_pk_bf16_f32 v97, v50, v51
    v_mfma_f32_32x32x8_bf16 v[32:47], a[72:73], v[112:113], v[32:47]
    v_exp_f32 v56, v56
    v_exp_f32 v57, v57
    v_exp_f32 v58, v58
    v_exp_f32 v59, v59
    v_cvt_pk_bf16_f32 v98, v52, v53
    v_cvt_pk_bf16_f32 v99, v54, v55
    v_mfma_f32_32x32x16_bf16 v[64:79], a[124:127], v[100:103], v[64:79]
    s_add_u32 s36, s36, 4096
    v_exp_f32 v60, v60
    v_exp_f32 v61, v61
    v_exp_f32 v62, v62
    v_exp_f32 v63, v63
    v_cvt_pk_bf16_f32 v100, v56, v57
    v_cvt_pk_bf16_f32 v101, v58, v59
    v_mfma_f32_32x32x16_bf16 v[80:95], a[120:123], v[96:99], v[80:95]
    s_add_u32 s37, s37, 4096
    v_exp_f32 v32, v32
    v_exp_f32 v33, v33
    v_exp_f32 v34, v34
    v_exp_f32 v35, v35
    v_cvt_pk_bf16_f32 v102, v60, v61
    v_cvt_pk_bf16_f32 v103, v62, v63
    v_mfma_f32_32x32x16_bf16 v[48:63], a[16:19], v[108:111], 0
    buffer_load_dwordx4 a[32:35], v9, s[20:23], s36 offen offset:0 sc1
    v_exp_f32 v36, v36
    v_exp_f32 v37, v37
    v_exp_f32 v38, v38
    v_exp_f32 v39, v39
    v_cvt_pk_bf16_f32 v96, v32, v33
    v_cvt_pk_bf16_f32 v97, v34, v35
    v_mfma_f32_32x32x8_bf16 v[48:63], a[72:73], v[114:115], v[48:63]
    v_exp_f32 v40, v40
    v_exp_f32 v41, v41
    v_exp_f32 v42, v42
    v_exp_f32 v43, v43
    v_cvt_pk_bf16_f32 v98, v36, v37
    v_cvt_pk_bf16_f32 v99, v38, v39
    v_mfma_f32_32x32x16_bf16 v[80:95], a[124:127], v[100:103], v[80:95]
    buffer_load_dwordx2 a[80:81], v10, s[20:23], s37 offen offset:0 sc1
    v_exp_f32 v44, v44
    v_exp_f32 v45, v45
    v_exp_f32 v46, v46
    v_exp_f32 v47, v47
    v_cvt_pk_bf16_f32 v100, v40, v41
    v_cvt_pk_bf16_f32 v101, v42, v43
    v_mfma_f32_32x32x16_bf16 v[64:79], a[128:131], v[96:99], v[64:79]
    s_waitcnt vmcnt(10)
    v_exp_f32 v48, v48
    v_exp_f32 v49, v49
    v_exp_f32 v50, v50
    v_exp_f32 v51, v51
    v_cvt_pk_bf16_f32 v102, v44, v45
    v_cvt_pk_bf16_f32 v103, v46, v47
    v_mfma_f32_32x32x16_bf16 v[32:47], a[20:23], v[104:107], 0
    s_add_u32 s38, s38, 4096
    v_exp_f32 v52, v52
    v_exp_f32 v53, v53
    v_exp_f32 v54, v54
    v_exp_f32 v55, v55
    v_cvt_pk_bf16_f32 v96, v48, v49
    v_cvt_pk_bf16_f32 v97, v50, v51
    v_mfma_f32_32x32x8_bf16 v[32:47], a[74:75], v[112:113], v[32:47]
    v_exp_f32 v56, v56
    v_exp_f32 v57, v57
    v_exp_f32 v58, v58
    v_exp_f32 v59, v59
    v_cvt_pk_bf16_f32 v98, v52, v53
    v_cvt_pk_bf16_f32 v99, v54, v55
    v_mfma_f32_32x32x16_bf16 v[64:79], a[132:135], v[100:103], v[64:79]
    buffer_load_dwordx4 a[160:163], v11, s[20:23], s38 offen offset:0 sc1
    v_exp_f32 v60, v60
    v_exp_f32 v61, v61
    v_exp_f32 v62, v62
    v_exp_f32 v63, v63
    v_cvt_pk_bf16_f32 v100, v56, v57
    v_cvt_pk_bf16_f32 v101, v58, v59
    v_mfma_f32_32x32x16_bf16 v[80:95], a[128:131], v[96:99], v[80:95]
    buffer_load_dwordx4 a[164:167], v11, s[20:23], s38 offen offset:1024 sc1
    v_exp_f32 v32, v32
    v_exp_f32 v33, v33
    v_exp_f32 v34, v34
    v_exp_f32 v35, v35
    v_cvt_pk_bf16_f32 v102, v60, v61
    v_cvt_pk_bf16_f32 v103, v62, v63
    v_mfma_f32_32x32x16_bf16 v[48:63], a[20:23], v[108:111], 0
    buffer_load_dwordx4 a[36:39], v9, s[20:23], s36 offen offset:512 sc1
    v_exp_f32 v36, v36
    v_exp_f32 v37, v37
    v_exp_f32 v38, v38
    v_exp_f32 v39, v39
    v_cvt_pk_bf16_f32 v96, v32, v33
    v_cvt_pk_bf16_f32 v97, v34, v35
    v_mfma_f32_32x32x8_bf16 v[48:63], a[74:75], v[114:115], v[48:63]
    v_exp_f32 v40, v40
    v_exp_f32 v41, v41
    v_exp_f32 v42, v42
    v_exp_f32 v43, v43
    v_cvt_pk_bf16_f32 v98, v36, v37
    v_cvt_pk_bf16_f32 v99, v38, v39
    v_mfma_f32_32x32x16_bf16 v[80:95], a[132:135], v[100:103], v[80:95]
    buffer_load_dwordx2 a[82:83], v10, s[20:23], s37 offen offset:512 sc1
    v_exp_f32 v44, v44
    v_exp_f32 v45, v45
    v_exp_f32 v46, v46
    v_exp_f32 v47, v47
    v_cvt_pk_bf16_f32 v100, v40, v41
    v_cvt_pk_bf16_f32 v101, v42, v43
    v_mfma_f32_32x32x16_bf16 v[64:79], a[136:139], v[96:99], v[64:79]
    s_waitcnt vmcnt(10)
    v_exp_f32 v48, v48
    v_exp_f32 v49, v49
    v_exp_f32 v50, v50
    v_exp_f32 v51, v51
    v_cvt_pk_bf16_f32 v102, v44, v45
    v_cvt_pk_bf16_f32 v103, v46, v47
    v_mfma_f32_32x32x16_bf16 v[32:47], a[24:27], v[104:107], 0
    buffer_load_dwordx4 a[168:171], v11, s[20:23], s38 offen offset:2048 sc1
    v_exp_f32 v52, v52
    v_exp_f32 v53, v53
    v_exp_f32 v54, v54
    v_exp_f32 v55, v55
    v_cvt_pk_bf16_f32 v96, v48, v49
    v_cvt_pk_bf16_f32 v97, v50, v51
    v_mfma_f32_32x32x8_bf16 v[32:47], a[76:77], v[112:113], v[32:47]
    v_exp_f32 v56, v56
    v_exp_f32 v57, v57
    v_exp_f32 v58, v58
    v_exp_f32 v59, v59
    v_cvt_pk_bf16_f32 v98, v52, v53
    v_cvt_pk_bf16_f32 v99, v54, v55
    v_mfma_f32_32x32x16_bf16 v[64:79], a[140:143], v[100:103], v[64:79]
    buffer_load_dwordx4 a[172:175], v11, s[20:23], s38 offen offset:3072 sc1
    v_exp_f32 v60, v60
    v_exp_f32 v61, v61
    v_exp_f32 v62, v62
    v_exp_f32 v63, v63
    v_cvt_pk_bf16_f32 v100, v56, v57
    v_cvt_pk_bf16_f32 v101, v58, v59
    v_mfma_f32_32x32x16_bf16 v[80:95], a[136:139], v[96:99], v[80:95]
    buffer_load_dwordx4 a[40:43], v9, s[20:23], s36 offen offset:1024 sc1
    v_exp_f32 v32, v32
    v_exp_f32 v33, v33
    v_exp_f32 v34, v34
    v_exp_f32 v35, v35
    v_cvt_pk_bf16_f32 v102, v60, v61
    v_cvt_pk_bf16_f32 v103, v62, v63
    v_mfma_f32_32x32x16_bf16 v[48:63], a[24:27], v[108:111], 0
    buffer_load_dwordx2 a[84:85], v10, s[20:23], s37 offen offset:1024 sc1
    v_exp_f32 v36, v36
    v_exp_f32 v37, v37
    v_exp_f32 v38, v38
    v_exp_f32 v39, v39
    v_cvt_pk_bf16_f32 v96, v32, v33
    v_cvt_pk_bf16_f32 v97, v34, v35
    v_mfma_f32_32x32x8_bf16 v[48:63], a[76:77], v[114:115], v[48:63]
    v_exp_f32 v40, v40
    v_exp_f32 v41, v41
    v_exp_f32 v42, v42
    v_exp_f32 v43, v43
    v_cvt_pk_bf16_f32 v98, v36, v37
    v_cvt_pk_bf16_f32 v99, v38, v39
    v_mfma_f32_32x32x16_bf16 v[80:95], a[140:143], v[100:103], v[80:95]
    s_add_u32 s38, s38, 4096
    v_exp_f32 v44, v44
    v_exp_f32 v45, v45
    v_exp_f32 v46, v46
    v_exp_f32 v47, v47
    v_cvt_pk_bf16_f32 v100, v40, v41
    v_cvt_pk_bf16_f32 v101, v42, v43
    v_mfma_f32_32x32x16_bf16 v[64:79], a[144:147], v[96:99], v[64:79]
    s_waitcnt vmcnt(10)
    v_exp_f32 v48, v48
    v_exp_f32 v49, v49
    v_exp_f32 v50, v50
    v_exp_f32 v51, v51
    v_cvt_pk_bf16_f32 v102, v44, v45
    v_cvt_pk_bf16_f32 v103, v46, v47
    v_mfma_f32_32x32x16_bf16 v[32:47], a[28:31], v[104:107], 0
    buffer_load_dwordx4 a[176:179], v11, s[20:23], s38 offen offset:0 sc1
    v_exp_f32 v52, v52
    v_exp_f32 v53, v53
    v_exp_f32 v54, v54
    v_exp_f32 v55, v55
    v_cvt_pk_bf16_f32 v96, v48, v49
    v_cvt_pk_bf16_f32 v97, v50, v51
    v_mfma_f32_32x32x8_bf16 v[32:47], a[78:79], v[112:113], v[32:47]
    v_exp_f32 v56, v56
    v_exp_f32 v57, v57
    v_exp_f32 v58, v58
    v_exp_f32 v59, v59
    v_cvt_pk_bf16_f32 v98, v52, v53
    v_cvt_pk_bf16_f32 v99, v54, v55
    v_mfma_f32_32x32x16_bf16 v[64:79], a[148:151], v[100:103], v[64:79]
    buffer_load_dwordx4 a[180:183], v11, s[20:23], s38 offen offset:1024 sc1
    v_exp_f32 v60, v60
    v_exp_f32 v61, v61
    v_exp_f32 v62, v62
    v_exp_f32 v63, v63
    v_cvt_pk_bf16_f32 v100, v56, v57
    v_cvt_pk_bf16_f32 v101, v58, v59
    v_mfma_f32_32x32x16_bf16 v[80:95], a[144:147], v[96:99], v[80:95]
    buffer_load_dwordx4 a[44:47], v9, s[20:23], s36 offen offset:1536 sc1
    v_exp_f32 v32, v32
    v_exp_f32 v33, v33
    v_exp_f32 v34, v34
    v_exp_f32 v35, v35
    v_cvt_pk_bf16_f32 v102, v60, v61
    v_cvt_pk_bf16_f32 v103, v62, v63
    v_mfma_f32_32x32x16_bf16 v[48:63], a[28:31], v[108:111], 0
    buffer_load_dwordx2 a[86:87], v10, s[20:23], s37 offen offset:1536 sc1
    v_exp_f32 v36, v36
    v_exp_f32 v37, v37
    v_exp_f32 v38, v38
    v_exp_f32 v39, v39
    v_cvt_pk_bf16_f32 v96, v32, v33
    v_cvt_pk_bf16_f32 v97, v34, v35
    v_mfma_f32_32x32x8_bf16 v[48:63], a[78:79], v[114:115], v[48:63]
    v_exp_f32 v40, v40
    v_exp_f32 v41, v41
    v_exp_f32 v42, v42
    v_exp_f32 v43, v43
    v_cvt_pk_bf16_f32 v98, v36, v37
    v_cvt_pk_bf16_f32 v99, v38, v39
    v_mfma_f32_32x32x16_bf16 v[80:95], a[148:151], v[100:103], v[80:95]
    buffer_load_dwordx4 a[184:187], v11, s[20:23], s38 offen offset:2048 sc1
    v_exp_f32 v44, v44
    v_exp_f32 v45, v45
    v_exp_f32 v46, v46
    v_exp_f32 v47, v47
    v_cvt_pk_bf16_f32 v100, v40, v41
    v_cvt_pk_bf16_f32 v101, v42, v43
    v_mfma_f32_32x32x16_bf16 v[64:79], a[152:155], v[96:99], v[64:79]
    s_waitcnt vmcnt(11)
    v_exp_f32 v48, v48
    v_exp_f32 v49, v49
    v_exp_f32 v50, v50
    v_exp_f32 v51, v51
    v_cvt_pk_bf16_f32 v102, v44, v45
    v_cvt_pk_bf16_f32 v103, v46, v47
    v_mfma_f32_32x32x16_bf16 v[32:47], a[32:35], v[104:107], 0
    buffer_load_dwordx4 a[188:191], v11, s[20:23], s38 offen offset:3072 sc1
    v_exp_f32 v52, v52
    v_exp_f32 v53, v53
    v_exp_f32 v54, v54
    v_exp_f32 v55, v55
    v_cvt_pk_bf16_f32 v96, v48, v49
    v_cvt_pk_bf16_f32 v97, v50, v51
    v_mfma_f32_32x32x8_bf16 v[32:47], a[80:81], v[112:113], v[32:47]
    v_exp_f32 v56, v56
    v_exp_f32 v57, v57
    v_exp_f32 v58, v58
    v_exp_f32 v59, v59
    v_cvt_pk_bf16_f32 v98, v52, v53
    v_cvt_pk_bf16_f32 v99, v54, v55
    v_mfma_f32_32x32x16_bf16 v[64:79], a[156:159], v[100:103], v[64:79]
    buffer_load_dwordx4 a[48:51], v9, s[20:23], s36 offen offset:2048 sc1
    v_exp_f32 v60, v60
    v_exp_f32 v61, v61
    v_exp_f32 v62, v62
    v_exp_f32 v63, v63
    v_cvt_pk_bf16_f32 v100, v56, v57
    v_cvt_pk_bf16_f32 v101, v58, v59
    v_mfma_f32_32x32x16_bf16 v[80:95], a[152:155], v[96:99], v[80:95]
    buffer_load_dwordx2 a[88:89], v10, s[20:23], s37 offen offset:2048 sc1
    v_exp_f32 v32, v32
    v_exp_f32 v33, v33
    v_exp_f32 v34, v34
    v_exp_f32 v35, v35
    v_cvt_pk_bf16_f32 v102, v60, v61
    v_cvt_pk_bf16_f32 v103, v62, v63
    v_mfma_f32_32x32x16_bf16 v[48:63], a[32:35], v[108:111], 0
    s_add_u32 s38, s38, 4096
    v_exp_f32 v36, v36
    v_exp_f32 v37, v37
    v_exp_f32 v38, v38
    v_exp_f32 v39, v39
    v_cvt_pk_bf16_f32 v96, v32, v33
    v_cvt_pk_bf16_f32 v97, v34, v35
    v_mfma_f32_32x32x8_bf16 v[48:63], a[80:81], v[114:115], v[48:63]
    v_exp_f32 v40, v40
    v_exp_f32 v41, v41
    v_exp_f32 v42, v42
    v_exp_f32 v43, v43
    v_cvt_pk_bf16_f32 v98, v36, v37
    v_cvt_pk_bf16_f32 v99, v38, v39
    v_mfma_f32_32x32x16_bf16 v[80:95], a[156:159], v[100:103], v[80:95]
    buffer_load_dwordx4 a[192:195], v11, s[20:23], s38 offen offset:0 sc1
    v_exp_f32 v44, v44
    v_exp_f32 v45, v45
    v_exp_f32 v46, v46
    v_exp_f32 v47, v47
    v_cvt_pk_bf16_f32 v100, v40, v41
    v_cvt_pk_bf16_f32 v101, v42, v43
    v_mfma_f32_32x32x16_bf16 v[64:79], a[160:163], v[96:99], v[64:79]
    s_waitcnt vmcnt(11)
    v_exp_f32 v48, v48
    v_exp_f32 v49, v49
    v_exp_f32 v50, v50
    v_exp_f32 v51, v51
    v_cvt_pk_bf16_f32 v102, v44, v45
    v_cvt_pk_bf16_f32 v103, v46, v47
    v_mfma_f32_32x32x16_bf16 v[32:47], a[36:39], v[104:107], 0
    buffer_load_dwordx4 a[196:199], v11, s[20:23], s38 offen offset:1024 sc1
    v_exp_f32 v52, v52
    v_exp_f32 v53, v53
    v_exp_f32 v54, v54
    v_exp_f32 v55, v55
    v_cvt_pk_bf16_f32 v96, v48, v49
    v_cvt_pk_bf16_f32 v97, v50, v51
    v_mfma_f32_32x32x8_bf16 v[32:47], a[82:83], v[112:113], v[32:47]
    v_exp_f32 v56, v56
    v_exp_f32 v57, v57
    v_exp_f32 v58, v58
    v_exp_f32 v59, v59
    v_cvt_pk_bf16_f32 v98, v52, v53
    v_cvt_pk_bf16_f32 v99, v54, v55
    v_mfma_f32_32x32x16_bf16 v[64:79], a[164:167], v[100:103], v[64:79]
    buffer_load_dwordx4 a[52:55], v9, s[20:23], s36 offen offset:2560 sc1
    v_exp_f32 v60, v60
    v_exp_f32 v61, v61
    v_exp_f32 v62, v62
    v_exp_f32 v63, v63
    v_cvt_pk_bf16_f32 v100, v56, v57
    v_cvt_pk_bf16_f32 v101, v58, v59
    v_mfma_f32_32x32x16_bf16 v[80:95], a[160:163], v[96:99], v[80:95]
    buffer_load_dwordx2 a[90:91], v10, s[20:23], s37 offen offset:2560 sc1
    v_exp_f32 v32, v32
    v_exp_f32 v33, v33
    v_exp_f32 v34, v34
    v_exp_f32 v35, v35
    v_cvt_pk_bf16_f32 v102, v60, v61
    v_cvt_pk_bf16_f32 v103, v62, v63
    v_mfma_f32_32x32x16_bf16 v[48:63], a[36:39], v[108:111], 0
    buffer_load_dwordx4 a[200:203], v11, s[20:23], s38 offen offset:2048 sc1
    v_exp_f32 v36, v36
    v_exp_f32 v37, v37
    v_exp_f32 v38, v38
    v_exp_f32 v39, v39
    v_cvt_pk_bf16_f32 v96, v32, v33
    v_cvt_pk_bf16_f32 v97, v34, v35
    v_mfma_f32_32x32x8_bf16 v[48:63], a[82:83], v[114:115], v[48:63]
    v_exp_f32 v40, v40
    v_exp_f32 v41, v41
    v_exp_f32 v42, v42
    v_exp_f32 v43, v43
    v_cvt_pk_bf16_f32 v98, v36, v37
    v_cvt_pk_bf16_f32 v99, v38, v39
    v_mfma_f32_32x32x16_bf16 v[80:95], a[164:167], v[100:103], v[80:95]
    buffer_load_dwordx4 a[204:207], v11, s[20:23], s38 offen offset:3072 sc1
    v_exp_f32 v44, v44
    v_exp_f32 v45, v45
    v_exp_f32 v46, v46
    v_exp_f32 v47, v47
    v_cvt_pk_bf16_f32 v100, v40, v41
    v_cvt_pk_bf16_f32 v101, v42, v43
    v_mfma_f32_32x32x16_bf16 v[64:79], a[168:171], v[96:99], v[64:79]
    s_waitcnt vmcnt(12)
    v_exp_f32 v48, v48
    v_exp_f32 v49, v49
    v_exp_f32 v50, v50
    v_exp_f32 v51, v51
    v_cvt_pk_bf16_f32 v102, v44, v45
    v_cvt_pk_bf16_f32 v103, v46, v47
    v_mfma_f32_32x32x16_bf16 v[32:47], a[40:43], v[104:107], 0
    buffer_load_dwordx4 a[56:59], v9, s[20:23], s36 offen offset:3072 sc1
    v_exp_f32 v52, v52
    v_exp_f32 v53, v53
    v_exp_f32 v54, v54
    v_exp_f32 v55, v55
    v_cvt_pk_bf16_f32 v96, v48, v49
    v_cvt_pk_bf16_f32 v97, v50, v51
    v_mfma_f32_32x32x8_bf16 v[32:47], a[84:85], v[112:113], v[32:47]
    v_exp_f32 v56, v56
    v_exp_f32 v57, v57
    v_exp_f32 v58, v58
    v_exp_f32 v59, v59
    v_cvt_pk_bf16_f32 v98, v52, v53
    v_cvt_pk_bf16_f32 v99, v54, v55
    v_mfma_f32_32x32x16_bf16 v[64:79], a[172:175], v[100:103], v[64:79]
    buffer_load_dwordx2 a[92:93], v10, s[20:23], s37 offen offset:3072 sc1
    v_exp_f32 v60, v60
    v_exp_f32 v61, v61
    v_exp_f32 v62, v62
    v_exp_f32 v63, v63
    v_cvt_pk_bf16_f32 v100, v56, v57
    v_cvt_pk_bf16_f32 v101, v58, v59
    v_mfma_f32_32x32x16_bf16 v[80:95], a[168:171], v[96:99], v[80:95]
    s_add_u32 s38, s38, 4096
    v_exp_f32 v32, v32
    v_exp_f32 v33, v33
    v_exp_f32 v34, v34
    v_exp_f32 v35, v35
    v_cvt_pk_bf16_f32 v102, v60, v61
    v_cvt_pk_bf16_f32 v103, v62, v63
    v_mfma_f32_32x32x16_bf16 v[48:63], a[40:43], v[108:111], 0
    buffer_load_dwordx4 a[208:211], v11, s[20:23], s38 offen offset:0 sc1
    v_exp_f32 v36, v36
    v_exp_f32 v37, v37
    v_exp_f32 v38, v38
    v_exp_f32 v39, v39
    v_cvt_pk_bf16_f32 v96, v32, v33
    v_cvt_pk_bf16_f32 v97, v34, v35
    v_mfma_f32_32x32x8_bf16 v[48:63], a[84:85], v[114:115], v[48:63]
    v_exp_f32 v40, v40
    v_exp_f32 v41, v41
    v_exp_f32 v42, v42
    v_exp_f32 v43, v43
    v_cvt_pk_bf16_f32 v98, v36, v37
    v_cvt_pk_bf16_f32 v99, v38, v39
    v_mfma_f32_32x32x16_bf16 v[80:95], a[172:175], v[100:103], v[80:95]
    buffer_load_dwordx4 a[212:215], v11, s[20:23], s38 offen offset:1024 sc1
    v_exp_f32 v44, v44
    v_exp_f32 v45, v45
    v_exp_f32 v46, v46
    v_exp_f32 v47, v47
    v_cvt_pk_bf16_f32 v100, v40, v41
    v_cvt_pk_bf16_f32 v101, v42, v43
    v_mfma_f32_32x32x16_bf16 v[64:79], a[176:179], v[96:99], v[64:79]
    s_waitcnt vmcnt(12)
    v_exp_f32 v48, v48
    v_exp_f32 v49, v49
    v_exp_f32 v50, v50
    v_exp_f32 v51, v51
    v_cvt_pk_bf16_f32 v102, v44, v45
    v_cvt_pk_bf16_f32 v103, v46, v47
    v_mfma_f32_32x32x16_bf16 v[32:47], a[44:47], v[104:107], 0
    buffer_load_dwordx4 a[60:63], v9, s[20:23], s36 offen offset:3584 sc1
    v_exp_f32 v52, v52
    v_exp_f32 v53, v53
    v_exp_f32 v54, v54
    v_exp_f32 v55, v55
    v_cvt_pk_bf16_f32 v96, v48, v49
    v_cvt_pk_bf16_f32 v97, v50, v51
    v_mfma_f32_32x32x8_bf16 v[32:47], a[86:87], v[112:113], v[32:47]
    v_exp_f32 v56, v56
    v_exp_f32 v57, v57
    v_exp_f32 v58, v58
    v_exp_f32 v59, v59
    v_cvt_pk_bf16_f32 v98, v52, v53
    v_cvt_pk_bf16_f32 v99, v54, v55
    v_mfma_f32_32x32x16_bf16 v[64:79], a[180:183], v[100:103], v[64:79]
    buffer_load_dwordx2 a[94:95], v10, s[20:23], s37 offen offset:3584 sc1
    v_exp_f32 v60, v60
    v_exp_f32 v61, v61
    v_exp_f32 v62, v62
    v_exp_f32 v63, v63
    v_cvt_pk_bf16_f32 v100, v56, v57
    v_cvt_pk_bf16_f32 v101, v58, v59
    v_mfma_f32_32x32x16_bf16 v[80:95], a[176:179], v[96:99], v[80:95]
    buffer_load_dwordx4 a[216:219], v11, s[20:23], s38 offen offset:2048 sc1
    v_exp_f32 v32, v32
    v_exp_f32 v33, v33
    v_exp_f32 v34, v34
    v_exp_f32 v35, v35
    v_cvt_pk_bf16_f32 v102, v60, v61
    v_cvt_pk_bf16_f32 v103, v62, v63
    v_mfma_f32_32x32x16_bf16 v[48:63], a[44:47], v[108:111], 0
    buffer_load_dwordx4 a[220:223], v11, s[20:23], s38 offen offset:3072 sc1
    v_exp_f32 v36, v36
    v_exp_f32 v37, v37
    v_exp_f32 v38, v38
    v_exp_f32 v39, v39
    v_cvt_pk_bf16_f32 v96, v32, v33
    v_cvt_pk_bf16_f32 v97, v34, v35
    v_mfma_f32_32x32x8_bf16 v[48:63], a[86:87], v[114:115], v[48:63]
    v_exp_f32 v40, v40
    v_exp_f32 v41, v41
    v_exp_f32 v42, v42
    v_exp_f32 v43, v43
    v_cvt_pk_bf16_f32 v98, v36, v37
    v_cvt_pk_bf16_f32 v99, v38, v39
    v_mfma_f32_32x32x16_bf16 v[80:95], a[180:183], v[100:103], v[80:95]
    ds_write_b128 v252, v[104:107]
    v_exp_f32 v44, v44
    v_exp_f32 v45, v45
    v_exp_f32 v46, v46
    v_exp_f32 v47, v47
    v_cvt_pk_bf16_f32 v100, v40, v41
    v_cvt_pk_bf16_f32 v101, v42, v43
    v_mfma_f32_32x32x16_bf16 v[64:79], a[184:187], v[96:99], v[64:79]
    s_waitcnt vmcnt(12)
    v_exp_f32 v48, v48
    v_exp_f32 v49, v49
    v_exp_f32 v50, v50
    v_exp_f32 v51, v51
    v_cvt_pk_bf16_f32 v102, v44, v45
    v_cvt_pk_bf16_f32 v103, v46, v47
    v_mfma_f32_32x32x16_bf16 v[32:47], a[48:51], v[104:107], 0
    ds_write_b128 v252, v[108:111] offset:1024
    v_exp_f32 v52, v52
    v_exp_f32 v53, v53
    v_exp_f32 v54, v54
    v_exp_f32 v55, v55
    v_cvt_pk_bf16_f32 v96, v48, v49
    v_cvt_pk_bf16_f32 v97, v50, v51
    v_mfma_f32_32x32x8_bf16 v[32:47], a[88:89], v[112:113], v[32:47]
    v_exp_f32 v56, v56
    v_exp_f32 v57, v57
    v_exp_f32 v58, v58
    v_exp_f32 v59, v59
    v_cvt_pk_bf16_f32 v98, v52, v53
    v_cvt_pk_bf16_f32 v99, v54, v55
    v_mfma_f32_32x32x16_bf16 v[64:79], a[188:191], v[100:103], v[64:79]
    ds_write_b128 v252, v[112:115] offset:2048
    v_exp_f32 v60, v60
    v_exp_f32 v61, v61
    v_exp_f32 v62, v62
    v_exp_f32 v63, v63
    v_cvt_pk_bf16_f32 v100, v56, v57
    v_cvt_pk_bf16_f32 v101, v58, v59
    v_mfma_f32_32x32x16_bf16 v[80:95], a[184:187], v[96:99], v[80:95]
    v_exp_f32 v32, v32
    v_exp_f32 v33, v33
    v_exp_f32 v34, v34
    v_exp_f32 v35, v35
    v_cvt_pk_bf16_f32 v102, v60, v61
    v_cvt_pk_bf16_f32 v103, v62, v63
    v_mfma_f32_32x32x16_bf16 v[48:63], a[48:51], v[108:111], 0
    s_lshl2_add_u32 s83, s26, s32
    v_exp_f32 v36, v36
    v_exp_f32 v37, v37
    v_exp_f32 v38, v38
    v_exp_f32 v39, v39
    v_cvt_pk_bf16_f32 v96, v32, v33
    v_cvt_pk_bf16_f32 v97, v34, v35
    v_mfma_f32_32x32x8_bf16 v[48:63], a[88:89], v[114:115], v[48:63]
    v_exp_f32 v40, v40
    v_exp_f32 v41, v41
    v_exp_f32 v42, v42
    v_exp_f32 v43, v43
    v_cvt_pk_bf16_f32 v98, v36, v37
    v_cvt_pk_bf16_f32 v99, v38, v39
    v_mfma_f32_32x32x16_bf16 v[80:95], a[188:191], v[100:103], v[80:95]
    s_lshl1_add_u32 s83, s83, s24
    v_exp_f32 v44, v44
    v_exp_f32 v45, v45
    v_exp_f32 v46, v46
    v_exp_f32 v47, v47
    v_cvt_pk_bf16_f32 v100, v40, v41
    v_cvt_pk_bf16_f32 v101, v42, v43
    v_mfma_f32_32x32x16_bf16 v[64:79], a[192:195], v[96:99], v[64:79]
    s_waitcnt vmcnt(8)
    v_exp_f32 v48, v48
    v_exp_f32 v49, v49
    v_exp_f32 v50, v50
    v_exp_f32 v51, v51
    v_cvt_pk_bf16_f32 v102, v44, v45
    v_cvt_pk_bf16_f32 v103, v46, v47
    v_mfma_f32_32x32x16_bf16 v[32:47], a[52:55], v[104:107], 0
    s_add_u32 m0, s54, 0
    v_exp_f32 v52, v52
    v_exp_f32 v53, v53
    v_exp_f32 v54, v54
    v_exp_f32 v55, v55
    v_cvt_pk_bf16_f32 v96, v48, v49
    v_cvt_pk_bf16_f32 v97, v50, v51
    v_mfma_f32_32x32x8_bf16 v[32:47], a[90:91], v[112:113], v[32:47]
    buffer_load_dwordx4 v124, s[12:15], s57 offen nt lds
    v_exp_f32 v56, v56
    v_exp_f32 v57, v57
    v_exp_f32 v58, v58
    v_exp_f32 v59, v59
    v_cvt_pk_bf16_f32 v98, v52, v53
    v_cvt_pk_bf16_f32 v99, v54, v55
    v_mfma_f32_32x32x16_bf16 v[64:79], a[196:199], v[100:103], v[64:79]
    s_mul_i32 s83, s83, 40
    v_exp_f32 v60, v60
    v_exp_f32 v61, v61
    v_exp_f32 v62, v62
    v_exp_f32 v63, v63
    v_cvt_pk_bf16_f32 v100, v56, v57
    v_cvt_pk_bf16_f32 v101, v58, v59
    v_mfma_f32_32x32x16_bf16 v[80:95], a[192:195], v[96:99], v[80:95]
    s_mul_i32 s92, s30, 5
    v_exp_f32 v32, v32
    v_exp_f32 v33, v33
    v_exp_f32 v34, v34
    v_exp_f32 v35, v35
    v_cvt_pk_bf16_f32 v102, v60, v61
    v_cvt_pk_bf16_f32 v103, v62, v63
    v_mfma_f32_32x32x16_bf16 v[48:63], a[52:55], v[108:111], 0
    buffer_load_dwordx4 v125, s[12:15], s57 offen offset:1024 nt lds
    v_exp_f32 v36, v36
    v_exp_f32 v37, v37
    v_exp_f32 v38, v38
    v_exp_f32 v39, v39
    v_cvt_pk_bf16_f32 v96, v32, v33
    v_cvt_pk_bf16_f32 v97, v34, v35
    v_mfma_f32_32x32x8_bf16 v[48:63], a[90:91], v[114:115], v[48:63]
    v_exp_f32 v40, v40
    v_exp_f32 v41, v41
    v_exp_f32 v42, v42
    v_exp_f32 v43, v43
    v_cvt_pk_bf16_f32 v98, v36, v37
    v_cvt_pk_bf16_f32 v99, v38, v39
    v_mfma_f32_32x32x16_bf16 v[80:95], a[196:199], v[100:103], v[80:95]
    v_exp_f32 v44, v44
    v_exp_f32 v45, v45
    v_exp_f32 v46, v46
    v_exp_f32 v47, v47
    v_cvt_pk_bf16_f32 v100, v40, v41
    v_cvt_pk_bf16_f32 v101, v42, v43
    v_mfma_f32_32x32x16_bf16 v[64:79], a[200:203], v[96:99], v[64:79]
    s_waitcnt vmcnt(6)
    v_exp_f32 v48, v48
    v_exp_f32 v49, v49
    v_exp_f32 v50, v50
    v_exp_f32 v51, v51
    v_cvt_pk_bf16_f32 v102, v44, v45
    v_cvt_pk_bf16_f32 v103, v46, v47
    v_mfma_f32_32x32x16_bf16 v[32:47], a[56:59], v[104:107], 0
    s_add_u32 m0, s54, 2048
    v_exp_f32 v52, v52
    v_exp_f32 v53, v53
    v_exp_f32 v54, v54
    v_exp_f32 v55, v55
    v_cvt_pk_bf16_f32 v96, v48, v49
    v_cvt_pk_bf16_f32 v97, v50, v51
    v_mfma_f32_32x32x8_bf16 v[32:47], a[92:93], v[112:113], v[32:47]
    buffer_load_dwordx4 v124, s[16:19], s58 offen nt lds
    v_exp_f32 v56, v56
    v_exp_f32 v57, v57
    v_exp_f32 v58, v58
    v_exp_f32 v59, v59
    v_cvt_pk_bf16_f32 v98, v52, v53
    v_cvt_pk_bf16_f32 v99, v54, v55
    v_mfma_f32_32x32x16_bf16 v[64:79], a[204:207], v[100:103], v[64:79]
    v_exp_f32 v60, v60
    v_exp_f32 v61, v61
    v_exp_f32 v62, v62
    v_exp_f32 v63, v63
    v_cvt_pk_bf16_f32 v100, v56, v57
    v_cvt_pk_bf16_f32 v101, v58, v59
    v_mfma_f32_32x32x16_bf16 v[80:95], a[200:203], v[96:99], v[80:95]
    v_exp_f32 v32, v32
    v_exp_f32 v33, v33
    v_exp_f32 v34, v34
    v_exp_f32 v35, v35
    v_cvt_pk_bf16_f32 v102, v60, v61
    v_cvt_pk_bf16_f32 v103, v62, v63
    v_mfma_f32_32x32x16_bf16 v[48:63], a[56:59], v[108:111], 0
    buffer_load_dwordx4 v125, s[16:19], s58 offen offset:1024 nt lds
    v_exp_f32 v36, v36
    v_exp_f32 v37, v37
    v_exp_f32 v38, v38
    v_exp_f32 v39, v39
    v_cvt_pk_bf16_f32 v96, v32, v33
    v_cvt_pk_bf16_f32 v97, v34, v35
    v_mfma_f32_32x32x8_bf16 v[48:63], a[92:93], v[114:115], v[48:63]
    v_exp_f32 v40, v40
    v_exp_f32 v41, v41
    v_exp_f32 v42, v42
    v_exp_f32 v43, v43
    v_cvt_pk_bf16_f32 v98, v36, v37
    v_cvt_pk_bf16_f32 v99, v38, v39
    v_mfma_f32_32x32x16_bf16 v[80:95], a[204:207], v[100:103], v[80:95]
    s_waitcnt lgkmcnt(0)
    v_exp_f32 v44, v44
    v_exp_f32 v45, v45
    v_exp_f32 v46, v46
    v_exp_f32 v47, v47
    v_cvt_pk_bf16_f32 v100, v40, v41
    v_cvt_pk_bf16_f32 v101, v42, v43
    v_mfma_f32_32x32x16_bf16 v[64:79], a[208:211], v[96:99], v[64:79]
    s_waitcnt vmcnt(4)
    v_exp_f32 v48, v48
    v_exp_f32 v49, v49
    v_exp_f32 v50, v50
    v_exp_f32 v51, v51
    v_cvt_pk_bf16_f32 v102, v44, v45
    v_cvt_pk_bf16_f32 v103, v46, v47
    v_mfma_f32_32x32x16_bf16 v[32:47], a[60:63], v[104:107], 0
    s_barrier
    v_exp_f32 v52, v52
    v_exp_f32 v53, v53
    v_exp_f32 v54, v54
    v_exp_f32 v55, v55
    v_cvt_pk_bf16_f32 v96, v48, v49
    v_cvt_pk_bf16_f32 v97, v50, v51
    v_mfma_f32_32x32x8_bf16 v[32:47], a[94:95], v[112:113], v[32:47]
    s_add_u32 s57, s57, s59
    v_exp_f32 v56, v56
    v_exp_f32 v57, v57
    v_exp_f32 v58, v58
    v_exp_f32 v59, v59
    v_cvt_pk_bf16_f32 v98, v52, v53
    v_cvt_pk_bf16_f32 v99, v54, v55
    v_mfma_f32_32x32x16_bf16 v[64:79], a[212:215], v[100:103], v[64:79]
    ds_read_b128 v[104:107], v253
    v_exp_f32 v60, v60
    v_exp_f32 v61, v61
    v_exp_f32 v62, v62
    v_exp_f32 v63, v63
    v_cvt_pk_bf16_f32 v100, v56, v57
    v_cvt_pk_bf16_f32 v101, v58, v59
    v_mfma_f32_32x32x16_bf16 v[80:95], a[208:211], v[96:99], v[80:95]
    ds_read_b64 v[112:113], v253 offset:2048
    v_exp_f32 v32, v32
    v_exp_f32 v33, v33
    v_exp_f32 v34, v34
    v_exp_f32 v35, v35
    v_cvt_pk_bf16_f32 v102, v60, v61
    v_cvt_pk_bf16_f32 v103, v62, v63
    v_mfma_f32_32x32x16_bf16 v[48:63], a[60:63], v[108:111], 0
    s_add_u32 s58, s58, s59
    v_exp_f32 v36, v36
    v_exp_f32 v37, v37
    v_exp_f32 v38, v38
    v_exp_f32 v39, v39
    v_cvt_pk_bf16_f32 v96, v32, v33
    v_cvt_pk_bf16_f32 v97, v34, v35
    v_mfma_f32_32x32x8_bf16 v[48:63], a[94:95], v[114:115], v[48:63]
    v_exp_f32 v40, v40
    v_exp_f32 v41, v41
    v_exp_f32 v42, v42
    v_exp_f32 v43, v43
    v_cvt_pk_bf16_f32 v98, v36, v37
    v_cvt_pk_bf16_f32 v99, v38, v39
    v_mfma_f32_32x32x16_bf16 v[80:95], a[212:215], v[100:103], v[80:95]
    ds_read_b128 v[108:111], v253 offset:1024
    v_exp_f32 v44, v44
    v_exp_f32 v45, v45
    v_exp_f32 v46, v46
    v_exp_f32 v47, v47
    v_cvt_pk_bf16_f32 v100, v40, v41
    v_cvt_pk_bf16_f32 v101, v42, v43
    v_mfma_f32_32x32x16_bf16 v[64:79], a[216:219], v[96:99], v[64:79]
    s_waitcnt lgkmcnt(1)
    v_exp_f32 v48, v48
    v_exp_f32 v49, v49
    v_exp_f32 v50, v50
    v_exp_f32 v51, v51
    v_cvt_pk_bf16_f32 v102, v44, v45
    v_cvt_pk_bf16_f32 v103, v46, v47
    v_mfma_f32_32x32x16_bf16 v[32:47], a[0:3], v[104:107], 0
    ds_read_b64 v[114:115], v253 offset:2056
    v_exp_f32 v52, v52
    v_exp_f32 v53, v53
    v_exp_f32 v54, v54
    v_exp_f32 v55, v55
    v_cvt_pk_bf16_f32 v96, v48, v49
    v_cvt_pk_bf16_f32 v97, v50, v51
    v_mfma_f32_32x32x8_bf16 v[32:47], a[64:65], v[112:113], v[32:47]
    v_exp_f32 v56, v56
    v_exp_f32 v57, v57
    v_exp_f32 v58, v58
    v_exp_f32 v59, v59
    v_cvt_pk_bf16_f32 v98, v52, v53
    v_cvt_pk_bf16_f32 v99, v54, v55
    v_mfma_f32_32x32x16_bf16 v[64:79], a[220:223], v[100:103], v[64:79]
    v_exp_f32 v60, v60
    v_exp_f32 v61, v61
    v_exp_f32 v62, v62
    v_exp_f32 v63, v63
    v_cvt_pk_bf16_f32 v100, v56, v57
    v_cvt_pk_bf16_f32 v101, v58, v59
    v_mfma_f32_32x32x16_bf16 v[80:95], a[216:219], v[96:99], v[80:95]
    s_waitcnt lgkmcnt(0)
    v_exp_f32 v32, v32
    v_exp_f32 v33, v33
    v_exp_f32 v34, v34
    v_exp_f32 v35, v35
    v_cvt_pk_bf16_f32 v102, v60, v61
    v_cvt_pk_bf16_f32 v103, v62, v63
    v_mfma_f32_32x32x16_bf16 v[48:63], a[0:3], v[108:111], 0
    s_add_u32 m0, s54, 4096
    v_exp_f32 v36, v36
    v_exp_f32 v37, v37
    v_exp_f32 v38, v38
    v_exp_f32 v39, v39
    v_cvt_pk_bf16_f32 v96, v32, v33
    v_cvt_pk_bf16_f32 v97, v34, v35
    v_mfma_f32_32x32x8_bf16 v[48:63], a[64:65], v[114:115], v[48:63]
    v_exp_f32 v40, v40
    v_exp_f32 v41, v41
    v_exp_f32 v42, v42
    v_exp_f32 v43, v43
    v_cvt_pk_bf16_f32 v98, v36, v37
    v_cvt_pk_bf16_f32 v99, v38, v39
    v_mfma_f32_32x32x16_bf16 v[80:95], a[220:223], v[100:103], v[80:95]
    buffer_load_dwordx4 v124, s[12:15], s57 offen nt lds
    v_exp_f32 v44, v44
    v_exp_f32 v45, v45
    v_exp_f32 v46, v46
    v_exp_f32 v47, v47
    v_cvt_pk_bf16_f32 v100, v40, v41
    v_cvt_pk_bf16_f32 v101, v42, v43
    v_mfma_f32_32x32x16_bf16 v[160:175], a[96:99], v[96:99], 0
    s_add_u32 s83, s83, s92
    v_exp_f32 v48, v48
    v_exp_f32 v49, v49
    v_exp_f32 v50, v50
    v_exp_f32 v51, v51
    v_cvt_pk_bf16_f32 v102, v44, v45
    v_cvt_pk_bf16_f32 v103, v46, v47
    v_mfma_f32_32x32x16_bf16 v[32:47], a[4:7], v[104:107], 0
    ds_write_b128 v248, v[64:67] offset:0
    v_exp_f32 v52, v52
    v_exp_f32 v53, v53
    v_exp_f32 v54, v54
    v_exp_f32 v55, v55
    v_cvt_pk_bf16_f32 v96, v48, v49
    v_cvt_pk_bf16_f32 v97, v50, v51
    v_mfma_f32_32x32x8_bf16 v[32:47], a[66:67], v[112:113], v[32:47]
    v_exp_f32 v56, v56
    v_exp_f32 v57, v57
    v_exp_f32 v58, v58
    v_exp_f32 v59, v59
    v_cvt_pk_bf16_f32 v98, v52, v53
    v_cvt_pk_bf16_f32 v99, v54, v55
    v_mfma_f32_32x32x16_bf16 v[160:175], a[100:103], v[100:103], v[160:175]
    buffer_load_dwordx4 v125, s[12:15], s57 offen offset:1024 nt lds
    v_exp_f32 v60, v60
    v_exp_f32 v61, v61
    v_exp_f32 v62, v62
    v_exp_f32 v63, v63
    v_cvt_pk_bf16_f32 v100, v56, v57
    v_cvt_pk_bf16_f32 v101, v58, v59
    v_mfma_f32_32x32x16_bf16 v[176:191], a[96:99], v[96:99], 0
    s_lshl_b32 s83, s83, 10
    v_exp_f32 v32, v32
    v_exp_f32 v33, v33
    v_exp_f32 v34, v34
    v_exp_f32 v35, v35
    v_cvt_pk_bf16_f32 v102, v60, v61
    v_cvt_pk_bf16_f32 v103, v62, v63
    v_mfma_f32_32x32x16_bf16 v[48:63], a[4:7], v[108:111], 0
    ds_write_b128 v248, v[68:71] offset:1024
    v_exp_f32 v36, v36
    v_exp_f32 v37, v37
    v_exp_f32 v38, v38
    v_exp_f32 v39, v39
    v_cvt_pk_bf16_f32 v96, v32, v33
    v_cvt_pk_bf16_f32 v97, v34, v35
    v_mfma_f32_32x32x8_bf16 v[48:63], a[66:67], v[114:115], v[48:63]
    v_exp_f32 v40, v40
    v_exp_f32 v41, v41
    v_exp_f32 v42, v42
    v_exp_f32 v43, v43
    v_cvt_pk_bf16_f32 v98, v36, v37
    v_cvt_pk_bf16_f32 v99, v38, v39
    v_mfma_f32_32x32x16_bf16 v[176:191], a[100:103], v[100:103], v[176:191]
    s_add_u32 m0, s54, 6144
    v_exp_f32 v44, v44
    v_exp_f32 v45, v45
    v_exp_f32 v46, v46
    v_exp_f32 v47, v47
    v_cvt_pk_bf16_f32 v100, v40, v41
    v_cvt_pk_bf16_f32 v101, v42, v43
    v_mfma_f32_32x32x16_bf16 v[160:175], a[104:107], v[96:99], v[160:175]
    buffer_load_dwordx4 v124, s[16:19], s58 offen nt lds
    v_exp_f32 v48, v48
    v_exp_f32 v49, v49
    v_exp_f32 v50, v50
    v_exp_f32 v51, v51
    v_cvt_pk_bf16_f32 v102, v44, v45
    v_cvt_pk_bf16_f32 v103, v46, v47
    v_mfma_f32_32x32x16_bf16 v[32:47], a[8:11], v[104:107], 0
    ds_write_b128 v248, v[72:75] offset:2048
    v_exp_f32 v52, v52
    v_exp_f32 v53, v53
    v_exp_f32 v54, v54
    v_exp_f32 v55, v55
    v_cvt_pk_bf16_f32 v96, v48, v49
    v_cvt_pk_bf16_f32 v97, v50, v51
    v_mfma_f32_32x32x8_bf16 v[32:47], a[68:69], v[112:113], v[32:47]
    v_exp_f32 v56, v56
    v_exp_f32 v57, v57
    v_exp_f32 v58, v58
    v_exp_f32 v59, v59
    v_cvt_pk_bf16_f32 v98, v52, v53
    v_cvt_pk_bf16_f32 v99, v54, v55
    v_mfma_f32_32x32x16_bf16 v[160:175], a[108:111], v[100:103], v[160:175]
    buffer_load_dwordx4 v125, s[16:19], s58 offen offset:1024 nt lds
    v_exp_f32 v60, v60
    v_exp_f32 v61, v61
    v_exp_f32 v62, v62
    v_exp_f32 v63, v63
    v_cvt_pk_bf16_f32 v100, v56, v57
    v_cvt_pk_bf16_f32 v101, v58, v59
    v_mfma_f32_32x32x16_bf16 v[176:191], a[104:107], v[96:99], v[176:191]
    s_add_u32 s83, s83, 7868416
    v_exp_f32 v32, v32
    v_exp_f32 v33, v33
    v_exp_f32 v34, v34
    v_exp_f32 v35, v35
    v_cvt_pk_bf16_f32 v102, v60, v61
    v_cvt_pk_bf16_f32 v103, v62, v63
    v_mfma_f32_32x32x16_bf16 v[48:63], a[8:11], v[108:111], 0
    ds_write_b128 v248, v[80:83] offset:3072
    v_exp_f32 v36, v36
    v_exp_f32 v37, v37
    v_exp_f32 v38, v38
    v_exp_f32 v39, v39
    v_cvt_pk_bf16_f32 v96, v32, v33
    v_cvt_pk_bf16_f32 v97, v34, v35
    v_mfma_f32_32x32x8_bf16 v[48:63], a[68:69], v[114:115], v[48:63]
    v_exp_f32 v40, v40
    v_exp_f32 v41, v41
    v_exp_f32 v42, v42
    v_exp_f32 v43, v43
    v_cvt_pk_bf16_f32 v98, v36, v37
    v_cvt_pk_bf16_f32 v99, v38, v39
    v_mfma_f32_32x32x16_bf16 v[176:191], a[108:111], v[100:103], v[176:191]
    s_lshl_b32 s92, s2, 10
    v_exp_f32 v44, v44
    v_exp_f32 v45, v45
    v_exp_f32 v46, v46
    v_exp_f32 v47, v47
    v_cvt_pk_bf16_f32 v100, v40, v41
    v_cvt_pk_bf16_f32 v101, v42, v43
    v_mfma_f32_32x32x16_bf16 v[160:175], a[112:115], v[96:99], v[160:175]
    s_add_u32 s92, s92, 13107200
    v_exp_f32 v48, v48
    v_exp_f32 v49, v49
    v_exp_f32 v50, v50
    v_exp_f32 v51, v51
    v_cvt_pk_bf16_f32 v102, v44, v45
    v_cvt_pk_bf16_f32 v103, v46, v47
    v_mfma_f32_32x32x16_bf16 v[32:47], a[12:15], v[104:107], 0
    ds_write_b128 v248, v[84:87] offset:4096
    v_exp_f32 v52, v52
    v_exp_f32 v53, v53
    v_exp_f32 v54, v54
    v_exp_f32 v55, v55
    v_cvt_pk_bf16_f32 v96, v48, v49
    v_cvt_pk_bf16_f32 v97, v50, v51
    v_mfma_f32_32x32x8_bf16 v[32:47], a[70:71], v[112:113], v[32:47]
    v_exp_f32 v56, v56
    v_exp_f32 v57, v57
    v_exp_f32 v58, v58
    v_exp_f32 v59, v59
    v_cvt_pk_bf16_f32 v98, v52, v53
    v_cvt_pk_bf16_f32 v99, v54, v55
    v_mfma_f32_32x32x16_bf16 v[160:175], a[116:119], v[100:103], v[160:175]
    s_cmp_lt_u32 s24, 2
    s_cselect_b32 s83, s83, s92
    v_exp_f32 v60, v60
    v_exp_f32 v61, v61
    v_exp_f32 v62, v62
    v_exp_f32 v63, v63
    v_cvt_pk_bf16_f32 v100, v56, v57
    v_cvt_pk_bf16_f32 v101, v58, v59
    v_mfma_f32_32x32x16_bf16 v[176:191], a[112:115], v[96:99], v[176:191]
    s_cmp_eq_u32 s24, 3
    s_cselect_b32 s83, 0x2000000, s83
    v_exp_f32 v32, v32
    v_exp_f32 v33, v33
    v_exp_f32 v34, v34
    v_exp_f32 v35, v35
    v_cvt_pk_bf16_f32 v102, v60, v61
    v_cvt_pk_bf16_f32 v103, v62, v63
    v_mfma_f32_32x32x16_bf16 v[48:63], a[12:15], v[108:111], 0
    ds_write_b128 v248, v[88:91] offset:5120
    v_exp_f32 v36, v36
    v_exp_f32 v37, v37
    v_exp_f32 v38, v38
    v_exp_f32 v39, v39
    v_cvt_pk_bf16_f32 v96, v32, v33
    v_cvt_pk_bf16_f32 v97, v34, v35
    v_mfma_f32_32x32x8_bf16 v[48:63], a[70:71], v[114:115], v[48:63]
    v_exp_f32 v40, v40
    v_exp_f32 v41, v41
    v_exp_f32 v42, v42
    v_exp_f32 v43, v43
    v_cvt_pk_bf16_f32 v98, v36, v37
    v_cvt_pk_bf16_f32 v99, v38, v39
    v_mfma_f32_32x32x16_bf16 v[176:191], a[116:119], v[100:103], v[176:191]
    s_cmp_eq_u32 s71, 0
    s_cselect_b32 s83, s83, 0x2000000
    v_exp_f32 v44, v44
    v_exp_f32 v45, v45
    v_exp_f32 v46, v46
    v_exp_f32 v47, v47
    v_cvt_pk_bf16_f32 v100, v40, v41
    v_cvt_pk_bf16_f32 v101, v42, v43
    v_mfma_f32_32x32x16_bf16 v[160:175], a[120:123], v[96:99], v[160:175]
    s_mov_b32 s47, 27164672
    v_exp_f32 v48, v48
    v_exp_f32 v49, v49
    v_exp_f32 v50, v50
    v_exp_f32 v51, v51
    v_cvt_pk_bf16_f32 v102, v44, v45
    v_cvt_pk_bf16_f32 v103, v46, v47
    v_mfma_f32_32x32x16_bf16 v[32:47], a[16:19], v[104:107], 0
    s_lshl_b32 s53, s30, 8
    v_exp_f32 v52, v52
    v_exp_f32 v53, v53
    v_exp_f32 v54, v54
    v_exp_f32 v55, v55
    v_cvt_pk_bf16_f32 v96, v48, v49
    v_cvt_pk_bf16_f32 v97, v50, v51
    v_mfma_f32_32x32x8_bf16 v[32:47], a[72:73], v[112:113], v[32:47]
    v_exp_f32 v56, v56
    v_exp_f32 v57, v57
    v_exp_f32 v58, v58
    v_exp_f32 v59, v59
    v_cvt_pk_bf16_f32 v98, v52, v53
    v_cvt_pk_bf16_f32 v99, v54, v55
    v_mfma_f32_32x32x16_bf16 v[160:175], a[124:127], v[100:103], v[160:175]
    s_add_u32 s53, s53, s47
    v_exp_f32 v60, v60
    v_exp_f32 v61, v61
    v_exp_f32 v62, v62
    v_exp_f32 v63, v63
    v_cvt_pk_bf16_f32 v100, v56, v57
    v_cvt_pk_bf16_f32 v101, v58, v59
    v_mfma_f32_32x32x16_bf16 v[176:191], a[120:123], v[96:99], v[176:191]
    s_cmp_eq_u32 s71, 0
    s_cselect_b32 s53, s53, 0x2000000
    v_exp_f32 v32, v32
    v_exp_f32 v33, v33
    v_exp_f32 v34, v34
    v_exp_f32 v35, v35
    v_cvt_pk_bf16_f32 v102, v60, v61
    v_cvt_pk_bf16_f32 v103, v62, v63
    v_mfma_f32_32x32x16_bf16 v[48:63], a[16:19], v[108:111], 0
    s_cmp_eq_u32 s24, 0
    s_cselect_b32 s53, s53, 0x2000000
    v_exp_f32 v36, v36
    v_exp_f32 v37, v37
    v_exp_f32 v38, v38
    v_exp_f32 v39, v39
    v_cvt_pk_bf16_f32 v96, v32, v33
    v_cvt_pk_bf16_f32 v97, v34, v35
    v_mfma_f32_32x32x8_bf16 v[48:63], a[72:73], v[114:115], v[48:63]
    v_exp_f32 v40, v40
    v_exp_f32 v41, v41
    v_exp_f32 v42, v42
    v_exp_f32 v43, v43
    v_cvt_pk_bf16_f32 v98, v36, v37
    v_cvt_pk_bf16_f32 v99, v38, v39
    v_mfma_f32_32x32x16_bf16 v[176:191], a[124:127], v[100:103], v[176:191]
    s_lshl_b32 s89, s31, 2
    v_exp_f32 v44, v44
    v_exp_f32 v45, v45
    v_exp_f32 v46, v46
    v_exp_f32 v47, v47
    v_cvt_pk_bf16_f32 v100, v40, v41
    v_cvt_pk_bf16_f32 v101, v42, v43
    v_mfma_f32_32x32x16_bf16 v[160:175], a[128:131], v[96:99], v[160:175]
    s_lshl2_add_u32 s40, s26, s67
    v_exp_f32 v48, v48
    v_exp_f32 v49, v49
    v_exp_f32 v50, v50
    v_exp_f32 v51, v51
    v_cvt_pk_bf16_f32 v102, v44, v45
    v_cvt_pk_bf16_f32 v103, v46, v47
    v_mfma_f32_32x32x16_bf16 v[32:47], a[20:23], v[104:107], 0
    s_waitcnt lgkmcnt(0)
    v_exp_f32 v52, v52
    v_exp_f32 v53, v53
    v_exp_f32 v54, v54
    v_exp_f32 v55, v55
    v_cvt_pk_bf16_f32 v96, v48, v49
    v_cvt_pk_bf16_f32 v97, v50, v51
    v_mfma_f32_32x32x8_bf16 v[32:47], a[74:75], v[112:113], v[32:47]
    v_exp_f32 v56, v56
    v_exp_f32 v57, v57
    v_exp_f32 v58, v58
    v_exp_f32 v59, v59
    v_cvt_pk_bf16_f32 v98, v52, v53
    v_cvt_pk_bf16_f32 v99, v54, v55
    v_mfma_f32_32x32x16_bf16 v[160:175], a[132:135], v[100:103], v[160:175]
    s_barrier
    v_exp_f32 v60, v60
    v_exp_f32 v61, v61
    v_exp_f32 v62, v62
    v_exp_f32 v63, v63
    v_cvt_pk_bf16_f32 v100, v56, v57
    v_cvt_pk_bf16_f32 v101, v58, v59
    v_mfma_f32_32x32x16_bf16 v[176:191], a[128:131], v[96:99], v[176:191]
    ds_read_b128 v[64:67], v250 offset:0
    v_exp_f32 v32, v32
    v_exp_f32 v33, v33
    v_exp_f32 v34, v34
    v_exp_f32 v35, v35
    v_cvt_pk_bf16_f32 v102, v60, v61
    v_cvt_pk_bf16_f32 v103, v62, v63
    v_mfma_f32_32x32x16_bf16 v[48:63], a[20:23], v[108:111], 0
    ds_read_b128 v[68:71], v250 offset:1024
    v_exp_f32 v36, v36
    v_exp_f32 v37, v37
    v_exp_f32 v38, v38
    v_exp_f32 v39, v39
    v_cvt_pk_bf16_f32 v96, v32, v33
    v_cvt_pk_bf16_f32 v97, v34, v35
    v_mfma_f32_32x32x8_bf16 v[48:63], a[74:75], v[114:115], v[48:63]
    v_exp_f32 v40, v40
    v_exp_f32 v41, v41
    v_exp_f32 v42, v42
    v_exp_f32 v43, v43
    v_cvt_pk_bf16_f32 v98, v36, v37
    v_cvt_pk_bf16_f32 v99, v38, v39
    v_mfma_f32_32x32x16_bf16 v[176:191], a[132:135], v[100:103], v[176:191]
    ds_read_b128 v[72:75], v250 offset:2048
    v_exp_f32 v44, v44
    v_exp_f32 v45, v45
    v_exp_f32 v46, v46
    v_exp_f32 v47, v47
    v_cvt_pk_bf16_f32 v100, v40, v41
    v_cvt_pk_bf16_f32 v101, v42, v43
    v_mfma_f32_32x32x16_bf16 v[160:175], a[136:139], v[96:99], v[160:175]
    ds_read_b128 v[80:83], v250 offset:3072
    v_exp_f32 v48, v48
    v_exp_f32 v49, v49
    v_exp_f32 v50, v50
    v_exp_f32 v51, v51
    v_cvt_pk_bf16_f32 v102, v44, v45
    v_cvt_pk_bf16_f32 v103, v46, v47
    v_mfma_f32_32x32x16_bf16 v[32:47], a[24:27], v[104:107], 0
    ds_read_b128 v[84:87], v250 offset:4096
    v_exp_f32 v52, v52
    v_exp_f32 v53, v53
    v_exp_f32 v54, v54
    v_exp_f32 v55, v55
    v_cvt_pk_bf16_f32 v96, v48, v49
    v_cvt_pk_bf16_f32 v97, v50, v51
    v_mfma_f32_32x32x8_bf16 v[32:47], a[76:77], v[112:113], v[32:47]
    v_exp_f32 v56, v56
    v_exp_f32 v57, v57
    v_exp_f32 v58, v58
    v_exp_f32 v59, v59
    v_cvt_pk_bf16_f32 v98, v52, v53
    v_cvt_pk_bf16_f32 v99, v54, v55
    v_mfma_f32_32x32x16_bf16 v[160:175], a[140:143], v[100:103], v[160:175]
    ds_read_b128 v[88:91], v250 offset:5120
    v_exp_f32 v60, v60
    v_exp_f32 v61, v61
    v_exp_f32 v62, v62
    v_exp_f32 v63, v63
    v_cvt_pk_bf16_f32 v100, v56, v57
    v_cvt_pk_bf16_f32 v101, v58, v59
    v_mfma_f32_32x32x16_bf16 v[176:191], a[136:139], v[96:99], v[176:191]
    s_mul_i32 s40, s40, 80
    v_exp_f32 v32, v32
    v_exp_f32 v33, v33
    v_exp_f32 v34, v34
    v_exp_f32 v35, v35
    v_cvt_pk_bf16_f32 v102, v60, v61
    v_cvt_pk_bf16_f32 v103, v62, v63
    v_mfma_f32_32x32x16_bf16 v[48:63], a[24:27], v[108:111], 0
    s_mul_i32 s64, s30, 5
    v_exp_f32 v36, v36
    v_exp_f32 v37, v37
    v_exp_f32 v38, v38
    v_exp_f32 v39, v39
    v_cvt_pk_bf16_f32 v96, v32, v33
    v_cvt_pk_bf16_f32 v97, v34, v35
    v_mfma_f32_32x32x8_bf16 v[48:63], a[76:77], v[114:115], v[48:63]
    v_exp_f32 v40, v40
    v_exp_f32 v41, v41
    v_exp_f32 v42, v42
    v_exp_f32 v43, v43
    v_cvt_pk_bf16_f32 v98, v36, v37
    v_cvt_pk_bf16_f32 v99, v38, v39
    v_mfma_f32_32x32x16_bf16 v[176:191], a[140:143], v[100:103], v[176:191]
    s_add_u32 s40, s40, s64
    v_exp_f32 v44, v44
    v_exp_f32 v45, v45
    v_exp_f32 v46, v46
    v_exp_f32 v47, v47
    v_cvt_pk_bf16_f32 v100, v40, v41
    v_cvt_pk_bf16_f32 v101, v42, v43
    v_mfma_f32_32x32x16_bf16 v[160:175], a[144:147], v[96:99], v[160:175]
    s_add_u32 s64, s40, s32
    v_exp_f32 v48, v48
    v_exp_f32 v49, v49
    v_exp_f32 v50, v50
    v_exp_f32 v51, v51
    v_cvt_pk_bf16_f32 v102, v44, v45
    v_cvt_pk_bf16_f32 v103, v46, v47
    v_mfma_f32_32x32x16_bf16 v[32:47], a[28:31], v[104:107], 0
    s_lshl_b32 s64, s64, 10
    v_exp_f32 v52, v52
    v_exp_f32 v53, v53
    v_exp_f32 v54, v54
    v_exp_f32 v55, v55
    v_cvt_pk_bf16_f32 v96, v48, v49
    v_cvt_pk_bf16_f32 v97, v50, v51
    v_mfma_f32_32x32x8_bf16 v[32:47], a[78:79], v[112:113], v[32:47]
    v_exp_f32 v56, v56
    v_exp_f32 v57, v57
    v_exp_f32 v58, v58
    v_exp_f32 v59, v59
    v_cvt_pk_bf16_f32 v98, v52, v53
    v_cvt_pk_bf16_f32 v99, v54, v55
    v_mfma_f32_32x32x16_bf16 v[160:175], a[148:151], v[100:103], v[160:175]
    s_add_u32 s64, s64, 7864320
    v_exp_f32 v60, v60
    v_exp_f32 v61, v61
    v_exp_f32 v62, v62
    v_exp_f32 v63, v63
    v_cvt_pk_bf16_f32 v100, v56, v57
    v_cvt_pk_bf16_f32 v101, v58, v59
    v_mfma_f32_32x32x16_bf16 v[176:191], a[144:147], v[96:99], v[176:191]
    s_lshl_b32 s40, s40, 10
    v_exp_f32 v32, v32
    v_exp_f32 v33, v33
    v_exp_f32 v34, v34
    v_exp_f32 v35, v35
    v_cvt_pk_bf16_f32 v102, v60, v61
    v_cvt_pk_bf16_f32 v103, v62, v63
    v_mfma_f32_32x32x16_bf16 v[48:63], a[28:31], v[108:111], 0
    s_add_u32 s65, s40, 7868416
    v_exp_f32 v36, v36
    v_exp_f32 v37, v37
    v_exp_f32 v38, v38
    v_exp_f32 v39, v39
    v_cvt_pk_bf16_f32 v96, v32, v33
    v_cvt_pk_bf16_f32 v97, v34, v35
    v_mfma_f32_32x32x8_bf16 v[48:63], a[78:79], v[114:115], v[48:63]
    v_exp_f32 v40, v40
    v_exp_f32 v41, v41
    v_exp_f32 v42, v42
    v_exp_f32 v43, v43
    v_cvt_pk_bf16_f32 v98, v36, v37
    v_cvt_pk_bf16_f32 v99, v38, v39
    v_mfma_f32_32x32x16_bf16 v[176:191], a[148:151], v[100:103], v[176:191]
    s_and_b32 s40, s32, 1
    v_exp_f32 v44, v44
    v_exp_f32 v45, v45
    v_exp_f32 v46, v46
    v_exp_f32 v47, v47
    v_cvt_pk_bf16_f32 v100, v40, v41
    v_cvt_pk_bf16_f32 v101, v42, v43
    v_mfma_f32_32x32x16_bf16 v[160:175], a[152:155], v[96:99], v[160:175]
    s_lshl_b32 s40, s40, 9
    v_exp_f32 v48, v48
    v_exp_f32 v49, v49
    v_exp_f32 v50, v50
    v_exp_f32 v51, v51
    v_cvt_pk_bf16_f32 v102, v44, v45
    v_cvt_pk_bf16_f32 v103, v46, v47
    v_mfma_f32_32x32x16_bf16 v[32:47], a[32:35], v[104:107], 0
    s_add_u32 s65, s65, s40
    v_exp_f32 v52, v52
    v_exp_f32 v53, v53
    v_exp_f32 v54, v54
    v_exp_f32 v55, v55
    v_cvt_pk_bf16_f32 v96, v48, v49
    v_cvt_pk_bf16_f32 v97, v50, v51
    v_mfma_f32_32x32x8_bf16 v[32:47], a[80:81], v[112:113], v[32:47]
    v_exp_f32 v56, v56
    v_exp_f32 v57, v57
    v_exp_f32 v58, v58
    v_exp_f32 v59, v59
    v_cvt_pk_bf16_f32 v98, v52, v53
    v_cvt_pk_bf16_f32 v99, v54, v55
    v_mfma_f32_32x32x16_bf16 v[160:175], a[156:159], v[100:103], v[160:175]
    s_lshr_b32 s40, s32, 1
    v_exp_f32 v60, v60
    v_exp_f32 v61, v61
    v_exp_f32 v62, v62
    v_exp_f32 v63, v63
    v_cvt_pk_bf16_f32 v100, v56, v57
    v_cvt_pk_bf16_f32 v101, v58, v59
    v_mfma_f32_32x32x16_bf16 v[176:191], a[152:155], v[96:99], v[176:191]
    s_lshl3_add_u32 s65, s40, s65
    v_exp_f32 v32, v32
    v_exp_f32 v33, v33
    v_exp_f32 v34, v34
    v_exp_f32 v35, v35
    v_cvt_pk_bf16_f32 v102, v60, v61
    v_cvt_pk_bf16_f32 v103, v62, v63
    v_mfma_f32_32x32x16_bf16 v[48:63], a[32:35], v[108:111], 0
    buffer_store_dwordx4 v[228:231], v5, s[20:23], s83 offen sc1
    v_exp_f32 v36, v36
    v_exp_f32 v37, v37
    v_exp_f32 v38, v38
    v_exp_f32 v39, v39
    v_cvt_pk_bf16_f32 v96, v32, v33
    v_cvt_pk_bf16_f32 v97, v34, v35
    v_mfma_f32_32x32x8_bf16 v[48:63], a[80:81], v[114:115], v[48:63]
    v_exp_f32 v40, v40
    v_exp_f32 v41, v41
    v_exp_f32 v42, v42
    v_exp_f32 v43, v43
    v_cvt_pk_bf16_f32 v98, v36, v37
    v_cvt_pk_bf16_f32 v99, v38, v39
    v_mfma_f32_32x32x16_bf16 v[176:191], a[156:159], v[100:103], v[176:191]
    s_add_u32 s66, s64, 40960
    v_exp_f32 v44, v44
    v_exp_f32 v45, v45
    v_exp_f32 v46, v46
    v_exp_f32 v47, v47
    v_cvt_pk_bf16_f32 v100, v40, v41
    v_cvt_pk_bf16_f32 v101, v42, v43
    v_mfma_f32_32x32x16_bf16 v[160:175], a[160:163], v[96:99], v[160:175]
    s_add_u32 s67, s65, 40960
    v_exp_f32 v48, v48
    v_exp_f32 v49, v49
    v_exp_f32 v50, v50
    v_exp_f32 v51, v51
    v_cvt_pk_bf16_f32 v102, v44, v45
    v_cvt_pk_bf16_f32 v103, v46, v47
    v_mfma_f32_32x32x16_bf16 v[32:47], a[36:39], v[104:107], 0
    s_and_b32 s33, s24, 1
    v_exp_f32 v52, v52
    v_exp_f32 v53, v53
    v_exp_f32 v54, v54
    v_exp_f32 v55, v55
    v_cvt_pk_bf16_f32 v96, v48, v49
    v_cvt_pk_bf16_f32 v97, v50, v51
    v_mfma_f32_32x32x8_bf16 v[32:47], a[82:83], v[112:113], v[32:47]
    v_exp_f32 v56, v56
    v_exp_f32 v57, v57
    v_exp_f32 v58, v58
    v_exp_f32 v59, v59
    v_cvt_pk_bf16_f32 v98, v52, v53
    v_cvt_pk_bf16_f32 v99, v54, v55
    v_mfma_f32_32x32x16_bf16 v[160:175], a[164:167], v[100:103], v[160:175]
    s_lshr_b32 s34, s24, 1
    v_exp_f32 v60, v60
    v_exp_f32 v61, v61
    v_exp_f32 v62, v62
    v_exp_f32 v63, v63
    v_cvt_pk_bf16_f32 v100, v56, v57
    v_cvt_pk_bf16_f32 v101, v58, v59
    v_mfma_f32_32x32x16_bf16 v[176:191], a[160:163], v[96:99], v[176:191]
    s_lshl1_add_u32 s27, s25, s33
    v_exp_f32 v32, v32
    v_exp_f32 v33, v33
    v_exp_f32 v34, v34
    v_exp_f32 v35, v35
    v_cvt_pk_bf16_f32 v102, v60, v61
    v_cvt_pk_bf16_f32 v103, v62, v63
    v_mfma_f32_32x32x16_bf16 v[48:63], a[36:39], v[108:111], 0
    v_exp_f32 v36, v36
    v_exp_f32 v37, v37
    v_exp_f32 v38, v38
    v_exp_f32 v39, v39
    v_cvt_pk_bf16_f32 v96, v32, v33
    v_cvt_pk_bf16_f32 v97, v34, v35
    v_mfma_f32_32x32x8_bf16 v[48:63], a[82:83], v[114:115], v[48:63]
    v_exp_f32 v40, v40
    v_exp_f32 v41, v41
    v_exp_f32 v42, v42
    v_exp_f32 v43, v43
    v_cvt_pk_bf16_f32 v98, v36, v37
    v_cvt_pk_bf16_f32 v99, v38, v39
    v_mfma_f32_32x32x16_bf16 v[176:191], a[164:167], v[100:103], v[176:191]
    v_exp_f32 v44, v44
    v_exp_f32 v45, v45
    v_exp_f32 v46, v46
    v_exp_f32 v47, v47
    v_cvt_pk_bf16_f32 v100, v40, v41
    v_cvt_pk_bf16_f32 v101, v42, v43
    v_mfma_f32_32x32x16_bf16 v[160:175], a[168:171], v[96:99], v[160:175]
    v_exp_f32 v48, v48
    v_exp_f32 v49, v49
    v_exp_f32 v50, v50
    v_exp_f32 v51, v51
    v_cvt_pk_bf16_f32 v102, v44, v45
    v_cvt_pk_bf16_f32 v103, v46, v47
    v_mfma_f32_32x32x16_bf16 v[32:47], a[40:43], v[104:107], 0
    v_exp_f32 v52, v52
    v_exp_f32 v53, v53
    v_exp_f32 v54, v54
    v_exp_f32 v55, v55
    v_cvt_pk_bf16_f32 v96, v48, v49
    v_cvt_pk_bf16_f32 v97, v50, v51
    v_mfma_f32_32x32x8_bf16 v[32:47], a[84:85], v[112:113], v[32:47]
    v_exp_f32 v56, v56
    v_exp_f32 v57, v57
    v_exp_f32 v58, v58
    v_exp_f32 v59, v59
    v_cvt_pk_bf16_f32 v98, v52, v53
    v_cvt_pk_bf16_f32 v99, v54, v55
    v_mfma_f32_32x32x16_bf16 v[160:175], a[172:175], v[100:103], v[160:175]
    v_exp_f32 v60, v60
    v_exp_f32 v61, v61
    v_exp_f32 v62, v62
    v_exp_f32 v63, v63
    v_cvt_pk_bf16_f32 v100, v56, v57
    v_cvt_pk_bf16_f32 v101, v58, v59
    v_mfma_f32_32x32x16_bf16 v[176:191], a[168:171], v[96:99], v[176:191]
    v_exp_f32 v32, v32
    v_exp_f32 v33, v33
    v_exp_f32 v34, v34
    v_exp_f32 v35, v35
    v_cvt_pk_bf16_f32 v102, v60, v61
    v_cvt_pk_bf16_f32 v103, v62, v63
    v_mfma_f32_32x32x16_bf16 v[48:63], a[40:43], v[108:111], 0
    v_exp_f32 v36, v36
    v_exp_f32 v37, v37
    v_exp_f32 v38, v38
    v_exp_f32 v39, v39
    v_cvt_pk_bf16_f32 v96, v32, v33
    v_cvt_pk_bf16_f32 v97, v34, v35
    v_mfma_f32_32x32x8_bf16 v[48:63], a[84:85], v[114:115], v[48:63]
    v_exp_f32 v40, v40
    v_exp_f32 v41, v41
    v_exp_f32 v42, v42
    v_exp_f32 v43, v43
    v_cvt_pk_bf16_f32 v98, v36, v37
    v_cvt_pk_bf16_f32 v99, v38, v39
    v_mfma_f32_32x32x16_bf16 v[176:191], a[172:175], v[100:103], v[176:191]
    v_exp_f32 v44, v44
    v_exp_f32 v45, v45
    v_exp_f32 v46, v46
    v_exp_f32 v47, v47
    v_cvt_pk_bf16_f32 v100, v40, v41
    v_cvt_pk_bf16_f32 v101, v42, v43
    v_mfma_f32_32x32x16_bf16 v[160:175], a[176:179], v[96:99], v[160:175]
    v_exp_f32 v48, v48
    v_exp_f32 v49, v49
    v_exp_f32 v50, v50
    v_exp_f32 v51, v51
    v_cvt_pk_bf16_f32 v102, v44, v45
    v_cvt_pk_bf16_f32 v103, v46, v47
    v_mfma_f32_32x32x16_bf16 v[32:47], a[44:47], v[104:107], 0
    v_exp_f32 v52, v52
    v_exp_f32 v53, v53
    v_exp_f32 v54, v54
    v_exp_f32 v55, v55
    v_cvt_pk_bf16_f32 v96, v48, v49
    v_cvt_pk_bf16_f32 v97, v50, v51
    v_mfma_f32_32x32x8_bf16 v[32:47], a[86:87], v[112:113], v[32:47]
    v_exp_f32 v56, v56
    v_exp_f32 v57, v57
    v_exp_f32 v58, v58
    v_exp_f32 v59, v59
    v_cvt_pk_bf16_f32 v98, v52, v53
    v_cvt_pk_bf16_f32 v99, v54, v55
    v_mfma_f32_32x32x16_bf16 v[160:175], a[180:183], v[100:103], v[160:175]
    v_exp_f32 v60, v60
    v_exp_f32 v61, v61
    v_exp_f32 v62, v62
    v_exp_f32 v63, v63
    v_cvt_pk_bf16_f32 v100, v56, v57
    v_cvt_pk_bf16_f32 v101, v58, v59
    v_mfma_f32_32x32x16_bf16 v[176:191], a[176:179], v[96:99], v[176:191]
    v_exp_f32 v32, v32
    v_exp_f32 v33, v33
    v_exp_f32 v34, v34
    v_exp_f32 v35, v35
    v_cvt_pk_bf16_f32 v102, v60, v61
    v_cvt_pk_bf16_f32 v103, v62, v63
    v_mfma_f32_32x32x16_bf16 v[48:63], a[44:47], v[108:111], 0
    v_exp_f32 v36, v36
    v_exp_f32 v37, v37
    v_exp_f32 v38, v38
    v_exp_f32 v39, v39
    v_cvt_pk_bf16_f32 v96, v32, v33
    v_cvt_pk_bf16_f32 v97, v34, v35
    v_mfma_f32_32x32x8_bf16 v[48:63], a[86:87], v[114:115], v[48:63]
    v_exp_f32 v40, v40
    v_exp_f32 v41, v41
    v_exp_f32 v42, v42
    v_exp_f32 v43, v43
    v_cvt_pk_bf16_f32 v98, v36, v37
    v_cvt_pk_bf16_f32 v99, v38, v39
    v_mfma_f32_32x32x16_bf16 v[176:191], a[180:183], v[100:103], v[176:191]
    v_exp_f32 v44, v44
    v_exp_f32 v45, v45
    v_exp_f32 v46, v46
    v_exp_f32 v47, v47
    v_cvt_pk_bf16_f32 v100, v40, v41
    v_cvt_pk_bf16_f32 v101, v42, v43
    v_mfma_f32_32x32x16_bf16 v[160:175], a[184:187], v[96:99], v[160:175]
    v_exp_f32 v48, v48
    v_exp_f32 v49, v49
    v_exp_f32 v50, v50
    v_exp_f32 v51, v51
    v_cvt_pk_bf16_f32 v102, v44, v45
    v_cvt_pk_bf16_f32 v103, v46, v47
    v_mfma_f32_32x32x16_bf16 v[32:47], a[48:51], v[104:107], 0
    s_waitcnt vmcnt(1)
    v_exp_f32 v52, v52
    v_exp_f32 v53, v53
    v_exp_f32 v54, v54
    v_exp_f32 v55, v55
    v_cvt_pk_bf16_f32 v96, v48, v49
    v_cvt_pk_bf16_f32 v97, v50, v51
    v_mfma_f32_32x32x8_bf16 v[32:47], a[88:89], v[112:113], v[32:47]
    v_exp_f32 v56, v56
    v_exp_f32 v57, v57
    v_exp_f32 v58, v58
    v_exp_f32 v59, v59
    v_cvt_pk_bf16_f32 v98, v52, v53
    v_cvt_pk_bf16_f32 v99, v54, v55
    v_mfma_f32_32x32x16_bf16 v[160:175], a[188:191], v[100:103], v[160:175]
    ds_read_b64_tr_b16 v[128:129], v116 offset:0
    v_exp_f32 v60, v60
    v_exp_f32 v61, v61
    v_exp_f32 v62, v62
    v_exp_f32 v63, v63
    v_cvt_pk_bf16_f32 v100, v56, v57
    v_cvt_pk_bf16_f32 v101, v58, v59
    v_mfma_f32_32x32x16_bf16 v[176:191], a[184:187], v[96:99], v[176:191]
    ds_read_b64_tr_b16 v[130:131], v116 offset:1024
    v_exp_f32 v32, v32
    v_exp_f32 v33, v33
    v_exp_f32 v34, v34
    v_exp_f32 v35, v35
    v_cvt_pk_bf16_f32 v102, v60, v61
    v_cvt_pk_bf16_f32 v103, v62, v63
    v_mfma_f32_32x32x16_bf16 v[48:63], a[48:51], v[108:111], 0
    ds_read_b64_tr_b16 v[132:133], v117 offset:0
    v_exp_f32 v36, v36
    v_exp_f32 v37, v37
    v_exp_f32 v38, v38
    v_exp_f32 v39, v39
    v_cvt_pk_bf16_f32 v96, v32, v33
    v_cvt_pk_bf16_f32 v97, v34, v35
    v_mfma_f32_32x32x8_bf16 v[48:63], a[88:89], v[114:115], v[48:63]
    v_exp_f32 v40, v40
    v_exp_f32 v41, v41
    v_exp_f32 v42, v42
    v_exp_f32 v43, v43
    v_cvt_pk_bf16_f32 v98, v36, v37
    v_cvt_pk_bf16_f32 v99, v38, v39
    v_mfma_f32_32x32x16_bf16 v[176:191], a[188:191], v[100:103], v[176:191]
    ds_read_b64_tr_b16 v[134:135], v117 offset:1024
    v_exp_f32 v44, v44
    v_exp_f32 v45, v45
    v_exp_f32 v46, v46
    v_exp_f32 v47, v47
    v_cvt_pk_bf16_f32 v100, v40, v41
    v_cvt_pk_bf16_f32 v101, v42, v43
    v_mfma_f32_32x32x16_bf16 v[160:175], a[192:195], v[96:99], v[160:175]
    ds_read_b64_tr_b16 v[136:137], v118 offset:0
    v_exp_f32 v48, v48
    v_exp_f32 v49, v49
    v_exp_f32 v50, v50
    v_exp_f32 v51, v51
    v_cvt_pk_bf16_f32 v102, v44, v45
    v_cvt_pk_bf16_f32 v103, v46, v47
    v_mfma_f32_32x32x16_bf16 v[32:47], a[52:55], v[104:107], 0
    ds_read_b64_tr_b16 v[138:139], v118 offset:1024
    v_exp_f32 v52, v52
    v_exp_f32 v53, v53
    v_exp_f32 v54, v54
    v_exp_f32 v55, v55
    v_cvt_pk_bf16_f32 v96, v48, v49
    v_cvt_pk_bf16_f32 v97, v50, v51
    v_mfma_f32_32x32x8_bf16 v[32:47], a[90:91], v[112:113], v[32:47]
    v_exp_f32 v56, v56
    v_exp_f32 v57, v57
    v_exp_f32 v58, v58
    v_exp_f32 v59, v59
    v_cvt_pk_bf16_f32 v98, v52, v53
    v_cvt_pk_bf16_f32 v99, v54, v55
    v_mfma_f32_32x32x16_bf16 v[160:175], a[196:199], v[100:103], v[160:175]
    ds_read_b64_tr_b16 v[140:141], v119 offset:0
    v_exp_f32 v60, v60
    v_exp_f32 v61, v61
    v_exp_f32 v62, v62
    v_exp_f32 v63, v63
    v_cvt_pk_bf16_f32 v100, v56, v57
    v_cvt_pk_bf16_f32 v101, v58, v59
    v_mfma_f32_32x32x16_bf16 v[176:191], a[192:195], v[96:99], v[176:191]
    ds_read_b64_tr_b16 v[142:143], v119 offset:1024
    v_exp_f32 v32, v32
    v_exp_f32 v33, v33
    v_exp_f32 v34, v34
    v_exp_f32 v35, v35
    v_cvt_pk_bf16_f32 v102, v60, v61
    v_cvt_pk_bf16_f32 v103, v62, v63
    v_mfma_f32_32x32x16_bf16 v[48:63], a[52:55], v[108:111], 0
    ds_read_b64_tr_b16 v[144:145], v116 offset:4096
    v_exp_f32 v36, v36
    v_exp_f32 v37, v37
    v_exp_f32 v38, v38
    v_exp_f32 v39, v39
    v_cvt_pk_bf16_f32 v96, v32, v33
    v_cvt_pk_bf16_f32 v97, v34, v35
    v_mfma_f32_32x32x8_bf16 v[48:63], a[90:91], v[114:115], v[48:63]
    v_exp_f32 v40, v40
    v_exp_f32 v41, v41
    v_exp_f32 v42, v42
    v_exp_f32 v43, v43
    v_cvt_pk_bf16_f32 v98, v36, v37
    v_cvt_pk_bf16_f32 v99, v38, v39
    v_mfma_f32_32x32x16_bf16 v[176:191], a[196:199], v[100:103], v[176:191]
    ds_read_b64_tr_b16 v[146:147], v116 offset:5120
    v_exp_f32 v44, v44
    v_exp_f32 v45, v45
    v_exp_f32 v46, v46
    v_exp_f32 v47, v47
    v_cvt_pk_bf16_f32 v100, v40, v41
    v_cvt_pk_bf16_f32 v101, v42, v43
    v_mfma_f32_32x32x16_bf16 v[160:175], a[200:203], v[96:99], v[160:175]
    ds_read_b64_tr_b16 v[148:149], v117 offset:4096
    v_exp_f32 v48, v48
    v_exp_f32 v49, v49
    v_exp_f32 v50, v50
    v_exp_f32 v51, v51
    v_cvt_pk_bf16_f32 v102, v44, v45
    v_cvt_pk_bf16_f32 v103, v46, v47
    v_mfma_f32_32x32x16_bf16 v[32:47], a[56:59], v[104:107], 0
    ds_read_b64_tr_b16 v[150:151], v117 offset:5120
    v_exp_f32 v52, v52
    v_exp_f32 v53, v53
    v_exp_f32 v54, v54
    v_exp_f32 v55, v55
    v_cvt_pk_bf16_f32 v96, v48, v49
    v_cvt_pk_bf16_f32 v97, v50, v51
    v_mfma_f32_32x32x8_bf16 v[32:47], a[92:93], v[112:113], v[32:47]
    v_exp_f32 v56, v56
    v_exp_f32 v57, v57
    v_exp_f32 v58, v58
    v_exp_f32 v59, v59
    v_cvt_pk_bf16_f32 v98, v52, v53
    v_cvt_pk_bf16_f32 v99, v54, v55
    v_mfma_f32_32x32x16_bf16 v[160:175], a[204:207], v[100:103], v[160:175]
    ds_read_b64_tr_b16 v[152:153], v118 offset:4096
    v_exp_f32 v60, v60
    v_exp_f32 v61, v61
    v_exp_f32 v62, v62
    v_exp_f32 v63, v63
    v_cvt_pk_bf16_f32 v100, v56, v57
    v_cvt_pk_bf16_f32 v101, v58, v59
    v_mfma_f32_32x32x16_bf16 v[176:191], a[200:203], v[96:99], v[176:191]
    ds_read_b64_tr_b16 v[154:155], v118 offset:5120
    v_exp_f32 v32, v32
    v_exp_f32 v33, v33
    v_exp_f32 v34, v34
    v_exp_f32 v35, v35
    v_cvt_pk_bf16_f32 v102, v60, v61
    v_cvt_pk_bf16_f32 v103, v62, v63
    v_mfma_f32_32x32x16_bf16 v[48:63], a[56:59], v[108:111], 0
    ds_read_b64_tr_b16 v[156:157], v119 offset:4096
    v_exp_f32 v36, v36
    v_exp_f32 v37, v37
    v_exp_f32 v38, v38
    v_exp_f32 v39, v39
    v_cvt_pk_bf16_f32 v96, v32, v33
    v_cvt_pk_bf16_f32 v97, v34, v35
    v_mfma_f32_32x32x8_bf16 v[48:63], a[92:93], v[114:115], v[48:63]
    v_exp_f32 v40, v40
    v_exp_f32 v41, v41
    v_exp_f32 v42, v42
    v_exp_f32 v43, v43
    v_cvt_pk_bf16_f32 v98, v36, v37
    v_cvt_pk_bf16_f32 v99, v38, v39
    v_mfma_f32_32x32x16_bf16 v[176:191], a[204:207], v[100:103], v[176:191]
    ds_read_b64_tr_b16 v[158:159], v119 offset:5120
    v_exp_f32 v44, v44
    v_exp_f32 v45, v45
    v_exp_f32 v46, v46
    v_exp_f32 v47, v47
    v_cvt_pk_bf16_f32 v100, v40, v41
    v_cvt_pk_bf16_f32 v101, v42, v43
    v_mfma_f32_32x32x16_bf16 v[160:175], a[208:211], v[96:99], v[160:175]
    v_exp_f32 v48, v48
    v_exp_f32 v49, v49
    v_exp_f32 v50, v50
    v_exp_f32 v51, v51
    v_cvt_pk_bf16_f32 v102, v44, v45
    v_cvt_pk_bf16_f32 v103, v46, v47
    v_mfma_f32_32x32x16_bf16 v[32:47], a[60:63], v[104:107], 0
    v_exp_f32 v52, v52
    v_exp_f32 v53, v53
    v_exp_f32 v54, v54
    v_exp_f32 v55, v55
    v_cvt_pk_bf16_f32 v96, v48, v49
    v_cvt_pk_bf16_f32 v97, v50, v51
    v_mfma_f32_32x32x8_bf16 v[32:47], a[94:95], v[112:113], v[32:47]
    v_exp_f32 v56, v56
    v_exp_f32 v57, v57
    v_exp_f32 v58, v58
    v_exp_f32 v59, v59
    v_cvt_pk_bf16_f32 v98, v52, v53
    v_cvt_pk_bf16_f32 v99, v54, v55
    v_mfma_f32_32x32x16_bf16 v[160:175], a[212:215], v[100:103], v[160:175]
    ds_read_b128 v[104:107], v254
    v_exp_f32 v60, v60
    v_exp_f32 v61, v61
    v_exp_f32 v62, v62
    v_exp_f32 v63, v63
    v_cvt_pk_bf16_f32 v100, v56, v57
    v_cvt_pk_bf16_f32 v101, v58, v59
    v_mfma_f32_32x32x16_bf16 v[176:191], a[208:211], v[96:99], v[176:191]
    ds_read_b64 v[112:113], v254 offset:2048
    v_exp_f32 v32, v32
    v_exp_f32 v33, v33
    v_exp_f32 v34, v34
    v_exp_f32 v35, v35
    v_cvt_pk_bf16_f32 v102, v60, v61
    v_cvt_pk_bf16_f32 v103, v62, v63
    v_mfma_f32_32x32x16_bf16 v[48:63], a[60:63], v[108:111], 0
    v_exp_f32 v36, v36
    v_exp_f32 v37, v37
    v_exp_f32 v38, v38
    v_exp_f32 v39, v39
    v_cvt_pk_bf16_f32 v96, v32, v33
    v_cvt_pk_bf16_f32 v97, v34, v35
    v_mfma_f32_32x32x8_bf16 v[48:63], a[94:95], v[114:115], v[48:63]
    v_exp_f32 v40, v40
    v_exp_f32 v41, v41
    v_exp_f32 v42, v42
    v_exp_f32 v43, v43
    v_cvt_pk_bf16_f32 v98, v36, v37
    v_cvt_pk_bf16_f32 v99, v38, v39
    v_mfma_f32_32x32x16_bf16 v[176:191], a[212:215], v[100:103], v[176:191]
    ds_read_b128 v[108:111], v254 offset:1024
    v_exp_f32 v44, v44
    v_exp_f32 v45, v45
    v_exp_f32 v46, v46
    v_exp_f32 v47, v47
    v_cvt_pk_bf16_f32 v100, v40, v41
    v_cvt_pk_bf16_f32 v101, v42, v43
    v_mfma_f32_32x32x16_bf16 v[160:175], a[216:219], v[96:99], v[160:175]
    s_waitcnt lgkmcnt(1)
    v_exp_f32 v48, v48
    v_exp_f32 v49, v49
    v_exp_f32 v50, v50
    v_exp_f32 v51, v51
    v_cvt_pk_bf16_f32 v102, v44, v45
    v_cvt_pk_bf16_f32 v103, v46, v47
    v_mfma_f32_32x32x16_bf16 v[32:47], a[0:3], v[104:107], 0
    ds_read_b64 v[114:115], v254 offset:2056
    v_exp_f32 v52, v52
    v_exp_f32 v53, v53
    v_exp_f32 v54, v54
    v_exp_f32 v55, v55
    v_cvt_pk_bf16_f32 v96, v48, v49
    v_cvt_pk_bf16_f32 v97, v50, v51
    v_mfma_f32_32x32x8_bf16 v[32:47], a[64:65], v[112:113], v[32:47]
    v_exp_f32 v56, v56
    v_exp_f32 v57, v57
    v_exp_f32 v58, v58
    v_exp_f32 v59, v59
    v_cvt_pk_bf16_f32 v98, v52, v53
    v_cvt_pk_bf16_f32 v99, v54, v55
    v_mfma_f32_32x32x16_bf16 v[160:175], a[220:223], v[100:103], v[160:175]
    v_exp_f32 v60, v60
    v_exp_f32 v61, v61
    v_exp_f32 v62, v62
    v_exp_f32 v63, v63
    v_cvt_pk_bf16_f32 v100, v56, v57
    v_cvt_pk_bf16_f32 v101, v58, v59
    v_mfma_f32_32x32x16_bf16 v[176:191], a[216:219], v[96:99], v[176:191]
    s_waitcnt lgkmcnt(0)
    v_exp_f32 v32, v32
    v_exp_f32 v33, v33
    v_exp_f32 v34, v34
    v_exp_f32 v35, v35
    v_cvt_pk_bf16_f32 v102, v60, v61
    v_cvt_pk_bf16_f32 v103, v62, v63
    v_mfma_f32_32x32x16_bf16 v[48:63], a[0:3], v[108:111], 0
    buffer_store_dwordx4 v[128:131], v120, s[20:23], 0 offen sc1
    v_exp_f32 v36, v36
    v_exp_f32 v37, v37
    v_exp_f32 v38, v38
    v_mfma_f32_16x16x32_bf16 v[244:247], v[228:231], v[128:131], 0
    v_exp_f32 v39, v39
    v_cvt_pk_bf16_f32 v96, v32, v33
    v_cvt_pk_bf16_f32 v97, v34, v35
    v_mfma_f32_32x32x8_bf16 v[48:63], a[64:65], v[114:115], v[48:63]
    v_exp_f32 v40, v40
    v_exp_f32 v41, v41
    v_exp_f32 v42, v42
    v_exp_f32 v43, v43
    v_cvt_pk_bf16_f32 v98, v36, v37
    v_cvt_pk_bf16_f32 v99, v38, v39
    v_mfma_f32_32x32x16_bf16 v[176:191], a[220:223], v[100:103], v[176:191]
    s_mov_b32 s12, s76
    v_exp_f32 v44, v44
    v_exp_f32 v45, v45
    v_exp_f32 v46, v46
    v_mfma_f32_16x16x32_bf16 v[244:247], v[232:235], v[132:135], v[244:247]
    v_exp_f32 v47, v47
    v_cvt_pk_bf16_f32 v100, v40, v41
    v_cvt_pk_bf16_f32 v101, v42, v43
    v_mfma_f32_32x32x16_bf16 v[64:79], a[96:99], v[96:99], v[64:79]
    s_mov_b32 s13, s77
    v_exp_f32 v48, v48
    v_exp_f32 v49, v49
    v_exp_f32 v50, v50
    v_exp_f32 v51, v51
    v_cvt_pk_bf16_f32 v102, v44, v45
    v_cvt_pk_bf16_f32 v103, v46, v47
    v_mfma_f32_32x32x16_bf16 v[32:47], a[4:7], v[104:107], 0
    ds_write_b128 v249, v[160:163] offset:24576
    v_exp_f32 v52, v52
    v_exp_f32 v53, v53
    v_exp_f32 v54, v54
    v_mfma_f32_16x16x32_bf16 v[244:247], v[236:239], v[136:139], v[244:247]
    v_exp_f32 v55, v55
    v_cvt_pk_bf16_f32 v96, v48, v49
    v_cvt_pk_bf16_f32 v97, v50, v51
    v_mfma_f32_32x32x8_bf16 v[32:47], a[66:67], v[112:113], v[32:47]
    v_exp_f32 v56, v56
    v_exp_f32 v57, v57
    v_exp_f32 v58, v58
    v_exp_f32 v59, v59
    v_cvt_pk_bf16_f32 v98, v52, v53
    v_cvt_pk_bf16_f32 v99, v54, v55
    v_mfma_f32_32x32x16_bf16 v[64:79], a[100:103], v[100:103], v[64:79]
    buffer_store_dwordx4 v[132:135], v121, s[20:23], 0 offen sc1
    v_exp_f32 v60, v60
    v_exp_f32 v61, v61
    v_exp_f32 v62, v62
    v_mfma_f32_16x16x32_bf16 v[244:247], v[240:243], v[140:143], v[244:247]
    v_exp_f32 v63, v63
    v_cvt_pk_bf16_f32 v100, v56, v57
    v_cvt_pk_bf16_f32 v101, v58, v59
    v_mfma_f32_32x32x16_bf16 v[80:95], a[96:99], v[96:99], v[80:95]
    s_mov_b32 s14, 2621440
    v_exp_f32 v32, v32
    v_exp_f32 v33, v33
    v_exp_f32 v34, v34
    v_exp_f32 v35, v35
    v_cvt_pk_bf16_f32 v102, v60, v61
    v_cvt_pk_bf16_f32 v103, v62, v63
    v_mfma_f32_32x32x16_bf16 v[48:63], a[4:7], v[108:111], 0
    ds_write_b128 v249, v[164:167] offset:25600
    v_exp_f32 v36, v36
    v_exp_f32 v37, v37
    v_exp_f32 v38, v38
    v_mfma_f32_16x16x32_bf16 v[244:247], v[228:231], v[144:147], v[244:247]
    v_exp_f32 v39, v39
    v_cvt_pk_bf16_f32 v96, v32, v33
    v_cvt_pk_bf16_f32 v97, v34, v35
    v_mfma_f32_32x32x8_bf16 v[48:63], a[66:67], v[114:115], v[48:63]
    v_exp_f32 v40, v40
    v_exp_f32 v41, v41
    v_exp_f32 v42, v42
    v_exp_f32 v43, v43
    v_cvt_pk_bf16_f32 v98, v36, v37
    v_cvt_pk_bf16_f32 v99, v38, v39
    v_mfma_f32_32x32x16_bf16 v[80:95], a[100:103], v[100:103], v[80:95]
    buffer_store_dwordx4 v[136:139], v122, s[20:23], 0 offen sc1
    v_exp_f32 v44, v44
    v_exp_f32 v45, v45
    v_exp_f32 v46, v46
    v_mfma_f32_16x16x32_bf16 v[244:247], v[232:235], v[148:151], v[244:247]
    v_exp_f32 v47, v47
    v_cvt_pk_bf16_f32 v100, v40, v41
    v_cvt_pk_bf16_f32 v101, v42, v43
    v_mfma_f32_32x32x16_bf16 v[64:79], a[104:107], v[96:99], v[64:79]
    s_mov_b32 s15, 0x00020000
    v_exp_f32 v48, v48
    v_exp_f32 v49, v49
    v_exp_f32 v50, v50
    v_exp_f32 v51, v51
    v_cvt_pk_bf16_f32 v102, v44, v45
    v_cvt_pk_bf16_f32 v103, v46, v47
    v_mfma_f32_32x32x16_bf16 v[32:47], a[8:11], v[104:107], 0
    ds_write_b128 v249, v[168:171] offset:26624
    v_exp_f32 v52, v52
    v_exp_f32 v53, v53
    v_exp_f32 v54, v54
    v_mfma_f32_16x16x32_bf16 v[244:247], v[236:239], v[152:155], v[244:247]
    v_exp_f32 v55, v55
    v_cvt_pk_bf16_f32 v96, v48, v49
    v_cvt_pk_bf16_f32 v97, v50, v51
    v_mfma_f32_32x32x8_bf16 v[32:47], a[68:69], v[112:113], v[32:47]
    v_exp_f32 v56, v56
    v_exp_f32 v57, v57
    v_exp_f32 v58, v58
    v_exp_f32 v59, v59
    v_cvt_pk_bf16_f32 v98, v52, v53
    v_cvt_pk_bf16_f32 v99, v54, v55
    v_mfma_f32_32x32x16_bf16 v[64:79], a[108:111], v[100:103], v[64:79]
    buffer_store_dwordx4 v[140:143], v123, s[20:23], 0 offen sc1
    v_exp_f32 v60, v60
    v_exp_f32 v61, v61
    v_exp_f32 v62, v62
    v_mfma_f32_16x16x32_bf16 v[244:247], v[240:243], v[156:159], v[244:247]
    v_exp_f32 v63, v63
    v_cvt_pk_bf16_f32 v100, v56, v57
    v_cvt_pk_bf16_f32 v101, v58, v59
    v_mfma_f32_32x32x16_bf16 v[80:95], a[104:107], v[96:99], v[80:95]
    s_mul_i32 s37, s34, 3
    v_exp_f32 v32, v32
    v_exp_f32 v33, v33
    v_exp_f32 v34, v34
    v_exp_f32 v35, v35
    v_cvt_pk_bf16_f32 v102, v60, v61
    v_cvt_pk_bf16_f32 v103, v62, v63
    v_mfma_f32_32x32x16_bf16 v[48:63], a[8:11], v[108:111], 0
    ds_write_b128 v249, v[176:179] offset:27648
    v_exp_f32 v36, v36
    v_exp_f32 v37, v37
    v_exp_f32 v38, v38
    v_exp_f32 v39, v39
    v_cvt_pk_bf16_f32 v96, v32, v33
    v_cvt_pk_bf16_f32 v97, v34, v35
    v_mfma_f32_32x32x8_bf16 v[48:63], a[68:69], v[114:115], v[48:63]
    v_exp_f32 v40, v40
    v_exp_f32 v41, v41
    v_exp_f32 v42, v42
    v_exp_f32 v43, v43
    v_cvt_pk_bf16_f32 v98, v36, v37
    v_cvt_pk_bf16_f32 v99, v38, v39
    v_mfma_f32_32x32x16_bf16 v[80:95], a[108:111], v[100:103], v[80:95]
    buffer_store_dwordx4 v[144:147], v120, s[20:23], s60 offen sc1
    v_exp_f32 v44, v44
    v_exp_f32 v45, v45
    v_exp_f32 v46, v46
    v_exp_f32 v47, v47
    v_cvt_pk_bf16_f32 v100, v40, v41
    v_cvt_pk_bf16_f32 v101, v42, v43
    v_mfma_f32_32x32x16_bf16 v[64:79], a[112:115], v[96:99], v[64:79]
    s_mul_i32 s36, s27, 40960
    v_exp_f32 v48, v48
    v_exp_f32 v49, v49
    v_exp_f32 v50, v50
    v_exp_f32 v51, v51
    v_cvt_pk_bf16_f32 v102, v44, v45
    v_cvt_pk_bf16_f32 v103, v46, v47
    v_mfma_f32_32x32x16_bf16 v[32:47], a[12:15], v[104:107], 0
    ds_write_b128 v249, v[180:183] offset:28672
    v_exp_f32 v52, v52
    v_exp_f32 v53, v53
    v_exp_f32 v54, v54
    v_exp_f32 v55, v55
    v_cvt_pk_bf16_f32 v96, v48, v49
    v_cvt_pk_bf16_f32 v97, v50, v51
    v_mfma_f32_32x32x8_bf16 v[32:47], a[70:71], v[112:113], v[32:47]
    v_exp_f32 v56, v56
    v_exp_f32 v57, v57
    v_exp_f32 v58, v58
    v_exp_f32 v59, v59
    v_cvt_pk_bf16_f32 v98, v52, v53
    v_cvt_pk_bf16_f32 v99, v54, v55
    v_mfma_f32_32x32x16_bf16 v[64:79], a[116:119], v[100:103], v[64:79]
    buffer_store_dwordx4 v[148:151], v121, s[20:23], s61 offen sc1
    v_exp_f32 v60, v60
    v_exp_f32 v61, v61
    v_exp_f32 v62, v62
    v_exp_f32 v63, v63
    v_cvt_pk_bf16_f32 v100, v56, v57
    v_cvt_pk_bf16_f32 v101, v58, v59
    v_mfma_f32_32x32x16_bf16 v[80:95], a[112:115], v[96:99], v[80:95]
    buffer_store_dwordx4 v[244:247], v27, s[20:23], s70 offen sc1
    v_exp_f32 v32, v32
    v_exp_f32 v33, v33
    v_exp_f32 v34, v34
    v_exp_f32 v35, v35
    v_cvt_pk_bf16_f32 v102, v60, v61
    v_cvt_pk_bf16_f32 v103, v62, v63
    v_mfma_f32_32x32x16_bf16 v[48:63], a[12:15], v[108:111], 0
    ds_write_b128 v249, v[184:187] offset:29696
    v_exp_f32 v36, v36
    v_exp_f32 v37, v37
    v_exp_f32 v38, v38
    v_exp_f32 v39, v39
    v_cvt_pk_bf16_f32 v96, v32, v33
    v_cvt_pk_bf16_f32 v97, v34, v35
    v_mfma_f32_32x32x8_bf16 v[48:63], a[70:71], v[114:115], v[48:63]
    v_exp_f32 v40, v40
    v_exp_f32 v41, v41
    v_exp_f32 v42, v42
    v_exp_f32 v43, v43
    v_cvt_pk_bf16_f32 v98, v36, v37
    v_cvt_pk_bf16_f32 v99, v38, v39
    v_mfma_f32_32x32x16_bf16 v[80:95], a[116:119], v[100:103], v[80:95]
    buffer_store_dwordx4 v[152:155], v122, s[20:23], s62 offen sc1
    v_exp_f32 v44, v44
    v_exp_f32 v45, v45
    v_exp_f32 v46, v46
    v_exp_f32 v47, v47
    v_cvt_pk_bf16_f32 v100, v40, v41
    v_cvt_pk_bf16_f32 v101, v42, v43
    v_mfma_f32_32x32x16_bf16 v[64:79], a[120:123], v[96:99], v[64:79]
    s_mul_i32 s38, s26, 160
    v_exp_f32 v48, v48
    v_exp_f32 v49, v49
    v_exp_f32 v50, v50
    v_exp_f32 v51, v51
    v_cvt_pk_bf16_f32 v102, v44, v45
    v_cvt_pk_bf16_f32 v103, v46, v47
    v_mfma_f32_32x32x16_bf16 v[32:47], a[16:19], v[104:107], 0
    buffer_store_dwordx4 v[156:159], v123, s[20:23], s63 offen sc1
    v_exp_f32 v52, v52
    v_exp_f32 v53, v53
    v_exp_f32 v54, v54
    v_exp_f32 v55, v55
    v_cvt_pk_bf16_f32 v96, v48, v49
    v_cvt_pk_bf16_f32 v97, v50, v51
    v_mfma_f32_32x32x8_bf16 v[32:47], a[72:73], v[112:113], v[32:47]
    v_exp_f32 v56, v56
    v_exp_f32 v57, v57
    v_exp_f32 v58, v58
    v_exp_f32 v59, v59
    v_cvt_pk_bf16_f32 v98, v52, v53
    v_cvt_pk_bf16_f32 v99, v54, v55
    v_mfma_f32_32x32x16_bf16 v[64:79], a[124:127], v[100:103], v[64:79]
    s_add_u32 s39, s36, s38
    v_exp_f32 v60, v60
    v_exp_f32 v61, v61
    v_exp_f32 v62, v62
    v_exp_f32 v63, v63
    v_cvt_pk_bf16_f32 v100, v56, v57
    v_cvt_pk_bf16_f32 v101, v58, v59
    v_mfma_f32_32x32x16_bf16 v[80:95], a[120:123], v[96:99], v[80:95]
    s_lshl_b32 s41, s37, 5
    v_exp_f32 v32, v32
    v_exp_f32 v33, v33
    v_exp_f32 v34, v34
    v_exp_f32 v35, v35
    v_cvt_pk_bf16_f32 v102, v60, v61
    v_cvt_pk_bf16_f32 v103, v62, v63
    v_mfma_f32_32x32x16_bf16 v[48:63], a[16:19], v[108:111], 0
    s_add_u32 s41, s41, s39
    v_exp_f32 v36, v36
    v_exp_f32 v37, v37
    v_exp_f32 v38, v38
    v_exp_f32 v39, v39
    v_cvt_pk_bf16_f32 v96, v32, v33
    v_cvt_pk_bf16_f32 v97, v34, v35
    v_mfma_f32_32x32x8_bf16 v[48:63], a[72:73], v[114:115], v[48:63]
    v_exp_f32 v40, v40
    v_exp_f32 v41, v41
    v_exp_f32 v42, v42
    v_exp_f32 v43, v43
    v_cvt_pk_bf16_f32 v98, v36, v37
    v_cvt_pk_bf16_f32 v99, v38, v39
    v_mfma_f32_32x32x16_bf16 v[80:95], a[124:127], v[100:103], v[80:95]
    s_lshl_b32 s38, s34, 10
    v_exp_f32 v44, v44
    v_exp_f32 v45, v45
    v_exp_f32 v46, v46
    v_exp_f32 v47, v47
    v_cvt_pk_bf16_f32 v100, v40, v41
    v_cvt_pk_bf16_f32 v101, v42, v43
    v_mfma_f32_32x32x16_bf16 v[64:79], a[128:131], v[96:99], v[64:79]
    s_add_u32 s89, s89, s24
    v_exp_f32 v48, v48
    v_exp_f32 v49, v49
    v_exp_f32 v50, v50
    v_exp_f32 v51, v51
    v_cvt_pk_bf16_f32 v102, v44, v45
    v_cvt_pk_bf16_f32 v103, v46, v47
    v_mfma_f32_32x32x16_bf16 v[32:47], a[20:23], v[104:107], 0
    s_min_u32 s89, s89, 119
    v_exp_f32 v52, v52
    v_exp_f32 v53, v53
    v_exp_f32 v54, v54
    v_exp_f32 v55, v55
    v_cvt_pk_bf16_f32 v96, v48, v49
    v_cvt_pk_bf16_f32 v97, v50, v51
    v_mfma_f32_32x32x8_bf16 v[32:47], a[74:75], v[112:113], v[32:47]
    v_exp_f32 v56, v56
    v_exp_f32 v57, v57
    v_exp_f32 v58, v58
    v_exp_f32 v59, v59
    v_cvt_pk_bf16_f32 v98, v52, v53
    v_cvt_pk_bf16_f32 v99, v54, v55
    v_mfma_f32_32x32x16_bf16 v[64:79], a[132:135], v[100:103], v[64:79]
    s_mul_i32 s78, s89, 4370
    v_exp_f32 v60, v60
    v_exp_f32 v61, v61
    v_exp_f32 v62, v62
    v_exp_f32 v63, v63
    v_cvt_pk_bf16_f32 v100, v56, v57
    v_cvt_pk_bf16_f32 v101, v58, v59
    v_mfma_f32_32x32x16_bf16 v[80:95], a[128:131], v[96:99], v[80:95]
    s_lshr_b32 s78, s78, 16
    v_exp_f32 v32, v32
    v_exp_f32 v33, v33
    v_exp_f32 v34, v34
    v_exp_f32 v35, v35
    v_cvt_pk_bf16_f32 v102, v60, v61
    v_cvt_pk_bf16_f32 v103, v62, v63
    v_mfma_f32_32x32x16_bf16 v[48:63], a[20:23], v[108:111], 0
    s_mul_i32 s78, s78, 122880
    v_exp_f32 v36, v36
    v_exp_f32 v37, v37
    v_exp_f32 v38, v38
    v_exp_f32 v39, v39
    v_cvt_pk_bf16_f32 v96, v32, v33
    v_cvt_pk_bf16_f32 v97, v34, v35
    v_mfma_f32_32x32x8_bf16 v[48:63], a[74:75], v[114:115], v[48:63]
    v_exp_f32 v40, v40
    v_exp_f32 v41, v41
    v_exp_f32 v42, v42
    v_exp_f32 v43, v43
    v_cvt_pk_bf16_f32 v98, v36, v37
    v_cvt_pk_bf16_f32 v99, v38, v39
    v_mfma_f32_32x32x16_bf16 v[80:95], a[132:135], v[100:103], v[80:95]
    s_lshl_b32 s89, s89, 13
    v_exp_f32 v44, v44
    v_exp_f32 v45, v45
    v_exp_f32 v46, v46
    v_exp_f32 v47, v47
    v_cvt_pk_bf16_f32 v100, v40, v41
    v_cvt_pk_bf16_f32 v101, v42, v43
    v_mfma_f32_32x32x16_bf16 v[64:79], a[136:139], v[96:99], v[64:79]
    s_add_u32 s78, s78, s89
    v_exp_f32 v48, v48
    v_exp_f32 v49, v49
    v_exp_f32 v50, v50
    v_exp_f32 v51, v51
    v_cvt_pk_bf16_f32 v102, v44, v45
    v_cvt_pk_bf16_f32 v103, v46, v47
    v_mfma_f32_32x32x16_bf16 v[32:47], a[24:27], v[104:107], 0
    s_add_u32 s78, s78, 21266432
    v_exp_f32 v52, v52
    v_exp_f32 v53, v53
    v_exp_f32 v54, v54
    v_exp_f32 v55, v55
    v_cvt_pk_bf16_f32 v96, v48, v49
    v_cvt_pk_bf16_f32 v97, v50, v51
    v_mfma_f32_32x32x8_bf16 v[32:47], a[76:77], v[112:113], v[32:47]
    v_exp_f32 v56, v56
    v_exp_f32 v57, v57
    v_exp_f32 v58, v58
    v_exp_f32 v59, v59
    v_cvt_pk_bf16_f32 v98, v52, v53
    v_cvt_pk_bf16_f32 v99, v54, v55
    v_mfma_f32_32x32x16_bf16 v[64:79], a[140:143], v[100:103], v[64:79]
    s_lshr_b32 s92, s30, 1
    v_exp_f32 v60, v60
    v_exp_f32 v61, v61
    v_exp_f32 v62, v62
    v_exp_f32 v63, v63
    v_cvt_pk_bf16_f32 v100, v56, v57
    v_cvt_pk_bf16_f32 v101, v58, v59
    v_mfma_f32_32x32x16_bf16 v[80:95], a[136:139], v[96:99], v[80:95]
    s_mul_i32 s92, s92, 983040
    v_exp_f32 v32, v32
    v_exp_f32 v33, v33
    v_exp_f32 v34, v34
    v_exp_f32 v35, v35
    v_cvt_pk_bf16_f32 v102, v60, v61
    v_cvt_pk_bf16_f32 v103, v62, v63
    v_mfma_f32_32x32x16_bf16 v[48:63], a[24:27], v[108:111], 0
    s_add_u32 s89, s89, s92
    v_exp_f32 v36, v36
    v_exp_f32 v37, v37
    v_exp_f32 v38, v38
    v_exp_f32 v39, v39
    v_cvt_pk_bf16_f32 v96, v32, v33
    v_cvt_pk_bf16_f32 v97, v34, v35
    v_mfma_f32_32x32x8_bf16 v[48:63], a[76:77], v[114:115], v[48:63]
    v_exp_f32 v40, v40
    v_exp_f32 v41, v41
    v_exp_f32 v42, v42
    v_exp_f32 v43, v43
    v_cvt_pk_bf16_f32 v98, v36, v37
    v_cvt_pk_bf16_f32 v99, v38, v39
    v_mfma_f32_32x32x16_bf16 v[80:95], a[140:143], v[100:103], v[80:95]
    s_add_u32 s89, s89, 23232512
    v_exp_f32 v44, v44
    v_exp_f32 v45, v45
    v_exp_f32 v46, v46
    v_exp_f32 v47, v47
    v_cvt_pk_bf16_f32 v100, v40, v41
    v_cvt_pk_bf16_f32 v101, v42, v43
    v_mfma_f32_32x32x16_bf16 v[64:79], a[144:147], v[96:99], v[64:79]
    s_mul_i32 s86, s24, 25600
    v_exp_f32 v48, v48
    v_exp_f32 v49, v49
    v_exp_f32 v50, v50
    v_exp_f32 v51, v51
    v_cvt_pk_bf16_f32 v102, v44, v45
    v_cvt_pk_bf16_f32 v103, v46, v47
    v_mfma_f32_32x32x16_bf16 v[32:47], a[28:31], v[104:107], 0
    s_mul_i32 s87, s26, 102400
    v_exp_f32 v52, v52
    v_exp_f32 v53, v53
    v_exp_f32 v54, v54
    v_exp_f32 v55, v55
    v_cvt_pk_bf16_f32 v96, v48, v49
    v_cvt_pk_bf16_f32 v97, v50, v51
    v_mfma_f32_32x32x8_bf16 v[32:47], a[78:79], v[112:113], v[32:47]
    v_exp_f32 v56, v56
    v_exp_f32 v57, v57
    v_exp_f32 v58, v58
    v_exp_f32 v59, v59
    v_cvt_pk_bf16_f32 v98, v52, v53
    v_cvt_pk_bf16_f32 v99, v54, v55
    v_mfma_f32_32x32x16_bf16 v[64:79], a[148:151], v[100:103], v[64:79]
    s_add_u32 s87, s87, s86
    v_exp_f32 v60, v60
    v_exp_f32 v61, v61
    v_exp_f32 v62, v62
    v_exp_f32 v63, v63
    v_cvt_pk_bf16_f32 v100, v56, v57
    v_cvt_pk_bf16_f32 v101, v58, v59
    v_mfma_f32_32x32x16_bf16 v[80:95], a[144:147], v[96:99], v[80:95]
    s_add_u32 s87, s87, 20447232
    v_exp_f32 v32, v32
    v_exp_f32 v33, v33
    v_exp_f32 v34, v34
    v_exp_f32 v35, v35
    v_cvt_pk_bf16_f32 v102, v60, v61
    v_cvt_pk_bf16_f32 v103, v62, v63
    v_mfma_f32_32x32x16_bf16 v[48:63], a[28:31], v[108:111], 0
    s_lshr_b32 s88, s30, 1
    v_exp_f32 v36, v36
    v_exp_f32 v37, v37
    v_exp_f32 v38, v38
    v_exp_f32 v39, v39
    v_cvt_pk_bf16_f32 v96, v32, v33
    v_cvt_pk_bf16_f32 v97, v34, v35
    v_mfma_f32_32x32x8_bf16 v[48:63], a[78:79], v[114:115], v[48:63]
    v_exp_f32 v40, v40
    v_exp_f32 v41, v41
    v_exp_f32 v42, v42
    v_exp_f32 v43, v43
    v_cvt_pk_bf16_f32 v98, v36, v37
    v_cvt_pk_bf16_f32 v99, v38, v39
    v_mfma_f32_32x32x16_bf16 v[80:95], a[148:151], v[100:103], v[80:95]
    s_lshl_b32 s88, s88, 2
    v_exp_f32 v44, v44
    v_exp_f32 v45, v45
    v_exp_f32 v46, v46
    v_exp_f32 v47, v47
    v_cvt_pk_bf16_f32 v100, v40, v41
    v_cvt_pk_bf16_f32 v101, v42, v43
    v_mfma_f32_32x32x16_bf16 v[64:79], a[152:155], v[96:99], v[64:79]
    s_lshr_b32 s92, s31, 3
    v_exp_f32 v48, v48
    v_exp_f32 v49, v49
    v_exp_f32 v50, v50
    v_exp_f32 v51, v51
    v_cvt_pk_bf16_f32 v102, v44, v45
    v_cvt_pk_bf16_f32 v103, v46, v47
    v_mfma_f32_32x32x16_bf16 v[32:47], a[32:35], v[104:107], 0
    s_add_u32 s88, s88, s92
    v_exp_f32 v52, v52
    v_exp_f32 v53, v53
    v_exp_f32 v54, v54
    v_exp_f32 v55, v55
    v_cvt_pk_bf16_f32 v96, v48, v49
    v_cvt_pk_bf16_f32 v97, v50, v51
    v_mfma_f32_32x32x8_bf16 v[32:47], a[80:81], v[112:113], v[32:47]
    v_exp_f32 v56, v56
    v_exp_f32 v57, v57
    v_exp_f32 v58, v58
    v_exp_f32 v59, v59
    v_cvt_pk_bf16_f32 v98, v52, v53
    v_cvt_pk_bf16_f32 v99, v54, v55
    v_mfma_f32_32x32x16_bf16 v[64:79], a[156:159], v[100:103], v[64:79]
    s_mul_i32 s88, s88, 6
    v_exp_f32 v60, v60
    v_exp_f32 v61, v61
    v_exp_f32 v62, v62
    v_exp_f32 v63, v63
    v_cvt_pk_bf16_f32 v100, v56, v57
    v_cvt_pk_bf16_f32 v101, v58, v59
    v_mfma_f32_32x32x16_bf16 v[80:95], a[152:155], v[96:99], v[80:95]
    s_lshr_b32 s88, s88, 2
    v_exp_f32 v32, v32
    v_exp_f32 v33, v33
    v_exp_f32 v34, v34
    v_exp_f32 v35, v35
    v_cvt_pk_bf16_f32 v102, v60, v61
    v_cvt_pk_bf16_f32 v103, v62, v63
    v_mfma_f32_32x32x16_bf16 v[48:63], a[32:35], v[108:111], 0
    s_mul_i32 s88, s88, 10240
    v_exp_f32 v36, v36
    v_exp_f32 v37, v37
    v_exp_f32 v38, v38
    v_exp_f32 v39, v39
    v_cvt_pk_bf16_f32 v96, v32, v33
    v_cvt_pk_bf16_f32 v97, v34, v35
    v_mfma_f32_32x32x8_bf16 v[48:63], a[80:81], v[114:115], v[48:63]
    v_exp_f32 v40, v40
    v_exp_f32 v41, v41
    v_exp_f32 v42, v42
    v_exp_f32 v43, v43
    v_cvt_pk_bf16_f32 v98, v36, v37
    v_cvt_pk_bf16_f32 v99, v38, v39
    v_mfma_f32_32x32x16_bf16 v[80:95], a[156:159], v[100:103], v[80:95]
    s_mul_i32 s92, s24, 2560
    v_exp_f32 v44, v44
    v_exp_f32 v45, v45
    v_exp_f32 v46, v46
    v_exp_f32 v47, v47
    v_cvt_pk_bf16_f32 v100, v40, v41
    v_cvt_pk_bf16_f32 v101, v42, v43
    v_mfma_f32_32x32x16_bf16 v[64:79], a[160:163], v[96:99], v[64:79]
    s_add_u32 s88, s88, s92
    v_exp_f32 v48, v48
    v_exp_f32 v49, v49
    v_exp_f32 v50, v50
    v_exp_f32 v51, v51
    v_cvt_pk_bf16_f32 v102, v44, v45
    v_cvt_pk_bf16_f32 v103, v46, v47
    v_mfma_f32_32x32x16_bf16 v[32:47], a[36:39], v[104:107], 0
    s_waitcnt vmcnt(0) lgkmcnt(0)
    v_exp_f32 v52, v52
    v_exp_f32 v53, v53
    v_exp_f32 v54, v54
    v_exp_f32 v55, v55
    v_cvt_pk_bf16_f32 v96, v48, v49
    v_cvt_pk_bf16_f32 v97, v50, v51
    v_mfma_f32_32x32x8_bf16 v[32:47], a[82:83], v[112:113], v[32:47]
    v_exp_f32 v56, v56
    v_exp_f32 v57, v57
    v_exp_f32 v58, v58
    v_exp_f32 v59, v59
    v_cvt_pk_bf16_f32 v98, v52, v53
    v_cvt_pk_bf16_f32 v99, v54, v55
    v_mfma_f32_32x32x16_bf16 v[64:79], a[164:167], v[100:103], v[64:79]
    s_barrier
    v_exp_f32 v60, v60
    v_exp_f32 v61, v61
    v_exp_f32 v62, v62
    v_exp_f32 v63, v63
    v_cvt_pk_bf16_f32 v100, v56, v57
    v_cvt_pk_bf16_f32 v101, v58, v59
    v_mfma_f32_32x32x16_bf16 v[80:95], a[160:163], v[96:99], v[80:95]
    buffer_atomic_add v22, v23, s[20:23], s53 offen sc1
    v_exp_f32 v32, v32
    v_exp_f32 v33, v33
    v_exp_f32 v34, v34
    v_exp_f32 v35, v35
    v_cvt_pk_bf16_f32 v102, v60, v61
    v_cvt_pk_bf16_f32 v103, v62, v63
    v_mfma_f32_32x32x16_bf16 v[48:63], a[36:39], v[108:111], 0
    ds_read_b128 v[160:163], v251 offset:24576
    v_exp_f32 v36, v36
    v_exp_f32 v37, v37
    v_exp_f32 v38, v38
    v_exp_f32 v39, v39
    v_cvt_pk_bf16_f32 v96, v32, v33
    v_cvt_pk_bf16_f32 v97, v34, v35
    v_mfma_f32_32x32x8_bf16 v[48:63], a[82:83], v[114:115], v[48:63]
    v_exp_f32 v40, v40
    v_exp_f32 v41, v41
    v_exp_f32 v42, v42
    v_exp_f32 v43, v43
    v_cvt_pk_bf16_f32 v98, v36, v37
    v_cvt_pk_bf16_f32 v99, v38, v39
    v_mfma_f32_32x32x16_bf16 v[80:95], a[164:167], v[100:103], v[80:95]
    ds_read_b128 v[164:167], v251 offset:25600
    v_exp_f32 v44, v44
    v_exp_f32 v45, v45
    v_exp_f32 v46, v46
    v_exp_f32 v47, v47
    v_cvt_pk_bf16_f32 v100, v40, v41
    v_cvt_pk_bf16_f32 v101, v42, v43
    v_mfma_f32_32x32x16_bf16 v[64:79], a[168:171], v[96:99], v[64:79]
    ds_read_b128 v[168:171], v251 offset:26624
    v_exp_f32 v48, v48
    v_exp_f32 v49, v49
    v_exp_f32 v50, v50
    v_exp_f32 v51, v51
    v_cvt_pk_bf16_f32 v102, v44, v45
    v_cvt_pk_bf16_f32 v103, v46, v47
    v_mfma_f32_32x32x16_bf16 v[32:47], a[40:43], v[104:107], 0
    ds_read_b128 v[176:179], v251 offset:27648
    v_exp_f32 v52, v52
    v_exp_f32 v53, v53
    v_exp_f32 v54, v54
    v_exp_f32 v55, v55
    v_cvt_pk_bf16_f32 v96, v48, v49
    v_cvt_pk_bf16_f32 v97, v50, v51
    v_mfma_f32_32x32x8_bf16 v[32:47], a[84:85], v[112:113], v[32:47]
    v_exp_f32 v56, v56
    v_exp_f32 v57, v57
    v_exp_f32 v58, v58
    v_exp_f32 v59, v59
    v_cvt_pk_bf16_f32 v98, v52, v53
    v_cvt_pk_bf16_f32 v99, v54, v55
    v_mfma_f32_32x32x16_bf16 v[64:79], a[172:175], v[100:103], v[64:79]
    ds_read_b128 v[180:183], v251 offset:28672
    v_exp_f32 v60, v60
    v_exp_f32 v61, v61
    v_exp_f32 v62, v62
    v_exp_f32 v63, v63
    v_cvt_pk_bf16_f32 v100, v56, v57
    v_cvt_pk_bf16_f32 v101, v58, v59
    v_mfma_f32_32x32x16_bf16 v[80:95], a[168:171], v[96:99], v[80:95]
    ds_read_b128 v[184:187], v251 offset:29696
    v_exp_f32 v32, v32
    v_exp_f32 v33, v33
    v_exp_f32 v34, v34
    v_exp_f32 v35, v35
    v_cvt_pk_bf16_f32 v102, v60, v61
    v_cvt_pk_bf16_f32 v103, v62, v63
    v_mfma_f32_32x32x16_bf16 v[48:63], a[40:43], v[108:111], 0
    s_add_u32 s88, s88, 27418624
    v_exp_f32 v36, v36
    v_exp_f32 v37, v37
    v_exp_f32 v38, v38
    v_exp_f32 v39, v39
    v_cvt_pk_bf16_f32 v96, v32, v33
    v_cvt_pk_bf16_f32 v97, v34, v35
    v_mfma_f32_32x32x8_bf16 v[48:63], a[84:85], v[114:115], v[48:63]
    v_exp_f32 v40, v40
    v_exp_f32 v41, v41
    v_exp_f32 v42, v42
    v_exp_f32 v43, v43
    v_cvt_pk_bf16_f32 v98, v36, v37
    v_cvt_pk_bf16_f32 v99, v38, v39
    v_mfma_f32_32x32x16_bf16 v[80:95], a[172:175], v[100:103], v[80:95]
    s_add_u32 s28, s36, s38
    v_exp_f32 v44, v44
    v_exp_f32 v45, v45
    v_exp_f32 v46, v46
    v_exp_f32 v47, v47
    v_cvt_pk_bf16_f32 v100, v40, v41
    v_cvt_pk_bf16_f32 v101, v42, v43
    v_mfma_f32_32x32x16_bf16 v[64:79], a[176:179], v[96:99], v[64:79]
    s_add_u32 s28, s28, 7864320
    v_exp_f32 v48, v48
    v_exp_f32 v49, v49
    v_exp_f32 v50, v50
    v_exp_f32 v51, v51
    v_cvt_pk_bf16_f32 v102, v44, v45
    v_cvt_pk_bf16_f32 v103, v46, v47
    v_mfma_f32_32x32x16_bf16 v[32:47], a[44:47], v[104:107], 0
    buffer_load_dwordx4 v[216:219], v30, s[12:15], s41 offen offset:0
    v_exp_f32 v52, v52
    v_exp_f32 v53, v53
    v_exp_f32 v54, v54
    v_exp_f32 v55, v55
    v_cvt_pk_bf16_f32 v96, v48, v49
    v_cvt_pk_bf16_f32 v97, v50, v51
    v_mfma_f32_32x32x8_bf16 v[32:47], a[86:87], v[112:113], v[32:47]
    v_exp_f32 v56, v56
    v_exp_f32 v57, v57
    v_exp_f32 v58, v58
    v_exp_f32 v59, v59
    v_cvt_pk_bf16_f32 v98, v52, v53
    v_cvt_pk_bf16_f32 v99, v54, v55
    v_mfma_f32_32x32x16_bf16 v[64:79], a[180:183], v[100:103], v[64:79]
    s_and_b32 s52, s30, 1
    v_exp_f32 v60, v60
    v_exp_f32 v61, v61
    v_exp_f32 v62, v62
    v_exp_f32 v63, v63
    v_cvt_pk_bf16_f32 v100, v56, v57
    v_cvt_pk_bf16_f32 v101, v58, v59
    v_mfma_f32_32x32x16_bf16 v[80:95], a[176:179], v[96:99], v[80:95]
    s_and_b32 s42, s31, 7
    v_exp_f32 v32, v32
    v_exp_f32 v33, v33
    v_exp_f32 v34, v34
    v_exp_f32 v35, v35
    v_cvt_pk_bf16_f32 v102, v60, v61
    v_cvt_pk_bf16_f32 v103, v62, v63
    v_mfma_f32_32x32x16_bf16 v[48:63], a[44:47], v[108:111], 0
    buffer_load_dwordx4 v[220:223], v30, s[12:15], s41 offen offset:32
    v_exp_f32 v36, v36
    v_exp_f32 v37, v37
    v_exp_f32 v38, v38
    v_exp_f32 v39, v39
    v_cvt_pk_bf16_f32 v96, v32, v33
    v_cvt_pk_bf16_f32 v97, v34, v35
    v_mfma_f32_32x32x8_bf16 v[48:63], a[86:87], v[114:115], v[48:63]
    v_exp_f32 v40, v40
    v_exp_f32 v41, v41
    v_exp_f32 v42, v42
    v_exp_f32 v43, v43
    v_cvt_pk_bf16_f32 v98, v36, v37
    v_cvt_pk_bf16_f32 v99, v38, v39
    v_mfma_f32_32x32x16_bf16 v[80:95], a[180:183], v[100:103], v[80:95]
    s_lshl3_add_u32 s52, s52, s42
    v_exp_f32 v44, v44
    v_exp_f32 v45, v45
    v_exp_f32 v46, v46
    v_exp_f32 v47, v47
    v_cvt_pk_bf16_f32 v100, v40, v41
    v_cvt_pk_bf16_f32 v101, v42, v43
    v_mfma_f32_32x32x16_bf16 v[64:79], a[184:187], v[96:99], v[64:79]
    s_lshr_b32 s59, s30, 1
    v_exp_f32 v48, v48
    v_exp_f32 v49, v49
    v_exp_f32 v50, v50
    v_exp_f32 v51, v51
    v_cvt_pk_bf16_f32 v102, v44, v45
    v_cvt_pk_bf16_f32 v103, v46, v47
    v_mfma_f32_32x32x16_bf16 v[32:47], a[48:51], v[104:107], 0
    buffer_load_dwordx4 v[224:227], v30, s[12:15], s41 offen offset:64
    v_exp_f32 v52, v52
    v_exp_f32 v53, v53
    v_exp_f32 v54, v54
    v_exp_f32 v55, v55
    v_cvt_pk_bf16_f32 v96, v48, v49
    v_cvt_pk_bf16_f32 v97, v50, v51
    v_mfma_f32_32x32x8_bf16 v[32:47], a[88:89], v[112:113], v[32:47]
    v_exp_f32 v56, v56
    v_exp_f32 v57, v57
    v_exp_f32 v58, v58
    v_exp_f32 v59, v59
    v_cvt_pk_bf16_f32 v98, v52, v53
    v_cvt_pk_bf16_f32 v99, v54, v55
    v_mfma_f32_32x32x16_bf16 v[64:79], a[188:191], v[100:103], v[64:79]
    s_lshr_b32 s42, s31, 3
    v_exp_f32 v60, v60
    v_exp_f32 v61, v61
    v_exp_f32 v62, v62
    v_exp_f32 v63, v63
    v_cvt_pk_bf16_f32 v100, v56, v57
    v_cvt_pk_bf16_f32 v101, v58, v59
    v_mfma_f32_32x32x16_bf16 v[80:95], a[184:187], v[96:99], v[80:95]
    s_lshl2_add_u32 s59, s59, s42
    v_exp_f32 v32, v32
    v_exp_f32 v33, v33
    v_exp_f32 v34, v34
    v_exp_f32 v35, v35
    v_cvt_pk_bf16_f32 v102, v60, v61
    v_cvt_pk_bf16_f32 v103, v62, v63
    v_mfma_f32_32x32x16_bf16 v[48:63], a[48:51], v[108:111], 0
    s_lshl2_add_u32 s54, s52, s24
    v_exp_f32 v36, v36
    v_exp_f32 v37, v37
    v_exp_f32 v38, v38
    v_exp_f32 v39, v39
    v_cvt_pk_bf16_f32 v96, v32, v33
    v_cvt_pk_bf16_f32 v97, v34, v35
    v_mfma_f32_32x32x8_bf16 v[48:63], a[88:89], v[114:115], v[48:63]
    v_exp_f32 v40, v40
    v_exp_f32 v41, v41
    v_exp_f32 v42, v42
    v_exp_f32 v43, v43
    v_cvt_pk_bf16_f32 v98, v36, v37
    v_cvt_pk_bf16_f32 v99, v38, v39
    v_mfma_f32_32x32x16_bf16 v[80:95], a[188:191], v[100:103], v[80:95]
    s_lshl_b32 s35, s24, 12
    v_exp_f32 v44, v44
    v_exp_f32 v45, v45
    v_exp_f32 v46, v46
    v_exp_f32 v47, v47
    v_cvt_pk_bf16_f32 v100, v40, v41
    v_cvt_pk_bf16_f32 v101, v42, v43
    v_mfma_f32_32x32x16_bf16 v[64:79], a[192:195], v[96:99], v[64:79]
    s_mul_i32 s29, s59, 245760
    v_exp_f32 v48, v48
    v_exp_f32 v49, v49
    v_exp_f32 v50, v50
    v_exp_f32 v51, v51
    v_cvt_pk_bf16_f32 v102, v44, v45
    v_cvt_pk_bf16_f32 v103, v46, v47
    v_mfma_f32_32x32x16_bf16 v[32:47], a[52:55], v[104:107], 0
    s_add_u32 s29, s29, 23232512
    v_exp_f32 v52, v52
    v_exp_f32 v53, v53
    v_exp_f32 v54, v54
    v_exp_f32 v55, v55
    v_cvt_pk_bf16_f32 v96, v48, v49
    v_cvt_pk_bf16_f32 v97, v50, v51
    v_mfma_f32_32x32x8_bf16 v[32:47], a[90:91], v[112:113], v[32:47]
    v_exp_f32 v56, v56
    v_exp_f32 v57, v57
    v_exp_f32 v58, v58
    v_exp_f32 v59, v59
    v_cvt_pk_bf16_f32 v98, v52, v53
    v_cvt_pk_bf16_f32 v99, v54, v55
    v_mfma_f32_32x32x16_bf16 v[64:79], a[196:199], v[100:103], v[64:79]
    v_exp_f32 v60, v60
    v_exp_f32 v61, v61
    v_exp_f32 v62, v62
    v_exp_f32 v63, v63
    v_cvt_pk_bf16_f32 v100, v56, v57
    v_cvt_pk_bf16_f32 v101, v58, v59
    v_mfma_f32_32x32x16_bf16 v[80:95], a[192:195], v[96:99], v[80:95]
    v_exp_f32 v32, v32
    v_exp_f32 v33, v33
    v_exp_f32 v34, v34
    v_exp_f32 v35, v35
    v_cvt_pk_bf16_f32 v102, v60, v61
    v_cvt_pk_bf16_f32 v103, v62, v63
    v_mfma_f32_32x32x16_bf16 v[48:63], a[52:55], v[108:111], 0
    v_exp_f32 v36, v36
    v_exp_f32 v37, v37
    v_exp_f32 v38, v38
    v_exp_f32 v39, v39
    v_cvt_pk_bf16_f32 v96, v32, v33
    v_cvt_pk_bf16_f32 v97, v34, v35
    v_mfma_f32_32x32x8_bf16 v[48:63], a[90:91], v[114:115], v[48:63]
    v_exp_f32 v40, v40
    v_exp_f32 v41, v41
    v_exp_f32 v42, v42
    v_exp_f32 v43, v43
    v_cvt_pk_bf16_f32 v98, v36, v37
    v_cvt_pk_bf16_f32 v99, v38, v39
    v_mfma_f32_32x32x16_bf16 v[80:95], a[196:199], v[100:103], v[80:95]
    v_exp_f32 v44, v44
    v_exp_f32 v45, v45
    v_exp_f32 v46, v46
    v_exp_f32 v47, v47
    v_cvt_pk_bf16_f32 v100, v40, v41
    v_cvt_pk_bf16_f32 v101, v42, v43
    v_mfma_f32_32x32x16_bf16 v[64:79], a[200:203], v[96:99], v[64:79]
    v_exp_f32 v48, v48
    v_exp_f32 v49, v49
    v_exp_f32 v50, v50
    v_exp_f32 v51, v51
    v_cvt_pk_bf16_f32 v102, v44, v45
    v_cvt_pk_bf16_f32 v103, v46, v47
    v_mfma_f32_32x32x16_bf16 v[32:47], a[56:59], v[104:107], 0
    v_exp_f32 v52, v52
    v_exp_f32 v53, v53
    v_exp_f32 v54, v54
    v_exp_f32 v55, v55
    v_cvt_pk_bf16_f32 v96, v48, v49
    v_cvt_pk_bf16_f32 v97, v50, v51
    v_mfma_f32_32x32x8_bf16 v[32:47], a[92:93], v[112:113], v[32:47]
    v_exp_f32 v56, v56
    v_exp_f32 v57, v57
    v_exp_f32 v58, v58
    v_exp_f32 v59, v59
    v_cvt_pk_bf16_f32 v98, v52, v53
    v_cvt_pk_bf16_f32 v99, v54, v55
    v_mfma_f32_32x32x16_bf16 v[64:79], a[204:207], v[100:103], v[64:79]
    v_exp_f32 v60, v60
    v_exp_f32 v61, v61
    v_exp_f32 v62, v62
    v_exp_f32 v63, v63
    v_cvt_pk_bf16_f32 v100, v56, v57
    v_cvt_pk_bf16_f32 v101, v58, v59
    v_mfma_f32_32x32x16_bf16 v[80:95], a[200:203], v[96:99], v[80:95]
    v_exp_f32 v32, v32
    v_exp_f32 v33, v33
    v_exp_f32 v34, v34
    v_exp_f32 v35, v35
    v_cvt_pk_bf16_f32 v102, v60, v61
    v_cvt_pk_bf16_f32 v103, v62, v63
    v_mfma_f32_32x32x16_bf16 v[48:63], a[56:59], v[108:111], 0
    v_exp_f32 v36, v36
    v_exp_f32 v37, v37
    v_exp_f32 v38, v38
    v_exp_f32 v39, v39
    v_cvt_pk_bf16_f32 v96, v32, v33
    v_cvt_pk_bf16_f32 v97, v34, v35
    v_mfma_f32_32x32x8_bf16 v[48:63], a[92:93], v[114:115], v[48:63]
    v_exp_f32 v40, v40
    v_exp_f32 v41, v41
    v_exp_f32 v42, v42
    v_exp_f32 v43, v43
    v_cvt_pk_bf16_f32 v98, v36, v37
    v_cvt_pk_bf16_f32 v99, v38, v39
    v_mfma_f32_32x32x16_bf16 v[80:95], a[204:207], v[100:103], v[80:95]
    v_exp_f32 v44, v44
    v_exp_f32 v45, v45
    v_exp_f32 v46, v46
    v_exp_f32 v47, v47
    v_cvt_pk_bf16_f32 v100, v40, v41
    v_cvt_pk_bf16_f32 v101, v42, v43
    v_mfma_f32_32x32x16_bf16 v[64:79], a[208:211], v[96:99], v[64:79]
    v_exp_f32 v48, v48
    v_exp_f32 v49, v49
    v_exp_f32 v50, v50
    v_exp_f32 v51, v51
    v_cvt_pk_bf16_f32 v102, v44, v45
    v_cvt_pk_bf16_f32 v103, v46, v47
    v_mfma_f32_32x32x16_bf16 v[32:47], a[60:63], v[104:107], 0
    buffer_load_dword v20, v21, s[20:23], s47 offen sc0 sc1
    v_exp_f32 v52, v52
    v_exp_f32 v53, v53
    v_exp_f32 v54, v54
    v_exp_f32 v55, v55
    v_cvt_pk_bf16_f32 v96, v48, v49
    v_cvt_pk_bf16_f32 v97, v50, v51
    v_mfma_f32_32x32x8_bf16 v[32:47], a[94:95], v[112:113], v[32:47]
    v_exp_f32 v56, v56
    v_exp_f32 v57, v57
    v_exp_f32 v58, v58
    v_exp_f32 v59, v59
    v_cvt_pk_bf16_f32 v98, v52, v53
    v_cvt_pk_bf16_f32 v99, v54, v55
    v_mfma_f32_32x32x16_bf16 v[64:79], a[212:215], v[100:103], v[64:79]
    ds_read_b128 v[104:107], v255
    v_exp_f32 v60, v60
    v_exp_f32 v61, v61
    v_exp_f32 v62, v62
    v_exp_f32 v63, v63
    v_cvt_pk_bf16_f32 v100, v56, v57
    v_cvt_pk_bf16_f32 v101, v58, v59
    v_mfma_f32_32x32x16_bf16 v[80:95], a[208:211], v[96:99], v[80:95]
    ds_read_b64 v[112:113], v255 offset:2048
    v_exp_f32 v32, v32
    v_exp_f32 v33, v33
    v_exp_f32 v34, v34
    v_exp_f32 v35, v35
    v_cvt_pk_bf16_f32 v102, v60, v61
    v_cvt_pk_bf16_f32 v103, v62, v63
    v_mfma_f32_32x32x16_bf16 v[48:63], a[60:63], v[108:111], 0
    v_exp_f32 v36, v36
    v_exp_f32 v37, v37
    v_exp_f32 v38, v38
    v_exp_f32 v39, v39
    v_cvt_pk_bf16_f32 v96, v32, v33
    v_cvt_pk_bf16_f32 v97, v34, v35
    v_mfma_f32_32x32x8_bf16 v[48:63], a[94:95], v[114:115], v[48:63]
    v_exp_f32 v40, v40
    v_exp_f32 v41, v41
    v_exp_f32 v42, v42
    v_exp_f32 v43, v43
    v_cvt_pk_bf16_f32 v98, v36, v37
    v_cvt_pk_bf16_f32 v99, v38, v39
    v_mfma_f32_32x32x16_bf16 v[80:95], a[212:215], v[100:103], v[80:95]
    ds_read_b128 v[108:111], v255 offset:1024
    v_exp_f32 v44, v44
    v_exp_f32 v45, v45
    v_exp_f32 v46, v46
    v_exp_f32 v47, v47
    v_cvt_pk_bf16_f32 v100, v40, v41
    v_cvt_pk_bf16_f32 v101, v42, v43
    v_mfma_f32_32x32x16_bf16 v[64:79], a[216:219], v[96:99], v[64:79]
    s_waitcnt lgkmcnt(1)
    v_exp_f32 v48, v48
    v_exp_f32 v49, v49
    v_exp_f32 v50, v50
    v_exp_f32 v51, v51
    v_cvt_pk_bf16_f32 v102, v44, v45
    v_cvt_pk_bf16_f32 v103, v46, v47
    v_mfma_f32_32x32x16_bf16 v[32:47], a[0:3], v[104:107], 0
    ds_read_b64 v[114:115], v255 offset:2056
    v_exp_f32 v52, v52
    v_exp_f32 v53, v53
    v_exp_f32 v54, v54
    v_exp_f32 v55, v55
    v_cvt_pk_bf16_f32 v96, v48, v49
    v_cvt_pk_bf16_f32 v97, v50, v51
    v_mfma_f32_32x32x8_bf16 v[32:47], a[64:65], v[112:113], v[32:47]
    v_exp_f32 v56, v56
    v_exp_f32 v57, v57
    v_exp_f32 v58, v58
    v_exp_f32 v59, v59
    v_cvt_pk_bf16_f32 v98, v52, v53
    v_cvt_pk_bf16_f32 v99, v54, v55
    v_mfma_f32_32x32x16_bf16 v[64:79], a[220:223], v[100:103], v[64:79]
    v_exp_f32 v60, v60
    v_exp_f32 v61, v61
    v_exp_f32 v62, v62
    v_exp_f32 v63, v63
    v_cvt_pk_bf16_f32 v100, v56, v57
    v_cvt_pk_bf16_f32 v101, v58, v59
    v_mfma_f32_32x32x16_bf16 v[80:95], a[216:219], v[96:99], v[80:95]
    s_waitcnt lgkmcnt(0)
    v_exp_f32 v32, v32
    v_exp_f32 v33, v33
    v_exp_f32 v34, v34
    v_exp_f32 v35, v35
    v_cvt_pk_bf16_f32 v102, v60, v61
    v_cvt_pk_bf16_f32 v103, v62, v63
    v_mfma_f32_32x32x16_bf16 v[48:63], a[0:3], v[108:111], 0
    s_add_u32 s90, s29, s35
    v_exp_f32 v36, v36
    v_exp_f32 v37, v37
    v_exp_f32 v38, v38
    v_exp_f32 v39, v39
    v_cvt_pk_bf16_f32 v96, v32, v33
    v_cvt_pk_bf16_f32 v97, v34, v35
    v_mfma_f32_32x32x8_bf16 v[48:63], a[64:65], v[114:115], v[48:63]
    v_exp_f32 v40, v40
    v_exp_f32 v41, v41
    v_exp_f32 v42, v42
    v_exp_f32 v43, v43
    v_cvt_pk_bf16_f32 v98, v36, v37
    v_cvt_pk_bf16_f32 v99, v38, v39
    v_mfma_f32_32x32x16_bf16 v[80:95], a[220:223], v[100:103], v[80:95]
    s_lshl3_add_u32 s55, s25, s26
    v_exp_f32 v44, v44
    v_exp_f32 v45, v45
    v_exp_f32 v46, v46
    v_exp_f32 v47, v47
    v_cvt_pk_bf16_f32 v100, v40, v41
    v_cvt_pk_bf16_f32 v101, v42, v43
    v_mfma_f32_32x32x16_bf16 v[160:175], a[96:99], v[96:99], v[160:175]
    s_lshl_b32 s55, s55, 7
    v_exp_f32 v48, v48
    v_exp_f32 v49, v49
    v_exp_f32 v50, v50
    v_exp_f32 v51, v51
    v_cvt_pk_bf16_f32 v102, v44, v45
    v_cvt_pk_bf16_f32 v103, v46, v47
    v_mfma_f32_32x32x16_bf16 v[32:47], a[4:7], v[104:107], 0
    ds_write_b128 v250, v[64:67] offset:0
    v_exp_f32 v52, v52
    v_exp_f32 v53, v53
    v_exp_f32 v54, v54
    v_exp_f32 v55, v55
    v_cvt_pk_bf16_f32 v96, v48, v49
    v_cvt_pk_bf16_f32 v97, v50, v51
    v_mfma_f32_32x32x8_bf16 v[32:47], a[66:67], v[112:113], v[32:47]
    v_exp_f32 v56, v56
    v_exp_f32 v57, v57
    v_exp_f32 v58, v58
    v_exp_f32 v59, v59
    v_cvt_pk_bf16_f32 v98, v52, v53
    v_cvt_pk_bf16_f32 v99, v54, v55
    v_mfma_f32_32x32x16_bf16 v[160:175], a[100:103], v[100:103], v[160:175]
    s_lshl_b32 s56, s52, 11
    v_exp_f32 v60, v60
    v_exp_f32 v61, v61
    v_exp_f32 v62, v62
    v_exp_f32 v63, v63
    v_cvt_pk_bf16_f32 v100, v56, v57
    v_cvt_pk_bf16_f32 v101, v58, v59
    v_mfma_f32_32x32x16_bf16 v[176:191], a[96:99], v[96:99], v[176:191]
    s_mul_i32 s57, s27, 40
    v_exp_f32 v32, v32
    v_exp_f32 v33, v33
    v_exp_f32 v34, v34
    v_exp_f32 v35, v35
    v_cvt_pk_bf16_f32 v102, v60, v61
    v_cvt_pk_bf16_f32 v103, v62, v63
    v_mfma_f32_32x32x16_bf16 v[48:63], a[4:7], v[108:111], 0
    ds_write_b128 v250, v[68:71] offset:1024
    v_exp_f32 v36, v36
    v_exp_f32 v37, v37
    v_exp_f32 v38, v38
    v_exp_f32 v39, v39
    v_cvt_pk_bf16_f32 v96, v32, v33
    v_cvt_pk_bf16_f32 v97, v34, v35
    v_mfma_f32_32x32x8_bf16 v[48:63], a[66:67], v[114:115], v[48:63]
    v_exp_f32 v40, v40
    v_exp_f32 v41, v41
    v_exp_f32 v42, v42
    v_exp_f32 v43, v43
    v_cvt_pk_bf16_f32 v98, v36, v37
    v_cvt_pk_bf16_f32 v99, v38, v39
    v_mfma_f32_32x32x16_bf16 v[176:191], a[100:103], v[100:103], v[176:191]
    s_mul_i32 s38, s26, 5
    v_exp_f32 v44, v44
    v_exp_f32 v45, v45
    v_exp_f32 v46, v46
    v_exp_f32 v47, v47
    v_cvt_pk_bf16_f32 v100, v40, v41
    v_cvt_pk_bf16_f32 v101, v42, v43
    v_mfma_f32_32x32x16_bf16 v[160:175], a[104:107], v[96:99], v[160:175]
    s_add_u32 s57, s57, s38
    v_exp_f32 v48, v48
    v_exp_f32 v49, v49
    v_exp_f32 v50, v50
    v_exp_f32 v51, v51
    v_cvt_pk_bf16_f32 v102, v44, v45
    v_cvt_pk_bf16_f32 v103, v46, v47
    v_mfma_f32_32x32x16_bf16 v[32:47], a[8:11], v[104:107], 0
    ds_write_b128 v250, v[72:75] offset:2048
    v_exp_f32 v52, v52
    v_exp_f32 v53, v53
    v_exp_f32 v54, v54
    v_exp_f32 v55, v55
    v_cvt_pk_bf16_f32 v96, v48, v49
    v_cvt_pk_bf16_f32 v97, v50, v51
    v_mfma_f32_32x32x8_bf16 v[32:47], a[68:69], v[112:113], v[32:47]
    v_exp_f32 v56, v56
    v_exp_f32 v57, v57
    v_exp_f32 v58, v58
    v_exp_f32 v59, v59
    v_cvt_pk_bf16_f32 v98, v52, v53
    v_cvt_pk_bf16_f32 v99, v54, v55
    v_mfma_f32_32x32x16_bf16 v[160:175], a[108:111], v[100:103], v[160:175]
    s_add_u32 s57, s57, s37
    v_exp_f32 v60, v60
    v_exp_f32 v61, v61
    v_exp_f32 v62, v62
    v_exp_f32 v63, v63
    v_cvt_pk_bf16_f32 v100, v56, v57
    v_cvt_pk_bf16_f32 v101, v58, v59
    v_mfma_f32_32x32x16_bf16 v[176:191], a[104:107], v[96:99], v[176:191]
    s_lshl_b32 s57, s57, 10
    v_exp_f32 v32, v32
    v_exp_f32 v33, v33
    v_exp_f32 v34, v34
    v_exp_f32 v35, v35
    v_cvt_pk_bf16_f32 v102, v60, v61
    v_cvt_pk_bf16_f32 v103, v62, v63
    v_mfma_f32_32x32x16_bf16 v[48:63], a[8:11], v[108:111], 0
    ds_write_b128 v250, v[80:83] offset:3072
    v_exp_f32 v36, v36
    v_exp_f32 v37, v37
    v_exp_f32 v38, v38
    v_exp_f32 v39, v39
    v_cvt_pk_bf16_f32 v96, v32, v33
    v_cvt_pk_bf16_f32 v97, v34, v35
    v_mfma_f32_32x32x8_bf16 v[48:63], a[68:69], v[114:115], v[48:63]
    v_exp_f32 v40, v40
    v_exp_f32 v41, v41
    v_exp_f32 v42, v42
    v_exp_f32 v43, v43
    v_cvt_pk_bf16_f32 v98, v36, v37
    v_cvt_pk_bf16_f32 v99, v38, v39
    v_mfma_f32_32x32x16_bf16 v[176:191], a[108:111], v[100:103], v[176:191]
    s_waitcnt vmcnt(0)
    v_exp_f32 v44, v44
    v_exp_f32 v45, v45
    v_exp_f32 v46, v46
    v_exp_f32 v47, v47
    v_cvt_pk_bf16_f32 v100, v40, v41
    v_cvt_pk_bf16_f32 v101, v42, v43
    v_mfma_f32_32x32x16_bf16 v[160:175], a[112:115], v[96:99], v[160:175]
    v_cmp_le_u32 vcc, 32, v20
    s_nop 0
    s_cmp_eq_u64 vcc, -1
    s_cbranch_scc0 L_wslow
L_wok:
    v_exp_f32 v48, v48
    v_exp_f32 v49, v49
    v_exp_f32 v50, v50
    v_exp_f32 v51, v51
    v_cvt_pk_bf16_f32 v102, v44, v45
    v_cvt_pk_bf16_f32 v103, v46, v47
    v_mfma_f32_32x32x16_bf16 v[32:47], a[12:15], v[104:107], 0
    ds_write_b128 v250, v[84:87] offset:4096
    v_exp_f32 v52, v52
    v_exp_f32 v53, v53
    v_exp_f32 v54, v54
    v_exp_f32 v55, v55
    v_cvt_pk_bf16_f32 v96, v48, v49
    v_cvt_pk_bf16_f32 v97, v50, v51
    v_mfma_f32_32x32x8_bf16 v[32:47], a[70:71], v[112:113], v[32:47]
    v_exp_f32 v56, v56
    v_exp_f32 v57, v57
    v_exp_f32 v58, v58
    v_exp_f32 v59, v59
    v_cvt_pk_bf16_f32 v98, v52, v53
    v_cvt_pk_bf16_f32 v99, v54, v55
    v_mfma_f32_32x32x16_bf16 v[160:175], a[116:119], v[100:103], v[160:175]
    buffer_load_dwordx4 v[228:231], v28, s[20:23], s88 offen offset:0 sc1
    v_exp_f32 v60, v60
    v_exp_f32 v61, v61
    v_exp_f32 v62, v62
    v_exp_f32 v63, v63
    v_cvt_pk_bf16_f32 v100, v56, v57
    v_cvt_pk_bf16_f32 v101, v58, v59
    v_mfma_f32_32x32x16_bf16 v[176:191], a[112:115], v[96:99], v[176:191]
    buffer_load_dwordx4 v[232:235], v28, s[20:23], s88 offen offset:512 sc1
    v_exp_f32 v32, v32
    v_exp_f32 v33, v33
    v_exp_f32 v34, v34
    v_exp_f32 v35, v35
    v_cvt_pk_bf16_f32 v102, v60, v61
    v_cvt_pk_bf16_f32 v103, v62, v63
    v_mfma_f32_32x32x16_bf16 v[48:63], a[12:15], v[108:111], 0
    ds_write_b128 v250, v[88:91] offset:5120
    v_exp_f32 v36, v36
    v_exp_f32 v37, v37
    v_exp_f32 v38, v38
    v_exp_f32 v39, v39
    v_cvt_pk_bf16_f32 v96, v32, v33
    v_cvt_pk_bf16_f32 v97, v34, v35
    v_mfma_f32_32x32x8_bf16 v[48:63], a[70:71], v[114:115], v[48:63]
    v_exp_f32 v40, v40
    v_exp_f32 v41, v41
    v_exp_f32 v42, v42
    v_exp_f32 v43, v43
    v_cvt_pk_bf16_f32 v98, v36, v37
    v_cvt_pk_bf16_f32 v99, v38, v39
    v_mfma_f32_32x32x16_bf16 v[176:191], a[116:119], v[100:103], v[176:191]
    buffer_load_dwordx4 v[236:239], v28, s[20:23], s88 offen offset:1024 sc1
    v_exp_f32 v44, v44
    v_exp_f32 v45, v45
    v_exp_f32 v46, v46
    v_exp_f32 v47, v47
    v_cvt_pk_bf16_f32 v100, v40, v41
    v_cvt_pk_bf16_f32 v101, v42, v43
    v_mfma_f32_32x32x16_bf16 v[160:175], a[120:123], v[96:99], v[160:175]
    buffer_load_dwordx4 v[240:243], v28, s[20:23], s88 offen offset:1536 sc1
    v_exp_f32 v48, v48
    v_exp_f32 v49, v49
    v_exp_f32 v50, v50
    v_exp_f32 v51, v51
    v_cvt_pk_bf16_f32 v102, v44, v45
    v_cvt_pk_bf16_f32 v103, v46, v47
    v_mfma_f32_32x32x16_bf16 v[32:47], a[16:19], v[104:107], 0
    buffer_load_dwordx4 v[244:247], v28, s[20:23], s88 offen offset:2048 sc1
    v_exp_f32 v52, v52
    v_exp_f32 v53, v53
    v_exp_f32 v54, v54
    v_exp_f32 v55, v55
    v_cvt_pk_bf16_f32 v96, v48, v49
    v_cvt_pk_bf16_f32 v97, v50, v51
    v_mfma_f32_32x32x8_bf16 v[32:47], a[72:73], v[112:113], v[32:47]
    v_exp_f32 v56, v56
    v_exp_f32 v57, v57
    v_exp_f32 v58, v58
    v_exp_f32 v59, v59
    v_cvt_pk_bf16_f32 v98, v52, v53
    v_cvt_pk_bf16_f32 v99, v54, v55
    v_mfma_f32_32x32x16_bf16 v[160:175], a[124:127], v[100:103], v[160:175]
    s_add_u32 m0, s86, 0
    v_exp_f32 v60, v60
    v_exp_f32 v61, v61
    v_exp_f32 v62, v62
    v_exp_f32 v63, v63
    v_cvt_pk_bf16_f32 v100, v56, v57
    v_cvt_pk_bf16_f32 v101, v58, v59
    v_mfma_f32_32x32x16_bf16 v[176:191], a[120:123], v[96:99], v[176:191]
    s_add_u32 s46, s87, 0
    v_exp_f32 v32, v32
    v_exp_f32 v33, v33
    v_exp_f32 v34, v34
    v_exp_f32 v35, v35
    v_cvt_pk_bf16_f32 v102, v60, v61
    v_cvt_pk_bf16_f32 v103, v62, v63
    v_mfma_f32_32x32x16_bf16 v[48:63], a[16:19], v[108:111], 0
    buffer_load_dwordx4 v5, s[20:23], s46 offen sc1 lds
    v_exp_f32 v36, v36
    v_exp_f32 v37, v37
    v_exp_f32 v38, v38
    v_exp_f32 v39, v39
    v_cvt_pk_bf16_f32 v96, v32, v33
    v_cvt_pk_bf16_f32 v97, v34, v35
    v_mfma_f32_32x32x8_bf16 v[48:63], a[72:73], v[114:115], v[48:63]
    v_exp_f32 v40, v40
    v_exp_f32 v41, v41
    v_exp_f32 v42, v42
    v_exp_f32 v43, v43
    v_cvt_pk_bf16_f32 v98, v36, v37
    v_cvt_pk_bf16_f32 v99, v38, v39
    v_mfma_f32_32x32x16_bf16 v[176:191], a[124:127], v[100:103], v[176:191]
    buffer_load_dwordx4 v5, s[20:23], s46 offen offset:1024 sc1 lds
    v_exp_f32 v44, v44
    v_exp_f32 v45, v45
    v_exp_f32 v46, v46
    v_exp_f32 v47, v47
    v_cvt_pk_bf16_f32 v100, v40, v41
    v_cvt_pk_bf16_f32 v101, v42, v43
    v_mfma_f32_32x32x16_bf16 v[160:175], a[128:131], v[96:99], v[160:175]
    buffer_load_dwordx4 v5, s[20:23], s46 offen offset:2048 sc1 lds
    v_exp_f32 v48, v48
    v_exp_f32 v49, v49
    v_exp_f32 v50, v50
    v_exp_f32 v51, v51
    v_cvt_pk_bf16_f32 v102, v44, v45
    v_cvt_pk_bf16_f32 v103, v46, v47
    v_mfma_f32_32x32x16_bf16 v[32:47], a[20:23], v[104:107], 0
    s_waitcnt lgkmcnt(0)
    v_exp_f32 v52, v52
    v_exp_f32 v53, v53
    v_exp_f32 v54, v54
    v_exp_f32 v55, v55
    v_cvt_pk_bf16_f32 v96, v48, v49
    v_cvt_pk_bf16_f32 v97, v50, v51
    v_mfma_f32_32x32x8_bf16 v[32:47], a[74:75], v[112:113], v[32:47]
    v_exp_f32 v56, v56
    v_exp_f32 v57, v57
    v_exp_f32 v58, v58
    v_exp_f32 v59, v59
    v_cvt_pk_bf16_f32 v98, v52, v53
    v_cvt_pk_bf16_f32 v99, v54, v55
    v_mfma_f32_32x32x16_bf16 v[160:175], a[132:135], v[100:103], v[160:175]
    s_barrier
    v_exp_f32 v60, v60
    v_exp_f32 v61, v61
    v_exp_f32 v62, v62
    v_exp_f32 v63, v63
    v_cvt_pk_bf16_f32 v100, v56, v57
    v_cvt_pk_bf16_f32 v101, v58, v59
    v_mfma_f32_32x32x16_bf16 v[176:191], a[128:131], v[96:99], v[176:191]
    ds_read_b128 v[192:195], v251 offset:0
    v_exp_f32 v32, v32
    v_exp_f32 v33, v33
    v_exp_f32 v34, v34
    v_exp_f32 v35, v35
    v_cvt_pk_bf16_f32 v102, v60, v61
    v_cvt_pk_bf16_f32 v103, v62, v63
    v_mfma_f32_32x32x16_bf16 v[48:63], a[20:23], v[108:111], 0
    ds_read_b128 v[196:199], v251 offset:1024
    v_exp_f32 v36, v36
    v_exp_f32 v37, v37
    v_exp_f32 v38, v38
    v_exp_f32 v39, v39
    v_cvt_pk_bf16_f32 v96, v32, v33
    v_cvt_pk_bf16_f32 v97, v34, v35
    v_mfma_f32_32x32x8_bf16 v[48:63], a[74:75], v[114:115], v[48:63]
    v_exp_f32 v40, v40
    v_exp_f32 v41, v41
    v_exp_f32 v42, v42
    v_exp_f32 v43, v43
    v_cvt_pk_bf16_f32 v98, v36, v37
    v_cvt_pk_bf16_f32 v99, v38, v39
    v_mfma_f32_32x32x16_bf16 v[176:191], a[132:135], v[100:103], v[176:191]
    ds_read_b128 v[200:203], v251 offset:2048
    v_exp_f32 v44, v44
    v_exp_f32 v45, v45
    v_exp_f32 v46, v46
    v_exp_f32 v47, v47
    v_cvt_pk_bf16_f32 v100, v40, v41
    v_cvt_pk_bf16_f32 v101, v42, v43
    v_mfma_f32_32x32x16_bf16 v[160:175], a[136:139], v[96:99], v[160:175]
    ds_read_b128 v[204:207], v251 offset:3072
    v_exp_f32 v48, v48
    v_exp_f32 v49, v49
    v_exp_f32 v50, v50
    v_exp_f32 v51, v51
    v_cvt_pk_bf16_f32 v102, v44, v45
    v_cvt_pk_bf16_f32 v103, v46, v47
    v_mfma_f32_32x32x16_bf16 v[32:47], a[24:27], v[104:107], 0
    ds_read_b128 v[208:211], v251 offset:4096
    v_exp_f32 v52, v52
    v_exp_f32 v53, v53
    v_exp_f32 v54, v54
    v_exp_f32 v55, v55
    v_cvt_pk_bf16_f32 v96, v48, v49
    v_cvt_pk_bf16_f32 v97, v50, v51
    v_mfma_f32_32x32x8_bf16 v[32:47], a[76:77], v[112:113], v[32:47]
    v_exp_f32 v56, v56
    v_exp_f32 v57, v57
    v_exp_f32 v58, v58
    v_exp_f32 v59, v59
    v_cvt_pk_bf16_f32 v98, v52, v53
    v_cvt_pk_bf16_f32 v99, v54, v55
    v_mfma_f32_32x32x16_bf16 v[160:175], a[140:143], v[100:103], v[160:175]
    ds_read_b128 v[212:215], v251 offset:5120
    v_exp_f32 v60, v60
    v_exp_f32 v61, v61
    v_exp_f32 v62, v62
    v_exp_f32 v63, v63
    v_cvt_pk_bf16_f32 v100, v56, v57
    v_cvt_pk_bf16_f32 v101, v58, v59
    v_mfma_f32_32x32x16_bf16 v[176:191], a[136:139], v[96:99], v[176:191]
    buffer_load_dwordx4 v5, s[20:23], s46 offen offset:3072 sc1 lds
    v_exp_f32 v32, v32
    v_exp_f32 v33, v33
    v_exp_f32 v34, v34
    v_exp_f32 v35, v35
    v_cvt_pk_bf16_f32 v102, v60, v61
    v_cvt_pk_bf16_f32 v103, v62, v63
    v_mfma_f32_32x32x16_bf16 v[48:63], a[24:27], v[108:111], 0
    s_add_u32 m0, s86, 4096
    v_exp_f32 v36, v36
    v_exp_f32 v37, v37
    v_exp_f32 v38, v38
    v_exp_f32 v39, v39
    v_cvt_pk_bf16_f32 v96, v32, v33
    v_cvt_pk_bf16_f32 v97, v34, v35
    v_mfma_f32_32x32x8_bf16 v[48:63], a[76:77], v[114:115], v[48:63]
    v_exp_f32 v40, v40
    v_exp_f32 v41, v41
    v_exp_f32 v42, v42
    v_exp_f32 v43, v43
    v_cvt_pk_bf16_f32 v98, v36, v37
    v_cvt_pk_bf16_f32 v99, v38, v39
    v_mfma_f32_32x32x16_bf16 v[176:191], a[140:143], v[100:103], v[176:191]
    s_add_u32 s46, s87, 4096
    v_exp_f32 v44, v44
    v_exp_f32 v45, v45
    v_exp_f32 v46, v46
    v_exp_f32 v47, v47
    v_cvt_pk_bf16_f32 v100, v40, v41
    v_cvt_pk_bf16_f32 v101, v42, v43
    v_mfma_f32_32x32x16_bf16 v[160:175], a[144:147], v[96:99], v[160:175]
    buffer_load_dwordx4 v5, s[20:23], s46 offen sc1 lds
    v_exp_f32 v48, v48
    v_exp_f32 v49, v49
    v_exp_f32 v50, v50
    v_exp_f32 v51, v51
    v_cvt_pk_bf16_f32 v102, v44, v45
    v_cvt_pk_bf16_f32 v103, v46, v47
    v_mfma_f32_32x32x16_bf16 v[32:47], a[28:31], v[104:107], 0
    buffer_load_dwordx4 v5, s[20:23], s46 offen offset:1024 sc1 lds
    v_exp_f32 v52, v52
    v_exp_f32 v53, v53
    v_exp_f32 v54, v54
    v_exp_f32 v55, v55
    v_cvt_pk_bf16_f32 v96, v48, v49
    v_cvt_pk_bf16_f32 v97, v50, v51
    v_mfma_f32_32x32x8_bf16 v[32:47], a[78:79], v[112:113], v[32:47]
    v_exp_f32 v56, v56
    v_exp_f32 v57, v57
    v_exp_f32 v58, v58
    v_exp_f32 v59, v59
    v_cvt_pk_bf16_f32 v98, v52, v53
    v_cvt_pk_bf16_f32 v99, v54, v55
    v_mfma_f32_32x32x16_bf16 v[160:175], a[148:151], v[100:103], v[160:175]
    buffer_load_dwordx4 v5, s[20:23], s46 offen offset:2048 sc1 lds
    v_exp_f32 v60, v60
    v_exp_f32 v61, v61
    v_exp_f32 v62, v62
    v_exp_f32 v63, v63
    v_cvt_pk_bf16_f32 v100, v56, v57
    v_cvt_pk_bf16_f32 v101, v58, v59
    v_mfma_f32_32x32x16_bf16 v[176:191], a[144:147], v[96:99], v[176:191]
    buffer_load_dwordx4 v5, s[20:23], s46 offen offset:3072 sc1 lds
    v_exp_f32 v32, v32
    v_exp_f32 v33, v33
    v_exp_f32 v34, v34
    v_exp_f32 v35, v35
    v_cvt_pk_bf16_f32 v102, v60, v61
    v_cvt_pk_bf16_f32 v103, v62, v63
    v_mfma_f32_32x32x16_bf16 v[48:63], a[28:31], v[108:111], 0
    s_add_u32 m0, s86, 8192
    v_exp_f32 v36, v36
    v_exp_f32 v37, v37
    v_exp_f32 v38, v38
    v_exp_f32 v39, v39
    v_cvt_pk_bf16_f32 v96, v32, v33
    v_cvt_pk_bf16_f32 v97, v34, v35
    v_mfma_f32_32x32x8_bf16 v[48:63], a[78:79], v[114:115], v[48:63]
    v_exp_f32 v40, v40
    v_exp_f32 v41, v41
    v_exp_f32 v42, v42
    v_exp_f32 v43, v43
    v_cvt_pk_bf16_f32 v98, v36, v37
    v_cvt_pk_bf16_f32 v99, v38, v39
    v_mfma_f32_32x32x16_bf16 v[176:191], a[148:151], v[100:103], v[176:191]
    s_add_u32 s46, s87, 8192
    v_exp_f32 v44, v44
    v_exp_f32 v45, v45
    v_exp_f32 v46, v46
    v_exp_f32 v47, v47
    v_cvt_pk_bf16_f32 v100, v40, v41
    v_cvt_pk_bf16_f32 v101, v42, v43
    v_mfma_f32_32x32x16_bf16 v[160:175], a[152:155], v[96:99], v[160:175]
    buffer_load_dwordx4 v5, s[20:23], s46 offen sc1 lds
    v_exp_f32 v48, v48
    v_exp_f32 v49, v49
    v_exp_f32 v50, v50
    v_exp_f32 v51, v51
    v_cvt_pk_bf16_f32 v102, v44, v45
    v_cvt_pk_bf16_f32 v103, v46, v47
    v_mfma_f32_32x32x16_bf16 v[32:47], a[32:35], v[104:107], 0
    buffer_load_dwordx4 v5, s[20:23], s46 offen offset:1024 sc1 lds
    v_exp_f32 v52, v52
    v_exp_f32 v53, v53
    v_exp_f32 v54, v54
    v_exp_f32 v55, v55
    v_cvt_pk_bf16_f32 v96, v48, v49
    v_cvt_pk_bf16_f32 v97, v50, v51
    v_mfma_f32_32x32x8_bf16 v[32:47], a[80:81], v[112:113], v[32:47]
    v_exp_f32 v56, v56
    v_exp_f32 v57, v57
    v_exp_f32 v58, v58
    v_exp_f32 v59, v59
    v_cvt_pk_bf16_f32 v98, v52, v53
    v_cvt_pk_bf16_f32 v99, v54, v55
    v_mfma_f32_32x32x16_bf16 v[160:175], a[156:159], v[100:103], v[160:175]
    buffer_load_dwordx4 v5, s[20:23], s46 offen offset:2048 sc1 lds
    v_exp_f32 v60, v60
    v_exp_f32 v61, v61
    v_exp_f32 v62, v62
    v_exp_f32 v63, v63
    v_cvt_pk_bf16_f32 v100, v56, v57
    v_cvt_pk_bf16_f32 v101, v58, v59
    v_mfma_f32_32x32x16_bf16 v[176:191], a[152:155], v[96:99], v[176:191]
    buffer_load_dwordx4 v5, s[20:23], s46 offen offset:3072 sc1 lds
    v_exp_f32 v32, v32
    v_exp_f32 v33, v33
    v_exp_f32 v34, v34
    v_exp_f32 v35, v35
    v_cvt_pk_bf16_f32 v102, v60, v61
    v_cvt_pk_bf16_f32 v103, v62, v63
    v_mfma_f32_32x32x16_bf16 v[48:63], a[32:35], v[108:111], 0
    s_add_u32 m0, s86, 12288
    v_exp_f32 v36, v36
    v_exp_f32 v37, v37
    v_exp_f32 v38, v38
    v_exp_f32 v39, v39
    v_cvt_pk_bf16_f32 v96, v32, v33
    v_cvt_pk_bf16_f32 v97, v34, v35
    v_mfma_f32_32x32x8_bf16 v[48:63], a[80:81], v[114:115], v[48:63]
    v_exp_f32 v40, v40
    v_exp_f32 v41, v41
    v_exp_f32 v42, v42
    v_exp_f32 v43, v43
    v_cvt_pk_bf16_f32 v98, v36, v37
    v_cvt_pk_bf16_f32 v99, v38, v39
    v_mfma_f32_32x32x16_bf16 v[176:191], a[156:159], v[100:103], v[176:191]
    s_add_u32 s46, s87, 12288
    v_exp_f32 v44, v44
    v_exp_f32 v45, v45
    v_exp_f32 v46, v46
    v_exp_f32 v47, v47
    v_cvt_pk_bf16_f32 v100, v40, v41
    v_cvt_pk_bf16_f32 v101, v42, v43
    v_mfma_f32_32x32x16_bf16 v[160:175], a[160:163], v[96:99], v[160:175]
    buffer_load_dwordx4 v5, s[20:23], s46 offen sc1 lds
    v_exp_f32 v48, v48
    v_exp_f32 v49, v49
    v_exp_f32 v50, v50
    v_exp_f32 v51, v51
    v_cvt_pk_bf16_f32 v102, v44, v45
    v_cvt_pk_bf16_f32 v103, v46, v47
    v_mfma_f32_32x32x16_bf16 v[32:47], a[36:39], v[104:107], 0
    buffer_load_dwordx4 v5, s[20:23], s46 offen offset:1024 sc1 lds
    v_exp_f32 v52, v52
    v_exp_f32 v53, v53
    v_exp_f32 v54, v54
    v_exp_f32 v55, v55
    v_cvt_pk_bf16_f32 v96, v48, v49
    v_cvt_pk_bf16_f32 v97, v50, v51
    v_mfma_f32_32x32x8_bf16 v[32:47], a[82:83], v[112:113], v[32:47]
    v_exp_f32 v56, v56
    v_exp_f32 v57, v57
    v_exp_f32 v58, v58
    v_exp_f32 v59, v59
    v_cvt_pk_bf16_f32 v98, v52, v53
    v_cvt_pk_bf16_f32 v99, v54, v55
    v_mfma_f32_32x32x16_bf16 v[160:175], a[164:167], v[100:103], v[160:175]
    buffer_load_dwordx4 v5, s[20:23], s46 offen offset:2048 sc1 lds
    v_exp_f32 v60, v60
    v_exp_f32 v61, v61
    v_exp_f32 v62, v62
    v_exp_f32 v63, v63
    v_cvt_pk_bf16_f32 v100, v56, v57
    v_cvt_pk_bf16_f32 v101, v58, v59
    v_mfma_f32_32x32x16_bf16 v[176:191], a[160:163], v[96:99], v[176:191]
    buffer_load_dwordx4 v5, s[20:23], s46 offen offset:3072 sc1 lds
    v_exp_f32 v32, v32
    v_exp_f32 v33, v33
    v_exp_f32 v34, v34
    v_exp_f32 v35, v35
    v_cvt_pk_bf16_f32 v102, v60, v61
    v_cvt_pk_bf16_f32 v103, v62, v63
    v_mfma_f32_32x32x16_bf16 v[48:63], a[36:39], v[108:111], 0
    s_add_u32 m0, s86, 16384
    v_exp_f32 v36, v36
    v_exp_f32 v37, v37
    v_exp_f32 v38, v38
    v_exp_f32 v39, v39
    v_cvt_pk_bf16_f32 v96, v32, v33
    v_cvt_pk_bf16_f32 v97, v34, v35
    v_mfma_f32_32x32x8_bf16 v[48:63], a[82:83], v[114:115], v[48:63]
    v_exp_f32 v40, v40
    v_exp_f32 v41, v41
    v_exp_f32 v42, v42
    v_exp_f32 v43, v43
    v_cvt_pk_bf16_f32 v98, v36, v37
    v_cvt_pk_bf16_f32 v99, v38, v39
    v_mfma_f32_32x32x16_bf16 v[176:191], a[164:167], v[100:103], v[176:191]
    s_add_u32 s46, s87, 16384
    v_exp_f32 v44, v44
    v_exp_f32 v45, v45
    v_exp_f32 v46, v46
    v_exp_f32 v47, v47
    v_cvt_pk_bf16_f32 v100, v40, v41
    v_cvt_pk_bf16_f32 v101, v42, v43
    v_mfma_f32_32x32x16_bf16 v[160:175], a[168:171], v[96:99], v[160:175]
    buffer_load_dwordx4 v5, s[20:23], s46 offen sc1 lds
    v_exp_f32 v48, v48
    v_exp_f32 v49, v49
    v_exp_f32 v50, v50
    v_exp_f32 v51, v51
    v_cvt_pk_bf16_f32 v102, v44, v45
    v_cvt_pk_bf16_f32 v103, v46, v47
    v_mfma_f32_32x32x16_bf16 v[32:47], a[40:43], v[104:107], 0
    buffer_load_dwordx4 v5, s[20:23], s46 offen offset:1024 sc1 lds
    v_exp_f32 v52, v52
    v_exp_f32 v53, v53
    v_exp_f32 v54, v54
    v_exp_f32 v55, v55
    v_cvt_pk_bf16_f32 v96, v48, v49
    v_cvt_pk_bf16_f32 v97, v50, v51
    v_mfma_f32_32x32x8_bf16 v[32:47], a[84:85], v[112:113], v[32:47]
    v_exp_f32 v56, v56
    v_exp_f32 v57, v57
    v_exp_f32 v58, v58
    v_exp_f32 v59, v59
    v_cvt_pk_bf16_f32 v98, v52, v53
    v_cvt_pk_bf16_f32 v99, v54, v55
    v_mfma_f32_32x32x16_bf16 v[160:175], a[172:175], v[100:103], v[160:175]
    buffer_load_dwordx4 v5, s[20:23], s46 offen offset:2048 sc1 lds
    v_exp_f32 v60, v60
    v_exp_f32 v61, v61
    v_exp_f32 v62, v62
    v_exp_f32 v63, v63
    v_cvt_pk_bf16_f32 v100, v56, v57
    v_cvt_pk_bf16_f32 v101, v58, v59
    v_mfma_f32_32x32x16_bf16 v[176:191], a[168:171], v[96:99], v[176:191]
    buffer_load_dwordx4 v5, s[20:23], s46 offen offset:3072 sc1 lds
    v_exp_f32 v32, v32
    v_exp_f32 v33, v33
    v_exp_f32 v34, v34
    v_exp_f32 v35, v35
    v_cvt_pk_bf16_f32 v102, v60, v61
    v_cvt_pk_bf16_f32 v103, v62, v63
    v_mfma_f32_32x32x16_bf16 v[48:63], a[40:43], v[108:111], 0
    s_add_u32 m0, s86, 20480
    v_exp_f32 v36, v36
    v_exp_f32 v37, v37
    v_exp_f32 v38, v38
    v_exp_f32 v39, v39
    v_cvt_pk_bf16_f32 v96, v32, v33
    v_cvt_pk_bf16_f32 v97, v34, v35
    v_mfma_f32_32x32x8_bf16 v[48:63], a[84:85], v[114:115], v[48:63]
    v_exp_f32 v40, v40
    v_exp_f32 v41, v41
    v_exp_f32 v42, v42
    v_exp_f32 v43, v43
    v_cvt_pk_bf16_f32 v98, v36, v37
    v_cvt_pk_bf16_f32 v99, v38, v39
    v_mfma_f32_32x32x16_bf16 v[176:191], a[172:175], v[100:103], v[176:191]
    s_add_u32 s46, s87, 20480
    v_exp_f32 v44, v44
    v_exp_f32 v45, v45
    v_exp_f32 v46, v46
    v_exp_f32 v47, v47
    v_cvt_pk_bf16_f32 v100, v40, v41
    v_cvt_pk_bf16_f32 v101, v42, v43
    v_mfma_f32_32x32x16_bf16 v[160:175], a[176:179], v[96:99], v[160:175]
    buffer_load_dwordx4 v5, s[20:23], s46 offen sc1 lds
    v_exp_f32 v48, v48
    v_exp_f32 v49, v49
    v_exp_f32 v50, v50
    v_exp_f32 v51, v51
    v_cvt_pk_bf16_f32 v102, v44, v45
    v_cvt_pk_bf16_f32 v103, v46, v47
    v_mfma_f32_32x32x16_bf16 v[32:47], a[44:47], v[104:107], 0
    buffer_load_dwordx4 v5, s[20:23], s46 offen offset:1024 sc1 lds
    v_exp_f32 v52, v52
    v_exp_f32 v53, v53
    v_exp_f32 v54, v54
    v_exp_f32 v55, v55
    v_cvt_pk_bf16_f32 v96, v48, v49
    v_cvt_pk_bf16_f32 v97, v50, v51
    v_mfma_f32_32x32x8_bf16 v[32:47], a[86:87], v[112:113], v[32:47]
    v_exp_f32 v56, v56
    v_exp_f32 v57, v57
    v_exp_f32 v58, v58
    v_exp_f32 v59, v59
    v_cvt_pk_bf16_f32 v98, v52, v53
    v_cvt_pk_bf16_f32 v99, v54, v55
    v_mfma_f32_32x32x16_bf16 v[160:175], a[180:183], v[100:103], v[160:175]
    buffer_load_dwordx4 v5, s[20:23], s46 offen offset:2048 sc1 lds
    v_exp_f32 v60, v60
    v_exp_f32 v61, v61
    v_exp_f32 v62, v62
    v_exp_f32 v63, v63
    v_cvt_pk_bf16_f32 v100, v56, v57
    v_cvt_pk_bf16_f32 v101, v58, v59
    v_mfma_f32_32x32x16_bf16 v[176:191], a[176:179], v[96:99], v[176:191]
    buffer_load_dwordx4 v5, s[20:23], s46 offen offset:3072 sc1 lds
    v_exp_f32 v32, v32
    v_exp_f32 v33, v33
    v_exp_f32 v34, v34
    v_exp_f32 v35, v35
    v_cvt_pk_bf16_f32 v102, v60, v61
    v_cvt_pk_bf16_f32 v103, v62, v63
    v_mfma_f32_32x32x16_bf16 v[48:63], a[44:47], v[108:111], 0
    s_add_u32 m0, s86, 24576
    v_exp_f32 v36, v36
    v_exp_f32 v37, v37
    v_exp_f32 v38, v38
    v_exp_f32 v39, v39
    v_cvt_pk_bf16_f32 v96, v32, v33
    v_cvt_pk_bf16_f32 v97, v34, v35
    v_mfma_f32_32x32x8_bf16 v[48:63], a[86:87], v[114:115], v[48:63]
    v_exp_f32 v40, v40
    v_exp_f32 v41, v41
    v_exp_f32 v42, v42
    v_exp_f32 v43, v43
    v_cvt_pk_bf16_f32 v98, v36, v37
    v_cvt_pk_bf16_f32 v99, v38, v39
    v_mfma_f32_32x32x16_bf16 v[176:191], a[180:183], v[100:103], v[176:191]
    s_add_u32 s46, s87, 24576
    v_exp_f32 v44, v44
    v_exp_f32 v45, v45
    v_exp_f32 v46, v46
    v_exp_f32 v47, v47
    v_cvt_pk_bf16_f32 v100, v40, v41
    v_cvt_pk_bf16_f32 v101, v42, v43
    v_mfma_f32_32x32x16_bf16 v[160:175], a[184:187], v[96:99], v[160:175]
    buffer_load_dwordx4 v5, s[20:23], s46 offen sc1 lds
    v_exp_f32 v48, v48
    v_exp_f32 v49, v49
    v_exp_f32 v50, v50
    v_exp_f32 v51, v51
    v_cvt_pk_bf16_f32 v102, v44, v45
    v_cvt_pk_bf16_f32 v103, v46, v47
    v_mfma_f32_32x32x16_bf16 v[32:47], a[48:51], v[104:107], 0
    buffer_load_dword v24, v25, s[20:23], s89 offen sc1
    v_exp_f32 v52, v52
    v_exp_f32 v53, v53
    v_exp_f32 v54, v54
    v_exp_f32 v55, v55
    v_cvt_pk_bf16_f32 v96, v48, v49
    v_cvt_pk_bf16_f32 v97, v50, v51
    v_mfma_f32_32x32x8_bf16 v[32:47], a[88:89], v[112:113], v[32:47]
    v_exp_f32 v56, v56
    v_exp_f32 v57, v57
    v_exp_f32 v58, v58
    v_exp_f32 v59, v59
    v_cvt_pk_bf16_f32 v98, v52, v53
    v_cvt_pk_bf16_f32 v99, v54, v55
    v_mfma_f32_32x32x16_bf16 v[160:175], a[188:191], v[100:103], v[160:175]
    s_add_u32 s57, s57, 10485760
    v_exp_f32 v60, v60
    v_exp_f32 v61, v61
    v_exp_f32 v62, v62
    v_exp_f32 v63, v63
    v_cvt_pk_bf16_f32 v100, v56, v57
    v_cvt_pk_bf16_f32 v101, v58, v59
    v_mfma_f32_32x32x16_bf16 v[176:191], a[184:187], v[96:99], v[176:191]
    s_lshl3_add_u32 s58, s27, s26
    v_exp_f32 v32, v32
    v_exp_f32 v33, v33
    v_exp_f32 v34, v34
    v_exp_f32 v35, v35
    v_cvt_pk_bf16_f32 v102, v60, v61
    v_cvt_pk_bf16_f32 v103, v62, v63
    v_mfma_f32_32x32x16_bf16 v[48:63], a[48:51], v[108:111], 0
    s_lshl_b32 s58, s58, 9
    v_exp_f32 v36, v36
    v_exp_f32 v37, v37
    v_exp_f32 v38, v38
    v_exp_f32 v39, v39
    v_cvt_pk_bf16_f32 v96, v32, v33
    v_cvt_pk_bf16_f32 v97, v34, v35
    v_mfma_f32_32x32x8_bf16 v[48:63], a[88:89], v[114:115], v[48:63]
    v_exp_f32 v40, v40
    v_exp_f32 v41, v41
    v_exp_f32 v42, v42
    v_exp_f32 v43, v43
    v_cvt_pk_bf16_f32 v98, v36, v37
    v_cvt_pk_bf16_f32 v99, v38, v39
    v_mfma_f32_32x32x16_bf16 v[176:191], a[188:191], v[100:103], v[176:191]
    s_lshl3_add_u32 s58, s34, s58
    v_exp_f32 v44, v44
    v_exp_f32 v45, v45
    v_exp_f32 v46, v46
    v_exp_f32 v47, v47
    v_cvt_pk_bf16_f32 v100, v40, v41
    v_cvt_pk_bf16_f32 v101, v42, v43
    v_mfma_f32_32x32x16_bf16 v[160:175], a[192:195], v[96:99], v[160:175]
    s_add_u32 s58, s58, 13107200
    v_exp_f32 v48, v48
    v_exp_f32 v49, v49
    v_exp_f32 v50, v50
    v_exp_f32 v51, v51
    v_cvt_pk_bf16_f32 v102, v44, v45
    v_cvt_pk_bf16_f32 v103, v46, v47
    v_mfma_f32_32x32x16_bf16 v[32:47], a[52:55], v[104:107], 0
    s_lshl_b32 s43, s30, 5
    v_exp_f32 v52, v52
    v_exp_f32 v53, v53
    v_exp_f32 v54, v54
    v_exp_f32 v55, v55
    v_cvt_pk_bf16_f32 v96, v48, v49
    v_cvt_pk_bf16_f32 v97, v50, v51
    v_mfma_f32_32x32x8_bf16 v[32:47], a[90:91], v[112:113], v[32:47]
    v_exp_f32 v56, v56
    v_exp_f32 v57, v57
    v_exp_f32 v58, v58
    v_exp_f32 v59, v59
    v_cvt_pk_bf16_f32 v98, v52, v53
    v_cvt_pk_bf16_f32 v99, v54, v55
    v_mfma_f32_32x32x16_bf16 v[160:175], a[196:199], v[100:103], v[160:175]
    s_add_u32 s43, s43, s31
    v_exp_f32 v60, v60
    v_exp_f32 v61, v61
    v_exp_f32 v62, v62
    v_exp_f32 v63, v63
    v_cvt_pk_bf16_f32 v100, v56, v57
    v_cvt_pk_bf16_f32 v101, v58, v59
    v_mfma_f32_32x32x16_bf16 v[176:191], a[192:195], v[96:99], v[176:191]
    s_lshl_b32 s43, s43, 7
    v_exp_f32 v32, v32
    v_exp_f32 v33, v33
    v_exp_f32 v34, v34
    v_exp_f32 v35, v35
    v_cvt_pk_bf16_f32 v102, v60, v61
    v_cvt_pk_bf16_f32 v103, v62, v63
    v_mfma_f32_32x32x16_bf16 v[48:63], a[52:55], v[108:111], 0
    s_add_u32 s43, s43, 27222016
    v_exp_f32 v36, v36
    v_exp_f32 v37, v37
    v_exp_f32 v38, v38
    v_exp_f32 v39, v39
    v_cvt_pk_bf16_f32 v96, v32, v33
    v_cvt_pk_bf16_f32 v97, v34, v35
    v_mfma_f32_32x32x8_bf16 v[48:63], a[90:91], v[114:115], v[48:63]
    v_exp_f32 v40, v40
    v_exp_f32 v41, v41
    v_exp_f32 v42, v42
    v_exp_f32 v43, v43
    v_cvt_pk_bf16_f32 v98, v36, v37
    v_cvt_pk_bf16_f32 v99, v38, v39
    v_mfma_f32_32x32x16_bf16 v[176:191], a[196:199], v[100:103], v[176:191]
    s_lshl_b32 s40, s26, 12
    v_exp_f32 v44, v44
    v_exp_f32 v45, v45
    v_exp_f32 v46, v46
    v_exp_f32 v47, v47
    v_cvt_pk_bf16_f32 v100, v40, v41
    v_cvt_pk_bf16_f32 v101, v42, v43
    v_mfma_f32_32x32x16_bf16 v[160:175], a[200:203], v[96:99], v[160:175]
    s_add_u32 s40, s40, 27222016
    v_exp_f32 v48, v48
    v_exp_f32 v49, v49
    v_exp_f32 v50, v50
    v_exp_f32 v51, v51
    v_cvt_pk_bf16_f32 v102, v44, v45
    v_cvt_pk_bf16_f32 v103, v46, v47
    v_mfma_f32_32x32x16_bf16 v[32:47], a[56:59], v[104:107], 0
    s_lshl_b32 s42, s24, 10
    v_exp_f32 v52, v52
    v_exp_f32 v53, v53
    v_exp_f32 v54, v54
    v_exp_f32 v55, v55
    v_cvt_pk_bf16_f32 v96, v48, v49
    v_cvt_pk_bf16_f32 v97, v50, v51
    v_mfma_f32_32x32x8_bf16 v[32:47], a[92:93], v[112:113], v[32:47]
    v_exp_f32 v56, v56
    v_exp_f32 v57, v57
    v_exp_f32 v58, v58
    v_exp_f32 v59, v59
    v_cvt_pk_bf16_f32 v98, v52, v53
    v_cvt_pk_bf16_f32 v99, v54, v55
    v_mfma_f32_32x32x16_bf16 v[160:175], a[204:207], v[100:103], v[160:175]
    s_add_u32 s42, s42, 126976
    v_exp_f32 v60, v60
    v_exp_f32 v61, v61
    v_exp_f32 v62, v62
    v_exp_f32 v63, v63
    v_cvt_pk_bf16_f32 v100, v56, v57
    v_cvt_pk_bf16_f32 v101, v58, v59
    v_mfma_f32_32x32x16_bf16 v[176:191], a[200:203], v[96:99], v[176:191]
    v_exp_f32 v32, v32
    v_exp_f32 v33, v33
    v_exp_f32 v34, v34
    v_exp_f32 v35, v35
    v_cvt_pk_bf16_f32 v102, v60, v61
    v_cvt_pk_bf16_f32 v103, v62, v63
    v_mfma_f32_32x32x16_bf16 v[48:63], a[56:59], v[108:111], 0
    v_exp_f32 v36, v36
    v_exp_f32 v37, v37
    v_exp_f32 v38, v38
    v_exp_f32 v39, v39
    v_cvt_pk_bf16_f32 v96, v32, v33
    v_cvt_pk_bf16_f32 v97, v34, v35
    v_mfma_f32_32x32x8_bf16 v[48:63], a[92:93], v[114:115], v[48:63]
    v_exp_f32 v40, v40
    v_exp_f32 v41, v41
    v_exp_f32 v42, v42
    v_exp_f32 v43, v43
    v_cvt_pk_bf16_f32 v98, v36, v37
    v_cvt_pk_bf16_f32 v99, v38, v39
    v_mfma_f32_32x32x16_bf16 v[176:191], a[204:207], v[100:103], v[176:191]
    v_exp_f32 v44, v44
    v_exp_f32 v45, v45
    v_exp_f32 v46, v46
    v_exp_f32 v47, v47
    v_cvt_pk_bf16_f32 v100, v40, v41
    v_cvt_pk_bf16_f32 v101, v42, v43
    v_mfma_f32_32x32x16_bf16 v[160:175], a[208:211], v[96:99], v[160:175]
    v_exp_f32 v48, v48
    v_exp_f32 v49, v49
    v_exp_f32 v50, v50
    v_exp_f32 v51, v51
    v_cvt_pk_bf16_f32 v102, v44, v45
    v_cvt_pk_bf16_f32 v103, v46, v47
    v_mfma_f32_32x32x16_bf16 v[32:47], a[60:63], v[104:107], 0
    v_exp_f32 v52, v52
    v_exp_f32 v53, v53
    v_exp_f32 v54, v54
    v_exp_f32 v55, v55
    v_cvt_pk_bf16_f32 v96, v48, v49
    v_cvt_pk_bf16_f32 v97, v50, v51
    v_mfma_f32_32x32x8_bf16 v[32:47], a[94:95], v[112:113], v[32:47]
    v_exp_f32 v56, v56
    v_exp_f32 v57, v57
    v_exp_f32 v58, v58
    v_exp_f32 v59, v59
    v_cvt_pk_bf16_f32 v98, v52, v53
    v_cvt_pk_bf16_f32 v99, v54, v55
    v_mfma_f32_32x32x16_bf16 v[160:175], a[212:215], v[100:103], v[160:175]
    v_exp_f32 v60, v60
    v_exp_f32 v61, v61
    v_exp_f32 v62, v62
    v_exp_f32 v63, v63
    v_cvt_pk_bf16_f32 v100, v56, v57
    v_cvt_pk_bf16_f32 v101, v58, v59
    v_mfma_f32_32x32x16_bf16 v[176:191], a[208:211], v[96:99], v[176:191]
    v_exp_f32 v32, v32
    v_exp_f32 v33, v33
    v_exp_f32 v34, v34
    v_exp_f32 v35, v35
    v_cvt_pk_bf16_f32 v102, v60, v61
    v_cvt_pk_bf16_f32 v103, v62, v63
    v_mfma_f32_32x32x16_bf16 v[48:63], a[60:63], v[108:111], 0
    v_exp_f32 v36, v36
    v_exp_f32 v37, v37
    v_exp_f32 v38, v38
    v_exp_f32 v39, v39
    v_cvt_pk_bf16_f32 v96, v32, v33
    v_cvt_pk_bf16_f32 v97, v34, v35
    v_mfma_f32_32x32x8_bf16 v[48:63], a[94:95], v[114:115], v[48:63]
    v_exp_f32 v40, v40
    v_exp_f32 v41, v41
    v_exp_f32 v42, v42
    v_exp_f32 v43, v43
    v_cvt_pk_bf16_f32 v98, v36, v37
    v_cvt_pk_bf16_f32 v99, v38, v39
    v_mfma_f32_32x32x16_bf16 v[176:191], a[212:215], v[100:103], v[176:191]
    v_exp_f32 v44, v44
    v_exp_f32 v45, v45
    v_exp_f32 v46, v46
    v_exp_f32 v47, v47
    v_cvt_pk_bf16_f32 v100, v40, v41
    v_cvt_pk_bf16_f32 v101, v42, v43
    v_mfma_f32_32x32x16_bf16 v[160:175], a[216:219], v[96:99], v[160:175]
    s_waitcnt vmcnt(1)
    v_exp_f32 v48, v48
    v_exp_f32 v49, v49
    v_exp_f32 v50, v50
    v_exp_f32 v51, v51
    v_cvt_pk_bf16_f32 v102, v44, v45
    v_cvt_pk_bf16_f32 v103, v46, v47
    v_exp_f32 v52, v52
    v_exp_f32 v53, v53
    v_exp_f32 v54, v54
    v_exp_f32 v55, v55
    v_cvt_pk_bf16_f32 v96, v48, v49
    v_cvt_pk_bf16_f32 v97, v50, v51
    v_exp_f32 v56, v56
    v_exp_f32 v57, v57
    v_exp_f32 v58, v58
    v_exp_f32 v59, v59
    v_cvt_pk_bf16_f32 v98, v52, v53
    v_cvt_pk_bf16_f32 v99, v54, v55
    v_mfma_f32_32x32x16_bf16 v[160:175], a[220:223], v[100:103], v[160:175]
    s_barrier
    v_exp_f32 v60, v60
    v_exp_f32 v61, v61
    v_exp_f32 v62, v62
    v_exp_f32 v63, v63
    v_cvt_pk_bf16_f32 v100, v56, v57
    v_cvt_pk_bf16_f32 v101, v58, v59
    v_mfma_f32_32x32x16_bf16 v[176:191], a[216:219], v[96:99], v[176:191]
    v_cvt_pk_bf16_f32 v102, v60, v61
    v_cvt_pk_bf16_f32 v103, v62, v63
    s_nop 1
    v_mfma_f32_32x32x16_bf16 v[176:191], a[220:223], v[100:103], v[176:191]
    s_waitcnt lgkmcnt(5)
    v_pk_add_f32 v[160:161], v[160:161], v[192:193]
    v_pk_add_f32 v[162:163], v[162:163], v[194:195]
    s_waitcnt lgkmcnt(4)
    v_pk_add_f32 v[164:165], v[164:165], v[196:197]
    v_pk_add_f32 v[166:167], v[166:167], v[198:199]
    s_waitcnt lgkmcnt(3)
    v_pk_add_f32 v[168:169], v[168:169], v[200:201]
    v_pk_add_f32 v[170:171], v[170:171], v[202:203]
    v_mov_b32 v14, v168
    v_mov_b32 v16, v168
    s_nop 1
    v_permlane32_swap_b32 v14, v16
    v_rcp_f32 v18, v16
    s_nop 0
    v_pk_mul_f32 v[192:193], v[160:161], v[18:19] op_sel_hi:[1,0]
    v_pk_mul_f32 v[194:195], v[162:163], v[18:19] op_sel_hi:[1,0]
    v_pk_mul_f32 v[196:197], v[164:165], v[18:19] op_sel_hi:[1,0]
    v_pk_mul_f32 v[198:199], v[166:167], v[18:19] op_sel_hi:[1,0]
    v_pk_mul_f32 v[200:201], v[168:169], v[18:19] op_sel_hi:[1,0]
    v_pk_mul_f32 v[202:203], v[170:171], v[18:19] op_sel_hi:[1,0]
    v_cvt_pk_bf16_f32 v192, v192, v193
    v_cvt_pk_bf16_f32 v193, v194, v195
    v_cvt_pk_bf16_f32 v194, v196, v197
    v_cvt_pk_bf16_f32 v195, v198, v199
    v_cvt_pk_bf16_f32 v196, v200, v201
    v_cvt_pk_bf16_f32 v197, v202, v203
    buffer_store_dwordx4 v[192:195], v5, s[20:23], s64 offen sc1
    buffer_store_dwordx2 v[196:197], v27, s[20:23], s65 offen sc1
    s_waitcnt lgkmcnt(2)
    v_pk_add_f32 v[176:177], v[176:177], v[204:205]
    v_pk_add_f32 v[178:179], v[178:179], v[206:207]
    s_waitcnt lgkmcnt(1)
    v_pk_add_f32 v[180:181], v[180:181], v[208:209]
    v_pk_add_f32 v[182:183], v[182:183], v[210:211]
    s_waitcnt lgkmcnt(0)
    v_pk_add_f32 v[184:185], v[184:185], v[212:213]
    v_pk_add_f32 v[186:187], v[186:187], v[214:215]
    v_mov_b32 v14, v184
    v_mov_b32 v17, v184
    s_nop 1
    v_permlane32_swap_b32 v14, v17
    v_rcp_f32 v18, v17
    s_nop 0
    v_pk_mul_f32 v[204:205], v[176:177], v[18:19] op_sel_hi:[1,0]
    v_pk_mul_f32 v[206:207], v[178:179], v[18:19] op_sel_hi:[1,0]
    v_pk_mul_f32 v[208:209], v[180:181], v[18:19] op_sel_hi:[1,0]
    v_pk_mul_f32 v[210:211], v[182:183], v[18:19] op_sel_hi:[1,0]
    v_pk_mul_f32 v[212:213], v[184:185], v[18:19] op_sel_hi:[1,0]
    v_pk_mul_f32 v[214:215], v[186:187], v[18:19] op_sel_hi:[1,0]
    v_cvt_pk_bf16_f32 v204, v204, v205
    v_cvt_pk_bf16_f32 v205, v206, v207
    v_cvt_pk_bf16_f32 v206, v208, v209
    v_cvt_pk_bf16_f32 v207, v210, v211
    v_cvt_pk_bf16_f32 v208, v212, v213
    v_cvt_pk_bf16_f32 v209, v214, v215
    buffer_store_dwordx4 v[204:207], v5, s[20:23], s66 offen sc1
    buffer_store_dwordx2 v[208:209], v27, s[20:23], s67 offen sc1
    v_and_b32 v14, 15, v2
    v_lshlrev_b32 v14, 4, v14
    v_lshl_add_u32 v14, v6, 8, v14
    s_mul_i32 s38, s34, 2560
    v_add_u32 v14, s38, v14
    v_add_u32 v15, 2048, v14
    v_bfe_u32 v12, v2, 4, 1
    v_lshl_add_u32 v14, v12, 9, v14
    v_add_u32 v20, 51200, v14
    v_add_u32 v21, 51200, v15
    ds_read_b128 a[96:99], v14 offset:0
    ds_read_b128 a[100:103], v14 offset:1024
    ds_read_b128 a[104:107], v15 offset:0
    v_pk_mul_f32 v[18:19], v[160:161], 0
    v_pk_fma_f32 v[18:19], v[162:163], 0, v[18:19]
    ds_read_b128 a[108:111], v14 offset:5120
    ds_read_b128 a[112:115], v14 offset:6144
    ds_read_b128 a[116:119], v15 offset:5120
    v_pk_fma_f32 v[18:19], v[164:165], 0, v[18:19]
    v_pk_fma_f32 v[18:19], v[166:167], 0, v[18:19]
    ds_read_b128 a[120:123], v14 offset:10240
    ds_read_b128 a[124:127], v14 offset:11264
    ds_read_b128 a[128:131], v15 offset:10240
    v_pk_fma_f32 v[18:19], v[168:169], 0, v[18:19]
    v_pk_fma_f32 v[18:19], v[170:171], 0, v[18:19]
    ds_read_b128 a[132:135], v14 offset:15360
    ds_read_b128 a[136:139], v14 offset:16384
    ds_read_b128 a[140:143], v15 offset:15360
    v_pk_fma_f32 v[18:19], v[176:177], 0, v[18:19]
    v_pk_fma_f32 v[18:19], v[178:179], 0, v[18:19]
    ds_read_b128 a[144:147], v14 offset:20480
    ds_read_b128 a[148:151], v14 offset:21504
    ds_read_b128 a[152:155], v15 offset:20480
    v_pk_fma_f32 v[18:19], v[180:181], 0, v[18:19]
    v_pk_fma_f32 v[18:19], v[182:183], 0, v[18:19]
    ds_read_b128 a[156:159], v14 offset:25600
    ds_read_b128 a[160:163], v14 offset:26624
    ds_read_b128 a[164:167], v15 offset:25600
    v_pk_fma_f32 v[18:19], v[184:185], 0, v[18:19]
    v_pk_fma_f32 v[18:19], v[186:187], 0, v[18:19]
    ds_read_b128 a[168:171], v14 offset:30720
    ds_read_b128 a[172:175], v14 offset:31744
    ds_read_b128 a[176:179], v15 offset:30720
    v_cmp_o_f32 s[68:69], v18, v19
    v_max_f32 v18, v16, v17
    ds_read_b128 a[180:183], v14 offset:35840
    ds_read_b128 a[184:187], v14 offset:36864
    ds_read_b128 a[188:191], v15 offset:35840
    v_min_f32 v19, v16, v17
    v_cmp_gt_f32 vcc, 0x71800000, v18
    ds_read_b128 a[192:195], v14 offset:40960
    ds_read_b128 a[196:199], v14 offset:41984
    ds_read_b128 a[200:203], v15 offset:40960
    s_and_b64 s[68:69], s[68:69], vcc
    v_cmp_lt_f32 vcc, 0x21800000, v19
    ds_read_b128 a[204:207], v14 offset:46080
    ds_read_b128 a[208:211], v14 offset:47104
    ds_read_b128 a[212:215], v15 offset:46080
    s_and_b64 s[68:69], s[68:69], vcc
    s_cmp_eq_u64 s[68:69], -1
    ds_read_b128 a[216:219], v20 offset:0
    ds_read_b128 a[220:223], v20 offset:1024
    ds_read_b128 a[224:227], v21 offset:0
    s_cselect_b32 s45, 0, 1
    v_mov_b32 v18, s45
    ds_read_b128 a[228:231], v20 offset:5120
    ds_read_b128 a[232:235], v20 offset:6144
    ds_read_b128 a[236:239], v21 offset:5120
    ds_write_b32 v251, v18
    v_pk_add_f32 v[228:229], v[228:229], v[232:233]
    ds_read_b128 a[240:243], v20 offset:10240
    ds_read_b128 a[244:247], v20 offset:11264
    ds_read_b128 v[80:83], v21 offset:10240
    v_pk_add_f32 v[230:231], v[230:231], v[234:235]
    v_pk_add_f32 v[228:229], v[228:229], v[236:237]
    ds_read_b128 v[84:87], v20 offset:15360
    ds_read_b128 v[88:91], v20 offset:16384
    ds_read_b128 v[92:95], v21 offset:15360
    v_pk_add_f32 v[230:231], v[230:231], v[238:239]
    v_pk_add_f32 v[228:229], v[228:229], v[240:241]
    ds_read_b128 v[96:99], v20 offset:20480
    ds_read_b128 v[100:103], v20 offset:21504
    ds_read_b128 v[104:107], v21 offset:20480
    v_pk_add_f32 v[230:231], v[230:231], v[242:243]
    v_pk_add_f32 v[228:229], v[228:229], v[244:245]
    ds_read_b128 v[108:111], v20 offset:25600
    ds_read_b128 v[112:115], v20 offset:26624
    ds_read_b128 v[116:119], v21 offset:25600
    v_pk_add_f32 v[230:231], v[230:231], v[246:247]
    v_add_u32 v27, s42, v5
    ds_read_b128 v[120:123], v20 offset:30720
    ds_read_b128 v[124:127], v20 offset:31744
    ds_read_b128 v[128:131], v21 offset:30720
    ds_write_b128 v27, v[228:231]
    v_add_u32 v27, 126976, v5
    ds_read_b128 v[132:135], v20 offset:35840
    ds_read_b128 v[136:139], v20 offset:36864
    ds_read_b128 v[140:143], v21 offset:35840
    s_mov_b32 s53, s59
    s_mov_b32 s69, s90
    ds_read_b128 v[144:147], v20 offset:40960
    ds_read_b128 v[148:151], v20 offset:41984
    ds_read_b128 v[152:155], v21 offset:40960
    s_waitcnt lgkmcnt(0)
    s_waitcnt vmcnt(0)
    s_barrier
    ds_read_b32 v26, v26
    s_waitcnt lgkmcnt(0)
    v_cmp_ne_u32 vcc, 0, v26
    s_nop 0
    s_cmp_lg_u64 vcc, 0
    s_cselect_b32 s45, 1, 0
    s_andn2_b32 s45, s45, s71
    s_cbranch_scc1 L_fb
    s_cmp_lg_u32 s24, 0
    s_cbranch_scc1 L_so2
    v_mov_b32 v9, 1
    s_mov_b64 exec, 0xffffffff
    buffer_atomic_add v9, v3, s[20:23], s40 offen sc1
    s_mov_b64 exec, 1
    v_mov_b32 v8, 0
    buffer_atomic_add v8, v1, s[20:23], s43 offen sc0 sc1
    s_mov_b64 exec, -1
    ds_read_b128 v[228:231], v27 offset:0
    ds_read_b128 v[232:235], v27 offset:1024
    ds_read_b128 v[236:239], v27 offset:2048
    ds_read_b128 v[240:243], v27 offset:3072
    s_waitcnt lgkmcnt(2)
    v_pk_add_f32 v[228:229], v[228:229], v[232:233]
    v_pk_add_f32 v[230:231], v[230:231], v[234:235]
    s_waitcnt lgkmcnt(1)
    v_pk_add_f32 v[228:229], v[228:229], v[236:237]
    v_pk_add_f32 v[230:231], v[230:231], v[238:239]
    s_waitcnt lgkmcnt(0)
    v_pk_add_f32 v[228:229], v[228:229], v[240:241]
    v_pk_add_f32 v[230:231], v[230:231], v[242:243]
    v_cvt_pk_bf16_f32 v232, v228, v228
    v_and_b32 v232, 0xffff0000, v232
    v_sub_f32 v228, v228, v232
    v_cvt_pk_bf16_f32 v228, v232, v228
    v_accvgpr_write_b32 a248, v228
    v_accvgpr_write_b32 a249, 0
    v_cvt_pk_bf16_f32 v232, v229, v229
    v_and_b32 v232, 0xffff0000, v232
    v_sub_f32 v229, v229, v232
    v_cvt_pk_bf16_f32 v229, v232, v229
    v_accvgpr_write_b32 a250, v229
    v_accvgpr_write_b32 a251, 0
    v_cvt_pk_bf16_f32 v232, v230, v230
    v_and_b32 v232, 0xffff0000, v232
    v_sub_f32 v230, v230, v232
    v_cvt_pk_bf16_f32 v230, v232, v230
    v_accvgpr_write_b32 a252, v230
    v_accvgpr_write_b32 a253, 0
    v_cvt_pk_bf16_f32 v232, v231, v231
    v_and_b32 v232, 0xffff0000, v232
    v_sub_f32 v231, v231, v232
    v_cvt_pk_bf16_f32 v231, v232, v231
    v_accvgpr_write_b32 a254, v231
    v_accvgpr_write_b32 a255, 0
    ds_read_b128 v[160:163], v20 offset:46080
    ds_read_b128 v[164:167], v20 offset:47104
    ds_read_b128 v[168:171], v21 offset:46080
    s_mul_i32 s38, s24, 6144
    s_add_u32 s38, s38, 102400
    v_add_u32 v30, s38, v5
    s_xor_b32 s38, s24, 2
    s_mul_i32 s38, s38, 6144
    s_add_u32 s38, s38, 102400
    v_add_u32 v31, s38, v5
    s_cmp_eq_u32 s34, 0
    s_cselect_b32 s44, 0xffff0000, 0
    s_cselect_b32 s45, 0, 0xffff0000
    v_lshlrev_b32 v9, 16, v216
    v_and_b32 v32, s44, v9
    v_and_b32 v33, s44, v216
    v_lshlrev_b32 v9, 16, v217
    v_and_b32 v34, s44, v9
    v_and_b32 v35, s44, v217
    v_lshlrev_b32 v9, 16, v218
    v_and_b32 v36, s44, v9
    v_and_b32 v37, s44, v218
    v_lshlrev_b32 v9, 16, v219
    v_and_b32 v38, s44, v9
    v_and_b32 v39, s44, v219
    v_lshlrev_b32 v9, 16, v220
    v_and_b32 v40, s44, v9
    v_and_b32 v41, s44, v220
    v_lshlrev_b32 v9, 16, v221
    v_and_b32 v42, s44, v9
    v_and_b32 v43, s44, v221
    v_lshlrev_b32 v9, 16, v222
    v_and_b32 v44, s44, v9
    v_and_b32 v45, s44, v222
    v_lshlrev_b32 v9, 16, v223
    v_and_b32 v46, s44, v9
    v_and_b32 v47, s44, v223
    v_lshlrev_b32 v9, 16, v224
    v_and_b32 v48, s44, v9
    v_and_b32 v49, s44, v224
    v_lshlrev_b32 v9, 16, v225
    v_and_b32 v50, s44, v9
    v_and_b32 v51, s44, v225
    v_lshlrev_b32 v9, 16, v226
    v_and_b32 v52, s44, v9
    v_and_b32 v53, s44, v226
    v_lshlrev_b32 v9, 16, v227
    v_and_b32 v54, s44, v9
    v_and_b32 v55, s44, v227
    v_lshlrev_b32 v9, 16, v216
    v_and_b32 v56, s45, v9
    v_and_b32 v57, s45, v216
    v_lshlrev_b32 v9, 16, v217
    v_and_b32 v58, s45, v9
    v_and_b32 v59, s45, v217
    v_lshlrev_b32 v9, 16, v218
    v_and_b32 v60, s45, v9
    v_and_b32 v61, s45, v218
    v_lshlrev_b32 v9, 16, v219
    v_and_b32 v62, s45, v9
    v_and_b32 v63, s45, v219
    v_lshlrev_b32 v9, 16, v220
    v_and_b32 v64, s45, v9
    v_and_b32 v65, s45, v220
    v_lshlrev_b32 v9, 16, v221
    v_and_b32 v66, s45, v9
    v_and_b32 v67, s45, v221
    v_lshlrev_b32 v9, 16, v222
    v_and_b32 v68, s45, v9
    v_and_b32 v69, s45, v222
    v_lshlrev_b32 v9, 16, v223
    v_and_b32 v70, s45, v9
    v_and_b32 v71, s45, v223
    v_mov_b32 v72, 0
    v_mov_b32 v73, 0
    v_mov_b32 v74, 0
    v_mov_b32 v75, 0
    v_mov_b32 v76, 0
    v_mov_b32 v77, 0
    v_mov_b32 v78, 0
    v_mov_b32 v79, 0
    s_waitcnt lgkmcnt(0)
    s_mov_b64 exec, 1
    s_mov_b32 s44, 200000
L_pp3:
    s_waitcnt vmcnt(0)
    v_readfirstlane_b32 s45, v8
    s_nop 0
    s_cmp_ge_u32 s45, 32
    s_cbranch_scc1 L_pq3
    v_mov_b32 v8, 0
    buffer_atomic_add v8, v1, s[20:23], s43 offen sc0 sc1
    s_sub_u32 s44, s44, 1
    s_cmp_lg_u32 s44, 0
    s_cbranch_scc1 L_pp3
L_pq3:
    s_mov_b64 exec, -1
    s_branch L_sj2
L_so2:
    s_mul_i32 s91, s24, 10752
    s_add_u32 s91, s91, 0xffffd600
    s_add_u32 s45, s91, s29
    s_add_u32 m0, s91, 0
    s_add_u32 s46, s45, 0
    buffer_load_dwordx4 v5, s[20:23], s46 offen sc1 lds
    buffer_load_dwordx4 v5, s[20:23], s46 offen offset:1024 sc1 lds
    buffer_load_dwordx4 v5, s[20:23], s46 offen offset:2048 sc1 lds
    buffer_load_dwordx4 v5, s[20:23], s46 offen offset:3072 sc1 lds
    s_add_u32 m0, s91, 4096
    s_add_u32 s46, s45, 4096
    buffer_load_dwordx4 v5, s[20:23], s46 offen sc1 lds
    buffer_load_dwordx4 v5, s[20:23], s46 offen offset:1024 sc1 lds
    buffer_load_dwordx4 v5, s[20:23], s46 offen offset:2048 sc1 lds
    buffer_load_dwordx4 v5, s[20:23], s46 offen offset:3072 sc1 lds
    s_add_u32 m0, s91, 8192
    s_add_u32 s46, s45, 8192
    buffer_load_dwordx4 v5, s[20:23], s46 offen sc1 lds
    buffer_load_dwordx4 v5, s[20:23], s46 offen offset:1024 sc1 lds
    buffer_load_dwordx4 v5, s[20:23], s46 offen offset:2048 sc1 lds
    s_cmp_lg_u32 s24, 1
    s_cbranch_scc1 L_wb0
L_wb0:
    s_cmp_lg_u32 s24, 2
    s_cbranch_scc1 L_wb1
L_wb1:
    s_cmp_lg_u32 s24, 3
    s_cbranch_scc1 L_wb2
L_wb2:
    ds_read_b128 v[228:231], v27 offset:0
    ds_read_b128 v[232:235], v27 offset:1024
    ds_read_b128 v[236:239], v27 offset:2048
    ds_read_b128 v[240:243], v27 offset:3072
    s_waitcnt lgkmcnt(2)
    v_pk_add_f32 v[228:229], v[228:229], v[232:233]
    v_pk_add_f32 v[230:231], v[230:231], v[234:235]
    s_waitcnt lgkmcnt(1)
    v_pk_add_f32 v[228:229], v[228:229], v[236:237]
    v_pk_add_f32 v[230:231], v[230:231], v[238:239]
    s_waitcnt lgkmcnt(0)
    v_pk_add_f32 v[228:229], v[228:229], v[240:241]
    v_pk_add_f32 v[230:231], v[230:231], v[242:243]
    v_cvt_pk_bf16_f32 v232, v228, v228
    v_and_b32 v232, 0xffff0000, v232
    v_sub_f32 v228, v228, v232
    v_cvt_pk_bf16_f32 v228, v232, v228
    v_accvgpr_write_b32 a248, v228
    v_accvgpr_write_b32 a249, 0
    v_cvt_pk_bf16_f32 v232, v229, v229
    v_and_b32 v232, 0xffff0000, v232
    v_sub_f32 v229, v229, v232
    v_cvt_pk_bf16_f32 v229, v232, v229
    v_accvgpr_write_b32 a250, v229
    v_accvgpr_write_b32 a251, 0
    v_cvt_pk_bf16_f32 v232, v230, v230
    v_and_b32 v232, 0xffff0000, v232
    v_sub_f32 v230, v230, v232
    v_cvt_pk_bf16_f32 v230, v232, v230
    v_accvgpr_write_b32 a252, v230
    v_accvgpr_write_b32 a253, 0
    v_cvt_pk_bf16_f32 v232, v231, v231
    v_and_b32 v232, 0xffff0000, v232
    v_sub_f32 v231, v231, v232
    v_cvt_pk_bf16_f32 v231, v232, v231
    v_accvgpr_write_b32 a254, v231
    v_accvgpr_write_b32 a255, 0
    ds_read_b128 v[160:163], v20 offset:46080
    ds_read_b128 v[164:167], v20 offset:47104
    ds_read_b128 v[168:171], v21 offset:46080
    s_mul_i32 s38, s24, 6144
    s_add_u32 s38, s38, 102400
    v_add_u32 v30, s38, v5
    s_xor_b32 s38, s24, 2
    s_mul_i32 s38, s38, 6144
    s_add_u32 s38, s38, 102400
    v_add_u32 v31, s38, v5
    s_cmp_eq_u32 s34, 0
    s_cselect_b32 s44, 0xffff0000, 0
    s_cselect_b32 s45, 0, 0xffff0000
    v_lshlrev_b32 v9, 16, v216
    v_and_b32 v32, s44, v9
    v_and_b32 v33, s44, v216
    v_lshlrev_b32 v9, 16, v217
    v_and_b32 v34, s44, v9
    v_and_b32 v35, s44, v217
    v_lshlrev_b32 v9, 16, v218
    v_and_b32 v36, s44, v9
    v_and_b32 v37, s44, v218
    v_lshlrev_b32 v9, 16, v219
    v_and_b32 v38, s44, v9
    v_and_b32 v39, s44, v219
    v_lshlrev_b32 v9, 16, v220
    v_and_b32 v40, s44, v9
    v_and_b32 v41, s44, v220
    v_lshlrev_b32 v9, 16, v221
    v_and_b32 v42, s44, v9
    v_and_b32 v43, s44, v221
    v_lshlrev_b32 v9, 16, v222
    v_and_b32 v44, s44, v9
    v_and_b32 v45, s44, v222
    v_lshlrev_b32 v9, 16, v223
    v_and_b32 v46, s44, v9
    v_and_b32 v47, s44, v223
    v_lshlrev_b32 v9, 16, v224
    v_and_b32 v48, s44, v9
    v_and_b32 v49, s44, v224
    v_lshlrev_b32 v9, 16, v225
    v_and_b32 v50, s44, v9
    v_and_b32 v51, s44, v225
    v_lshlrev_b32 v9, 16, v226
    v_and_b32 v52, s44, v9
    v_and_b32 v53, s44, v226
    v_lshlrev_b32 v9, 16, v227
    v_and_b32 v54, s44, v9
    v_and_b32 v55, s44, v227
    v_lshlrev_b32 v9, 16, v216
    v_and_b32 v56, s45, v9
    v_and_b32 v57, s45, v216
    v_lshlrev_b32 v9, 16, v217
    v_and_b32 v58, s45, v9
    v_and_b32 v59, s45, v217
    v_lshlrev_b32 v9, 16, v218
    v_and_b32 v60, s45, v9
    v_and_b32 v61, s45, v218
    v_lshlrev_b32 v9, 16, v219
    v_and_b32 v62, s45, v9
    v_and_b32 v63, s45, v219
    v_lshlrev_b32 v9, 16, v220
    v_and_b32 v64, s45, v9
    v_and_b32 v65, s45, v220
    v_lshlrev_b32 v9, 16, v221
    v_and_b32 v66, s45, v9
    v_and_b32 v67, s45, v221
    v_lshlrev_b32 v9, 16, v222
    v_and_b32 v68, s45, v9
    v_and_b32 v69, s45, v222
    v_lshlrev_b32 v9, 16, v223
    v_and_b32 v70, s45, v9
    v_and_b32 v71, s45, v223
    v_mov_b32 v72, 0
    v_mov_b32 v73, 0
    v_mov_b32 v74, 0
    v_mov_b32 v75, 0
    v_mov_b32 v76, 0
    v_mov_b32 v77, 0
    v_mov_b32 v78, 0
    v_mov_b32 v79, 0
    s_waitcnt lgkmcnt(0)
    s_waitcnt vmcnt(0)
L_sj2:
    s_barrier
    s_add_u32 s47, s28, 0
    buffer_load_dwordx4 a[0:3], v5, s[20:23], s47 offen offset:0 sc1
    buffer_load_dwordx4 a[4:7], v5, s[20:23], s47 offen offset:2048 sc1
    s_add_u32 s47, s28, 4096
    buffer_load_dwordx4 a[8:11], v5, s[20:23], s47 offen offset:0 sc1
    buffer_load_dwordx4 a[12:15], v5, s[20:23], s47 offen offset:2048 sc1
    s_add_u32 s47, s28, 8192
    buffer_load_dwordx4 a[16:19], v5, s[20:23], s47 offen offset:0 sc1
    buffer_load_dwordx4 a[20:23], v5, s[20:23], s47 offen offset:2048 sc1
    s_add_u32 s47, s28, 12288
    buffer_load_dwordx4 a[24:27], v5, s[20:23], s47 offen offset:0 sc1
    buffer_load_dwordx4 a[28:31], v5, s[20:23], s47 offen offset:2048 sc1
    s_add_u32 s47, s28, 16384
    buffer_load_dwordx4 a[32:35], v5, s[20:23], s47 offen offset:0 sc1
    buffer_load_dwordx4 a[36:39], v5, s[20:23], s47 offen offset:2048 sc1
    s_waitcnt vmcnt(9)
    v_mfma_f32_32x32x16_bf16 v[32:47], a[96:99], a[0:3], v[32:47]
    s_add_u32 s47, s28, 20480
    buffer_load_dwordx4 a[40:43], v5, s[20:23], s47 offen offset:0 sc1
    v_mfma_f32_32x32x16_bf16 v[48:63], a[100:103], a[0:3], v[48:63]
    v_mfma_f32_32x32x16_bf16 v[64:79], a[104:107], a[0:3], v[64:79]
    buffer_load_dwordx4 a[44:47], v5, s[20:23], s47 offen offset:2048 sc1
    s_waitcnt vmcnt(10)
    v_mfma_f32_32x32x16_bf16 v[32:47], a[108:111], a[4:7], v[32:47]
    v_mfma_f32_32x32x16_bf16 v[48:63], a[112:115], a[4:7], v[48:63]
    s_add_u32 s47, s28, 24576
    buffer_load_dwordx4 a[48:51], v5, s[20:23], s47 offen offset:0 sc1
    v_mfma_f32_32x32x16_bf16 v[64:79], a[116:119], a[4:7], v[64:79]
    s_waitcnt vmcnt(10)
    v_mfma_f32_32x32x16_bf16 v[32:47], a[120:123], a[8:11], v[32:47]
    buffer_load_dwordx4 a[52:55], v5, s[20:23], s47 offen offset:2048 sc1
    v_mfma_f32_32x32x16_bf16 v[48:63], a[124:127], a[8:11], v[48:63]
    v_mfma_f32_32x32x16_bf16 v[64:79], a[128:131], a[8:11], v[64:79]
    s_add_u32 s47, s28, 28672
    buffer_load_dwordx4 a[56:59], v5, s[20:23], s47 offen offset:0 sc1
    s_waitcnt vmcnt(11)
    v_mfma_f32_32x32x16_bf16 v[32:47], a[132:135], a[12:15], v[32:47]
    v_mfma_f32_32x32x16_bf16 v[48:63], a[136:139], a[12:15], v[48:63]
    buffer_load_dwordx4 a[60:63], v5, s[20:23], s47 offen offset:2048 sc1
    v_mfma_f32_32x32x16_bf16 v[64:79], a[140:143], a[12:15], v[64:79]
    s_waitcnt vmcnt(11)
    v_mfma_f32_32x32x16_bf16 v[32:47], a[144:147], a[16:19], v[32:47]
    s_add_u32 s47, s28, 32768
    buffer_load_dwordx4 a[64:67], v5, s[20:23], s47 offen offset:0 sc1
    v_mfma_f32_32x32x16_bf16 v[48:63], a[148:151], a[16:19], v[48:63]
    v_mfma_f32_32x32x16_bf16 v[64:79], a[152:155], a[16:19], v[64:79]
    buffer_load_dwordx4 a[68:71], v5, s[20:23], s47 offen offset:2048 sc1
    s_waitcnt vmcnt(12)
    v_mfma_f32_32x32x16_bf16 v[32:47], a[156:159], a[20:23], v[32:47]
    v_mfma_f32_32x32x16_bf16 v[48:63], a[160:163], a[20:23], v[48:63]
    s_add_u32 s47, s28, 36864
    buffer_load_dwordx4 a[72:75], v5, s[20:23], s47 offen offset:0 sc1
    v_mfma_f32_32x32x16_bf16 v[64:79], a[164:167], a[20:23], v[64:79]
    s_waitcnt vmcnt(12)
    v_mfma_f32_32x32x16_bf16 v[32:47], a[168:171], a[24:27], v[32:47]
    buffer_load_dwordx4 a[76:79], v5, s[20:23], s47 offen offset:2048 sc1
    v_mfma_f32_32x32x16_bf16 v[48:63], a[172:175], a[24:27], v[48:63]
    v_mfma_f32_32x32x16_bf16 v[64:79], a[176:179], a[24:27], v[64:79]
    s_add_u32 m0, s35, 131072
    s_add_u32 s46, s69, 131072
    buffer_load_dwordx4 v5, s[20:23], s46 offen sc1 lds
    s_waitcnt vmcnt(13)
    v_mfma_f32_32x32x16_bf16 v[32:47], a[180:183], a[28:31], v[32:47]
    v_mfma_f32_32x32x16_bf16 v[48:63], a[184:187], a[28:31], v[48:63]
    buffer_load_dwordx4 v5, s[20:23], s46 offen offset:1024 sc1 lds
    v_mfma_f32_32x32x16_bf16 v[64:79], a[188:191], a[28:31], v[64:79]
    s_waitcnt vmcnt(13)
    v_mfma_f32_32x32x16_bf16 v[32:47], a[192:195], a[32:35], v[32:47]
    buffer_load_dwordx4 v5, s[20:23], s46 offen offset:2048 sc1 lds
    v_mfma_f32_32x32x16_bf16 v[48:63], a[196:199], a[32:35], v[48:63]
    v_mfma_f32_32x32x16_bf16 v[64:79], a[200:203], a[32:35], v[64:79]
    buffer_load_dwordx4 v5, s[20:23], s46 offen offset:3072 sc1 lds
    s_waitcnt vmcnt(14)
    v_mfma_f32_32x32x16_bf16 v[32:47], a[204:207], a[36:39], v[32:47]
    v_mfma_f32_32x32x16_bf16 v[48:63], a[208:211], a[36:39], v[48:63]
    s_add_u32 m0, s35, 147456
    s_add_u32 s46, s69, 147456
    buffer_load_dwordx4 v5, s[20:23], s46 offen sc1 lds
    v_mfma_f32_32x32x16_bf16 v[64:79], a[212:215], a[36:39], v[64:79]
    s_waitcnt vmcnt(14)
    v_mfma_f32_32x32x16_bf16 v[32:47], a[216:219], a[40:43], v[32:47]
    buffer_load_dwordx4 v5, s[20:23], s46 offen offset:1024 sc1 lds
    v_mfma_f32_32x32x16_bf16 v[48:63], a[220:223], a[40:43], v[48:63]
    v_mfma_f32_32x32x16_bf16 v[64:79], a[224:227], a[40:43], v[64:79]
    buffer_load_dwordx4 v5, s[20:23], s46 offen offset:2048 sc1 lds
    s_waitcnt vmcnt(15)
    v_mfma_f32_32x32x16_bf16 v[32:47], a[228:231], a[44:47], v[32:47]
    v_mfma_f32_32x32x16_bf16 v[48:63], a[232:235], a[44:47], v[48:63]
    buffer_load_dwordx4 v5, s[20:23], s46 offen offset:3072 sc1 lds
    v_mfma_f32_32x32x16_bf16 v[64:79], a[236:239], a[44:47], v[64:79]
    s_waitcnt vmcnt(15)
    v_mfma_f32_32x32x16_bf16 v[32:47], a[240:243], a[48:51], v[32:47]
    v_mfma_f32_32x32x16_bf16 v[48:63], a[244:247], a[48:51], v[48:63]
    v_mfma_f32_32x32x16_bf16 v[64:79], v[80:83], a[48:51], v[64:79]
    s_waitcnt vmcnt(14)
    v_mfma_f32_32x32x16_bf16 v[32:47], v[84:87], a[52:55], v[32:47]
    v_mfma_f32_32x32x16_bf16 v[48:63], v[88:91], a[52:55], v[48:63]
    v_mfma_f32_32x32x16_bf16 v[64:79], v[92:95], a[52:55], v[64:79]
    s_waitcnt vmcnt(13)
    v_mfma_f32_32x32x16_bf16 v[32:47], v[96:99], a[56:59], v[32:47]
    v_mfma_f32_32x32x16_bf16 v[48:63], v[100:103], a[56:59], v[48:63]
    v_mfma_f32_32x32x16_bf16 v[64:79], v[104:107], a[56:59], v[64:79]
    s_waitcnt vmcnt(12)
    v_mfma_f32_32x32x16_bf16 v[32:47], v[108:111], a[60:63], v[32:47]
    v_mfma_f32_32x32x16_bf16 v[48:63], v[112:115], a[60:63], v[48:63]
    v_mfma_f32_32x32x16_bf16 v[64:79], v[116:119], a[60:63], v[64:79]
    s_waitcnt vmcnt(11)
    v_mfma_f32_32x32x16_bf16 v[32:47], v[120:123], a[64:67], v[32:47]
    v_mfma_f32_32x32x16_bf16 v[48:63], v[124:127], a[64:67], v[48:63]
    v_mfma_f32_32x32x16_bf16 v[64:79], v[128:131], a[64:67], v[64:79]
    s_waitcnt vmcnt(10)
    v_mfma_f32_32x32x16_bf16 v[32:47], v[132:135], a[68:71], v[32:47]
    v_mfma_f32_32x32x16_bf16 v[48:63], v[136:139], a[68:71], v[48:63]
    v_mfma_f32_32x32x16_bf16 v[64:79], v[140:143], a[68:71], v[64:79]
    s_waitcnt vmcnt(9)
    v_mfma_f32_32x32x16_bf16 v[32:47], v[144:147], a[72:75], v[32:47]
    v_mfma_f32_32x32x16_bf16 v[48:63], v[148:151], a[72:75], v[48:63]
    v_mfma_f32_32x32x16_bf16 v[64:79], v[152:155], a[72:75], v[64:79]
    s_waitcnt vmcnt(8)
    v_mfma_f32_32x32x16_bf16 v[32:47], v[160:163], a[76:79], v[32:47]
    v_mfma_f32_32x32x16_bf16 v[48:63], v[164:167], a[76:79], v[48:63]
    v_mfma_f32_32x32x16_bf16 v[64:79], v[168:171], a[76:79], v[64:79]
    s_cmp_eq_u32 s34, 0
    s_cbranch_scc1 L_x30
    s_nop 7
    ds_write_b128 v30, v[32:35] offset:0
    ds_write_b128 v30, v[36:39] offset:1024
    ds_write_b128 v30, v[40:43] offset:2048
    ds_write_b128 v30, v[44:47] offset:3072
    ds_write_b128 v30, v[48:51] offset:4096
    ds_write_b128 v30, v[52:55] offset:5120
    s_waitcnt lgkmcnt(0)
    s_barrier
    ds_read_b128 v[80:83], v31 offset:0
    ds_read_b128 v[84:87], v31 offset:1024
    ds_read_b128 v[88:91], v31 offset:2048
    ds_read_b128 v[92:95], v31 offset:3072
    s_waitcnt lgkmcnt(3)
    v_pk_add_f32 v[56:57], v[56:57], v[80:81]
    v_pk_add_f32 v[58:59], v[58:59], v[82:83]
    s_waitcnt lgkmcnt(2)
    v_pk_add_f32 v[60:61], v[60:61], v[84:85]
    v_pk_add_f32 v[62:63], v[62:63], v[86:87]
    v_cvt_pk_bf16_f32 v216, v56, v57
    v_cvt_pk_bf16_f32 v217, v58, v59
    v_cvt_pk_bf16_f32 v218, v60, v61
    v_cvt_pk_bf16_f32 v219, v62, v63
    buffer_store_dwordx4 v[216:219], v5, s[20:23], s57 offen offset:0 sc1
    s_waitcnt lgkmcnt(1)
    v_pk_add_f32 v[64:65], v[64:65], v[88:89]
    v_pk_add_f32 v[66:67], v[66:67], v[90:91]
    s_waitcnt lgkmcnt(0)
    v_pk_add_f32 v[68:69], v[68:69], v[92:93]
    v_pk_add_f32 v[70:71], v[70:71], v[94:95]
    v_cvt_pk_bf16_f32 v220, v64, v65
    v_cvt_pk_bf16_f32 v221, v66, v67
    v_cvt_pk_bf16_f32 v222, v68, v69
    v_cvt_pk_bf16_f32 v223, v70, v71
    buffer_store_dwordx4 v[220:223], v5, s[20:23], s57 offen offset:1024 sc1
    v_pk_mul_f32 v[106:107], v[56:57], v[56:57]
    v_pk_add_f32 v[104:105], v[56:57], 0
    v_pk_fma_f32 v[106:107], v[58:59], v[58:59], v[106:107]
    v_pk_add_f32 v[104:105], v[58:59], v[104:105]
    v_pk_fma_f32 v[106:107], v[60:61], v[60:61], v[106:107]
    v_pk_add_f32 v[104:105], v[60:61], v[104:105]
    v_pk_fma_f32 v[106:107], v[62:63], v[62:63], v[106:107]
    v_pk_add_f32 v[104:105], v[62:63], v[104:105]
    v_pk_fma_f32 v[106:107], v[64:65], v[64:65], v[106:107]
    v_pk_add_f32 v[104:105], v[64:65], v[104:105]
    v_pk_fma_f32 v[106:107], v[66:67], v[66:67], v[106:107]
    v_pk_add_f32 v[104:105], v[66:67], v[104:105]
    v_pk_fma_f32 v[106:107], v[68:69], v[68:69], v[106:107]
    v_pk_add_f32 v[104:105], v[68:69], v[104:105]
    v_pk_fma_f32 v[106:107], v[70:71], v[70:71], v[106:107]
    v_pk_add_f32 v[104:105], v[70:71], v[104:105]
    s_branch L_x3j
L_x30:
    s_nop 8
    ds_write_b128 v30, v[56:59] offset:0
    ds_write_b128 v30, v[60:63] offset:1024
    ds_write_b128 v30, v[64:67] offset:2048
    ds_write_b128 v30, v[68:71] offset:3072
    s_waitcnt lgkmcnt(0)
    s_barrier
    ds_read_b128 v[80:83], v31 offset:0
    ds_read_b128 v[84:87], v31 offset:1024
    ds_read_b128 v[88:91], v31 offset:2048
    ds_read_b128 v[92:95], v31 offset:3072
    ds_read_b128 v[96:99], v31 offset:4096
    ds_read_b128 v[100:103], v31 offset:5120
    s_waitcnt lgkmcnt(5)
    v_pk_add_f32 v[32:33], v[32:33], v[80:81]
    v_pk_add_f32 v[34:35], v[34:35], v[82:83]
    s_waitcnt lgkmcnt(4)
    v_pk_add_f32 v[36:37], v[36:37], v[84:85]
    v_pk_add_f32 v[38:39], v[38:39], v[86:87]
    v_cvt_pk_bf16_f32 v216, v32, v33
    v_cvt_pk_bf16_f32 v217, v34, v35
    v_cvt_pk_bf16_f32 v218, v36, v37
    v_cvt_pk_bf16_f32 v219, v38, v39
    buffer_store_dwordx4 v[216:219], v5, s[20:23], s57 offen offset:0 sc1
    s_waitcnt lgkmcnt(3)
    v_pk_add_f32 v[40:41], v[40:41], v[88:89]
    v_pk_add_f32 v[42:43], v[42:43], v[90:91]
    s_waitcnt lgkmcnt(2)
    v_pk_add_f32 v[44:45], v[44:45], v[92:93]
    v_pk_add_f32 v[46:47], v[46:47], v[94:95]
    v_cvt_pk_bf16_f32 v220, v40, v41
    v_cvt_pk_bf16_f32 v221, v42, v43
    v_cvt_pk_bf16_f32 v222, v44, v45
    v_cvt_pk_bf16_f32 v223, v46, v47
    buffer_store_dwordx4 v[220:223], v5, s[20:23], s57 offen offset:1024 sc1
    s_waitcnt lgkmcnt(1)
    v_pk_add_f32 v[48:49], v[48:49], v[96:97]
    v_pk_add_f32 v[50:51], v[50:51], v[98:99]
    s_waitcnt lgkmcnt(0)
    v_pk_add_f32 v[52:53], v[52:53], v[100:101]
    v_pk_add_f32 v[54:55], v[54:55], v[102:103]
    v_cvt_pk_bf16_f32 v224, v48, v49
    v_cvt_pk_bf16_f32 v225, v50, v51
    v_cvt_pk_bf16_f32 v226, v52, v53
    v_cvt_pk_bf16_f32 v227, v54, v55
    buffer_store_dwordx4 v[224:227], v5, s[20:23], s57 offen offset:2048 sc1
    v_pk_mul_f32 v[106:107], v[32:33], v[32:33]
    v_pk_add_f32 v[104:105], v[32:33], 0
    v_pk_fma_f32 v[106:107], v[34:35], v[34:35], v[106:107]
    v_pk_add_f32 v[104:105], v[34:35], v[104:105]
    v_pk_fma_f32 v[106:107], v[36:37], v[36:37], v[106:107]
    v_pk_add_f32 v[104:105], v[36:37], v[104:105]
    v_pk_fma_f32 v[106:107], v[38:39], v[38:39], v[106:107]
    v_pk_add_f32 v[104:105], v[38:39], v[104:105]
    v_pk_fma_f32 v[106:107], v[40:41], v[40:41], v[106:107]
    v_pk_add_f32 v[104:105], v[40:41], v[104:105]
    v_pk_fma_f32 v[106:107], v[42:43], v[42:43], v[106:107]
    v_pk_add_f32 v[104:105], v[42:43], v[104:105]
    v_pk_fma_f32 v[106:107], v[44:45], v[44:45], v[106:107]
    v_pk_add_f32 v[104:105], v[44:45], v[104:105]
    v_pk_fma_f32 v[106:107], v[46:47], v[46:47], v[106:107]
    v_pk_add_f32 v[104:105], v[46:47], v[104:105]
    v_pk_fma_f32 v[106:107], v[48:49], v[48:49], v[106:107]
    v_pk_add_f32 v[104:105], v[48:49], v[104:105]
    v_pk_fma_f32 v[106:107], v[50:51], v[50:51], v[106:107]
    v_pk_add_f32 v[104:105], v[50:51], v[104:105]
    v_pk_fma_f32 v[106:107], v[52:53], v[52:53], v[106:107]
    v_pk_add_f32 v[104:105], v[52:53], v[104:105]
    v_pk_fma_f32 v[106:107], v[54:55], v[54:55], v[106:107]
    v_pk_add_f32 v[104:105], v[54:55], v[104:105]
L_x3j:
    v_add_f32 v104, v104, v105
    v_add_f32 v105, v106, v107
    s_nop 1
    v_permlane32_swap_b32 v104, v105
    v_add_f32 v104, v104, v105
    buffer_store_dword v104, v29, s[20:23], s58 offen sc1
    s_add_u32 m0, s35, 32768
    s_add_u32 s46, s69, 32768
    buffer_load_dwordx4 v5, s[20:23], s46 offen sc1 lds
    buffer_load_dwordx4 v5, s[20:23], s46 offen offset:1024 sc1 lds
    buffer_load_dwordx4 v5, s[20:23], s46 offen offset:2048 sc1 lds
    buffer_load_dwordx4 v5, s[20:23], s46 offen offset:3072 sc1 lds
    s_add_u32 m0, s35, 49152
    s_add_u32 s46, s69, 49152
    buffer_load_dwordx4 v5, s[20:23], s46 offen sc1 lds
    buffer_load_dwordx4 v5, s[20:23], s46 offen offset:1024 sc1 lds
    buffer_load_dwordx4 v5, s[20:23], s46 offen offset:2048 sc1 lds
    buffer_load_dwordx4 v5, s[20:23], s46 offen offset:3072 sc1 lds
    s_add_u32 m0, s35, 65536
    s_add_u32 s46, s69, 65536
    buffer_load_dwordx4 v5, s[20:23], s46 offen sc1 lds
    buffer_load_dwordx4 v5, s[20:23], s46 offen offset:1024 sc1 lds
    buffer_load_dwordx4 v5, s[20:23], s46 offen offset:2048 sc1 lds
    buffer_load_dwordx4 v5, s[20:23], s46 offen offset:3072 sc1 lds
    s_add_u32 m0, s35, 81920
    s_add_u32 s46, s69, 81920
    buffer_load_dwordx4 v5, s[20:23], s46 offen sc1 lds
    buffer_load_dwordx4 v5, s[20:23], s46 offen offset:1024 sc1 lds
    buffer_load_dwordx4 v5, s[20:23], s46 offen offset:2048 sc1 lds
    buffer_load_dwordx4 v5, s[20:23], s46 offen offset:3072 sc1 lds
    s_andn2_b32 s40, s55, 0x7ff
    s_add_u32 s40, s40, 27254784
    s_lshl_b32 s43, s53, 7
    s_add_u32 s43, s43, s56
    s_add_u32 s43, s43, 27254784
    v_mov_b32 v16, v216
    v_mov_b32 v17, v217
    v_mov_b32 v18, v218
    v_mov_b32 v19, v219
    v_mov_b32 v20, v220
    v_mov_b32 v21, v221
    v_mov_b32 v22, v222
    v_mov_b32 v23, v223
    v_mov_b32 v24, v224
    v_mov_b32 v25, v225
    v_mov_b32 v26, v226
    v_mov_b32 v27, v227
    s_mul_i32 s28, s54, 40960
    s_add_u32 s28, s28, 10485760
    s_lshl_b32 s36, s54, 12
    s_add_u32 s36, s36, 13107200
    v_add_u32 v28, 65536, v5
    v_add_u32 v29, 131072, v5
    s_waitcnt lgkmcnt(0)
    s_waitcnt vmcnt(16)
    s_barrier
    s_cmp_lg_u32 s24, 0
    s_cbranch_scc1 L_so4
    v_mov_b32 v9, 1
    s_mov_b64 exec, 0xffff
    buffer_atomic_add v9, v3, s[20:23], s40 offen sc1
    s_mov_b64 exec, 1
    v_mov_b32 v8, 0
    buffer_atomic_add v8, v1, s[20:23], s43 offen sc0 sc1
    s_mov_b64 exec, -1
    s_mov_b64 exec, 1
    s_mov_b32 s44, 200000
L_pp5:
    s_waitcnt vmcnt(0)
    v_readfirstlane_b32 s45, v8
    s_nop 0
    s_cmp_ge_u32 s45, 16
    s_cbranch_scc1 L_pq5
    v_mov_b32 v8, 0
    buffer_atomic_add v8, v1, s[20:23], s43 offen sc0 sc1
    s_sub_u32 s44, s44, 1
    s_cmp_lg_u32 s44, 0
    s_cbranch_scc1 L_pp5
L_pq5:
    s_mov_b64 exec, -1
    s_branch L_sj4
L_so4:
    s_mul_i32 s91, s24, 10752
    s_add_u32 s91, s91, 0x15600
    s_add_u32 s45, s91, s29
    s_add_u32 m0, s91, 0
    s_add_u32 s46, s45, 0
    buffer_load_dwordx4 v5, s[20:23], s46 offen sc1 lds
    buffer_load_dwordx4 v5, s[20:23], s46 offen offset:1024 sc1 lds
    buffer_load_dwordx4 v5, s[20:23], s46 offen offset:2048 sc1 lds
    buffer_load_dwordx4 v5, s[20:23], s46 offen offset:3072 sc1 lds
    s_add_u32 m0, s91, 4096
    s_add_u32 s46, s45, 4096
    buffer_load_dwordx4 v5, s[20:23], s46 offen sc1 lds
    buffer_load_dwordx4 v5, s[20:23], s46 offen offset:1024 sc1 lds
    buffer_load_dwordx4 v5, s[20:23], s46 offen offset:2048 sc1 lds
    buffer_load_dwordx4 v5, s[20:23], s46 offen offset:3072 sc1 lds
    s_add_u32 m0, s91, 8192
    s_add_u32 s46, s45, 8192
    buffer_load_dwordx4 v5, s[20:23], s46 offen sc1 lds
    buffer_load_dwordx4 v5, s[20:23], s46 offen offset:1024 sc1 lds
    buffer_load_dwordx4 v5, s[20:23], s46 offen offset:2048 sc1 lds
    s_waitcnt vmcnt(0)
L_sj4:
    s_barrier
    s_add_u32 s47, s28, 0
    buffer_load_dwordx4 v[96:99], v5, s[20:23], s47 offen offset:0 sc1
    buffer_load_dwordx4 v[100:103], v5, s[20:23], s47 offen offset:1024 sc1
    buffer_load_dwordx4 v[104:107], v5, s[20:23], s47 offen offset:2048 sc1
    buffer_load_dwordx4 v[108:111], v5, s[20:23], s47 offen offset:3072 sc1
    s_add_u32 s47, s28, 4096
    buffer_load_dwordx4 v[112:115], v5, s[20:23], s47 offen offset:0 sc1
    buffer_load_dwordx4 v[116:119], v5, s[20:23], s47 offen offset:1024 sc1
    buffer_load_dwordx4 v[120:123], v5, s[20:23], s47 offen offset:2048 sc1
    buffer_load_dwordx4 v[124:127], v5, s[20:23], s47 offen offset:3072 sc1
    s_add_u32 s47, s28, 8192
    buffer_load_dwordx4 v[128:131], v5, s[20:23], s47 offen offset:0 sc1
    buffer_load_dwordx4 v[132:135], v5, s[20:23], s47 offen offset:1024 sc1
    ds_read_b128 a[0:3], v5 offset:0
    ds_read_b128 a[4:7], v5 offset:1024
    ds_read_b128 a[8:11], v5 offset:2048
    ds_read_b128 a[12:15], v5 offset:3072
    s_waitcnt vmcnt(9) lgkmcnt(3)
    v_mfma_f32_32x32x16_bf16 v[32:47], a[0:3], v[96:99], 0
    ds_read_b128 a[16:19], v5 offset:4096
    ds_read_b128 a[20:23], v5 offset:5120
    s_waitcnt lgkmcnt(4)
    v_mfma_f32_32x32x16_bf16 v[48:63], a[4:7], v[96:99], 0
    ds_read_b128 a[24:27], v5 offset:6144
    ds_read_b128 a[28:31], v5 offset:7168
    s_waitcnt lgkmcnt(5)
    v_mfma_f32_32x32x16_bf16 v[64:79], a[8:11], v[96:99], 0
    buffer_load_dwordx4 v[136:139], v5, s[20:23], s47 offen offset:2048 sc1
    s_waitcnt lgkmcnt(4)
    v_mfma_f32_32x32x16_bf16 v[80:95], a[12:15], v[96:99], 0
    buffer_load_dwordx4 v[140:143], v5, s[20:23], s47 offen offset:3072 sc1
    s_waitcnt vmcnt(10) lgkmcnt(3)
    v_mfma_f32_32x32x16_bf16 v[32:47], a[16:19], v[100:103], v[32:47]
    ds_read_b128 a[0:3], v5 offset:8192
    ds_read_b128 a[4:7], v5 offset:9216
    s_waitcnt lgkmcnt(4)
    v_mfma_f32_32x32x16_bf16 v[48:63], a[20:23], v[100:103], v[48:63]
    ds_read_b128 a[8:11], v5 offset:10240
    ds_read_b128 a[12:15], v5 offset:11264
    s_waitcnt lgkmcnt(5)
    v_mfma_f32_32x32x16_bf16 v[64:79], a[24:27], v[100:103], v[64:79]
    s_add_u32 s47, s28, 12288
    buffer_load_dwordx4 v[144:147], v5, s[20:23], s47 offen offset:0 sc1
    s_waitcnt lgkmcnt(4)
    v_mfma_f32_32x32x16_bf16 v[80:95], a[28:31], v[100:103], v[80:95]
    buffer_load_dwordx4 v[148:151], v5, s[20:23], s47 offen offset:1024 sc1
    s_waitcnt vmcnt(11) lgkmcnt(3)
    v_mfma_f32_32x32x16_bf16 v[32:47], a[0:3], v[104:107], v[32:47]
    ds_read_b128 a[16:19], v5 offset:12288
    ds_read_b128 a[20:23], v5 offset:13312
    s_waitcnt lgkmcnt(4)
    v_mfma_f32_32x32x16_bf16 v[48:63], a[4:7], v[104:107], v[48:63]
    ds_read_b128 a[24:27], v5 offset:14336
    ds_read_b128 a[28:31], v5 offset:15360
    s_waitcnt lgkmcnt(5)
    v_mfma_f32_32x32x16_bf16 v[64:79], a[8:11], v[104:107], v[64:79]
    buffer_load_dwordx4 v[152:155], v5, s[20:23], s47 offen offset:2048 sc1
    s_waitcnt lgkmcnt(4)
    v_mfma_f32_32x32x16_bf16 v[80:95], a[12:15], v[104:107], v[80:95]
    buffer_load_dwordx4 v[156:159], v5, s[20:23], s47 offen offset:3072 sc1
    s_waitcnt vmcnt(12) lgkmcnt(3)
    v_mfma_f32_32x32x16_bf16 v[32:47], a[16:19], v[108:111], v[32:47]
    ds_read_b128 a[0:3], v5 offset:16384
    ds_read_b128 a[4:7], v5 offset:17408
    s_waitcnt lgkmcnt(4)
    v_mfma_f32_32x32x16_bf16 v[48:63], a[20:23], v[108:111], v[48:63]
    ds_read_b128 a[8:11], v5 offset:18432
    ds_read_b128 a[12:15], v5 offset:19456
    s_waitcnt lgkmcnt(5)
    v_mfma_f32_32x32x16_bf16 v[64:79], a[24:27], v[108:111], v[64:79]
    s_add_u32 s47, s28, 16384
    buffer_load_dwordx4 v[160:163], v5, s[20:23], s47 offen offset:0 sc1
    s_waitcnt lgkmcnt(4)
    v_mfma_f32_32x32x16_bf16 v[80:95], a[28:31], v[108:111], v[80:95]
    buffer_load_dwordx4 v[164:167], v5, s[20:23], s47 offen offset:1024 sc1
    s_waitcnt vmcnt(13) lgkmcnt(3)
    v_mfma_f32_32x32x16_bf16 v[32:47], a[0:3], v[112:115], v[32:47]
    ds_read_b128 a[16:19], v5 offset:20480
    ds_read_b128 a[20:23], v5 offset:21504
    s_waitcnt lgkmcnt(4)
    v_mfma_f32_32x32x16_bf16 v[48:63], a[4:7], v[112:115], v[48:63]
    ds_read_b128 a[24:27], v5 offset:22528
    ds_read_b128 a[28:31], v5 offset:23552
    s_waitcnt lgkmcnt(5)
    v_mfma_f32_32x32x16_bf16 v[64:79], a[8:11], v[112:115], v[64:79]
    buffer_load_dwordx4 v[168:171], v5, s[20:23], s47 offen offset:2048 sc1
    s_waitcnt lgkmcnt(4)
    v_mfma_f32_32x32x16_bf16 v[80:95], a[12:15], v[112:115], v[80:95]
    buffer_load_dwordx4 v[172:175], v5, s[20:23], s47 offen offset:3072 sc1
    s_waitcnt vmcnt(14) lgkmcnt(3)
    v_mfma_f32_32x32x16_bf16 v[32:47], a[16:19], v[116:119], v[32:47]
    ds_read_b128 a[0:3], v5 offset:24576
    ds_read_b128 a[4:7], v5 offset:25600
    s_waitcnt lgkmcnt(4)
    v_mfma_f32_32x32x16_bf16 v[48:63], a[20:23], v[116:119], v[48:63]
    ds_read_b128 a[8:11], v5 offset:26624
    ds_read_b128 a[12:15], v5 offset:27648
    s_waitcnt lgkmcnt(5)
    v_mfma_f32_32x32x16_bf16 v[64:79], a[24:27], v[116:119], v[64:79]
    s_add_u32 s47, s28, 20480
    buffer_load_dwordx4 v[176:179], v5, s[20:23], s47 offen offset:0 sc1
    s_waitcnt lgkmcnt(4)
    v_mfma_f32_32x32x16_bf16 v[80:95], a[28:31], v[116:119], v[80:95]
    buffer_load_dwordx4 v[180:183], v5, s[20:23], s47 offen offset:1024 sc1
    s_waitcnt vmcnt(15) lgkmcnt(3)
    v_mfma_f32_32x32x16_bf16 v[32:47], a[0:3], v[120:123], v[32:47]
    ds_read_b128 a[16:19], v5 offset:28672
    ds_read_b128 a[20:23], v5 offset:29696
    s_waitcnt lgkmcnt(4)
    v_mfma_f32_32x32x16_bf16 v[48:63], a[4:7], v[120:123], v[48:63]
    ds_read_b128 a[24:27], v5 offset:30720
    ds_read_b128 a[28:31], v5 offset:31744
    s_waitcnt lgkmcnt(5)
    v_mfma_f32_32x32x16_bf16 v[64:79], a[8:11], v[120:123], v[64:79]
    buffer_load_dwordx4 v[184:187], v5, s[20:23], s47 offen offset:2048 sc1
    s_waitcnt lgkmcnt(4)
    v_mfma_f32_32x32x16_bf16 v[80:95], a[12:15], v[120:123], v[80:95]
    buffer_load_dwordx4 v[188:191], v5, s[20:23], s47 offen offset:3072 sc1
    s_waitcnt vmcnt(16) lgkmcnt(3)
    v_mfma_f32_32x32x16_bf16 v[32:47], a[16:19], v[124:127], v[32:47]
    ds_read_b128 a[0:3], v5 offset:32768
    ds_read_b128 a[4:7], v5 offset:33792
    s_waitcnt lgkmcnt(4)
    v_mfma_f32_32x32x16_bf16 v[48:63], a[20:23], v[124:127], v[48:63]
    ds_read_b128 a[8:11], v5 offset:34816
    ds_read_b128 a[12:15], v5 offset:35840
    s_waitcnt lgkmcnt(5)
    v_mfma_f32_32x32x16_bf16 v[64:79], a[24:27], v[124:127], v[64:79]
    s_add_u32 s47, s28, 24576
    buffer_load_dwordx4 v[192:195], v5, s[20:23], s47 offen offset:0 sc1
    s_waitcnt lgkmcnt(4)
    v_mfma_f32_32x32x16_bf16 v[80:95], a[28:31], v[124:127], v[80:95]
    buffer_load_dwordx4 v[196:199], v5, s[20:23], s47 offen offset:1024 sc1
    s_waitcnt vmcnt(17) lgkmcnt(3)
    v_mfma_f32_32x32x16_bf16 v[32:47], a[0:3], v[128:131], v[32:47]
    ds_read_b128 a[16:19], v5 offset:36864
    ds_read_b128 a[20:23], v5 offset:37888
    s_waitcnt lgkmcnt(4)
    v_mfma_f32_32x32x16_bf16 v[48:63], a[4:7], v[128:131], v[48:63]
    ds_read_b128 a[24:27], v5 offset:38912
    ds_read_b128 a[28:31], v5 offset:39936
    s_waitcnt lgkmcnt(5)
    v_mfma_f32_32x32x16_bf16 v[64:79], a[8:11], v[128:131], v[64:79]
    buffer_load_dwordx4 v[200:203], v5, s[20:23], s47 offen offset:2048 sc1
    s_waitcnt lgkmcnt(4)
    v_mfma_f32_32x32x16_bf16 v[80:95], a[12:15], v[128:131], v[80:95]
    buffer_load_dwordx4 v[204:207], v5, s[20:23], s47 offen offset:3072 sc1
    s_waitcnt vmcnt(18) lgkmcnt(3)
    v_mfma_f32_32x32x16_bf16 v[32:47], a[16:19], v[132:135], v[32:47]
    ds_read_b128 a[0:3], v5 offset:40960
    ds_read_b128 a[4:7], v5 offset:41984
    s_waitcnt lgkmcnt(4)
    v_mfma_f32_32x32x16_bf16 v[48:63], a[20:23], v[132:135], v[48:63]
    ds_read_b128 a[8:11], v5 offset:43008
    ds_read_b128 a[12:15], v5 offset:44032
    s_waitcnt lgkmcnt(5)
    v_mfma_f32_32x32x16_bf16 v[64:79], a[24:27], v[132:135], v[64:79]
    s_add_u32 s47, s28, 28672
    buffer_load_dwordx4 v[208:211], v5, s[20:23], s47 offen offset:0 sc1
    s_waitcnt lgkmcnt(4)
    v_mfma_f32_32x32x16_bf16 v[80:95], a[28:31], v[132:135], v[80:95]
    buffer_load_dwordx4 v[212:215], v5, s[20:23], s47 offen offset:1024 sc1
    s_waitcnt vmcnt(19) lgkmcnt(3)
    v_mfma_f32_32x32x16_bf16 v[32:47], a[0:3], v[136:139], v[32:47]
    ds_read_b128 a[16:19], v5 offset:45056
    ds_read_b128 a[20:23], v5 offset:46080
    s_waitcnt lgkmcnt(4)
    v_mfma_f32_32x32x16_bf16 v[48:63], a[4:7], v[136:139], v[48:63]
    ds_read_b128 a[24:27], v5 offset:47104
    ds_read_b128 a[28:31], v5 offset:48128
    s_waitcnt lgkmcnt(5)
    v_mfma_f32_32x32x16_bf16 v[64:79], a[8:11], v[136:139], v[64:79]
    buffer_load_dwordx4 v[216:219], v5, s[20:23], s47 offen offset:2048 sc1
    s_waitcnt lgkmcnt(4)
    v_mfma_f32_32x32x16_bf16 v[80:95], a[12:15], v[136:139], v[80:95]
    buffer_load_dwordx4 v[220:223], v5, s[20:23], s47 offen offset:3072 sc1
    s_waitcnt vmcnt(20) lgkmcnt(3)
    v_mfma_f32_32x32x16_bf16 v[32:47], a[16:19], v[140:143], v[32:47]
    ds_read_b128 a[0:3], v5 offset:49152
    ds_read_b128 a[4:7], v5 offset:50176
    s_waitcnt lgkmcnt(4)
    v_mfma_f32_32x32x16_bf16 v[48:63], a[20:23], v[140:143], v[48:63]
    ds_read_b128 a[8:11], v5 offset:51200
    ds_read_b128 a[12:15], v5 offset:52224
    s_waitcnt lgkmcnt(5)
    v_mfma_f32_32x32x16_bf16 v[64:79], a[24:27], v[140:143], v[64:79]
    s_add_u32 s47, s28, 32768
    buffer_load_dwordx4 v[224:227], v5, s[20:23], s47 offen offset:0 sc1
    s_waitcnt lgkmcnt(4)
    v_mfma_f32_32x32x16_bf16 v[80:95], a[28:31], v[140:143], v[80:95]
    buffer_load_dwordx4 v[228:231], v5, s[20:23], s47 offen offset:1024 sc1
    s_waitcnt vmcnt(21) lgkmcnt(3)
    v_mfma_f32_32x32x16_bf16 v[32:47], a[0:3], v[144:147], v[32:47]
    ds_read_b128 a[16:19], v5 offset:53248
    ds_read_b128 a[20:23], v5 offset:54272
    s_waitcnt lgkmcnt(4)
    v_mfma_f32_32x32x16_bf16 v[48:63], a[4:7], v[144:147], v[48:63]
    ds_read_b128 a[24:27], v5 offset:55296
    ds_read_b128 a[28:31], v5 offset:56320
    s_waitcnt lgkmcnt(5)
    v_mfma_f32_32x32x16_bf16 v[64:79], a[8:11], v[144:147], v[64:79]
    buffer_load_dwordx4 v[232:235], v5, s[20:23], s47 offen offset:2048 sc1
    s_waitcnt lgkmcnt(4)
    v_mfma_f32_32x32x16_bf16 v[80:95], a[12:15], v[144:147], v[80:95]
    buffer_load_dwordx4 v[236:239], v5, s[20:23], s47 offen offset:3072 sc1
    s_waitcnt vmcnt(22) lgkmcnt(3)
    v_mfma_f32_32x32x16_bf16 v[32:47], a[16:19], v[148:151], v[32:47]
    ds_read_b128 a[0:3], v5 offset:57344
    ds_read_b128 a[4:7], v5 offset:58368
    s_waitcnt lgkmcnt(4)
    v_mfma_f32_32x32x16_bf16 v[48:63], a[20:23], v[148:151], v[48:63]
    ds_read_b128 a[8:11], v5 offset:59392
    ds_read_b128 a[12:15], v5 offset:60416
    s_waitcnt lgkmcnt(5)
    v_mfma_f32_32x32x16_bf16 v[64:79], a[24:27], v[148:151], v[64:79]
    s_add_u32 s47, s28, 36864
    buffer_load_dwordx4 v[240:243], v5, s[20:23], s47 offen offset:0 sc1
    s_waitcnt lgkmcnt(4)
    v_mfma_f32_32x32x16_bf16 v[80:95], a[28:31], v[148:151], v[80:95]
    buffer_load_dwordx4 v[244:247], v5, s[20:23], s47 offen offset:1024 sc1
    s_waitcnt vmcnt(23) lgkmcnt(3)
    v_mfma_f32_32x32x16_bf16 v[32:47], a[0:3], v[152:155], v[32:47]
    ds_read_b128 a[16:19], v5 offset:61440
    ds_read_b128 a[20:23], v5 offset:62464
    s_waitcnt lgkmcnt(4)
    v_mfma_f32_32x32x16_bf16 v[48:63], a[4:7], v[152:155], v[48:63]
    ds_read_b128 a[24:27], v5 offset:63488
    ds_read_b128 a[28:31], v5 offset:64512
    s_waitcnt lgkmcnt(5)
    v_mfma_f32_32x32x16_bf16 v[64:79], a[8:11], v[152:155], v[64:79]
    buffer_load_dwordx4 v[248:251], v5, s[20:23], s47 offen offset:2048 sc1
    s_waitcnt lgkmcnt(4)
    v_mfma_f32_32x32x16_bf16 v[80:95], a[12:15], v[152:155], v[80:95]
    buffer_load_dwordx4 v[252:255], v5, s[20:23], s47 offen offset:3072 sc1
    s_waitcnt vmcnt(24) lgkmcnt(3)
    v_mfma_f32_32x32x16_bf16 v[32:47], a[16:19], v[156:159], v[32:47]
    ds_read_b128 a[0:3], v28 offset:0
    ds_read_b128 a[4:7], v28 offset:1024
    s_waitcnt lgkmcnt(4)
    v_mfma_f32_32x32x16_bf16 v[48:63], a[20:23], v[156:159], v[48:63]
    ds_read_b128 a[8:11], v28 offset:2048
    ds_read_b128 a[12:15], v28 offset:3072
    s_waitcnt lgkmcnt(5)
    v_mfma_f32_32x32x16_bf16 v[64:79], a[24:27], v[156:159], v[64:79]
    buffer_load_dwordx4 a[64:67], v5, s[20:23], s36 offen offset:0 sc1
    s_waitcnt lgkmcnt(4)
    v_mfma_f32_32x32x16_bf16 v[80:95], a[28:31], v[156:159], v[80:95]
    buffer_load_dwordx4 a[68:71], v5, s[20:23], s36 offen offset:1024 sc1
    s_waitcnt vmcnt(25) lgkmcnt(3)
    v_mfma_f32_32x32x16_bf16 v[32:47], a[0:3], v[160:163], v[32:47]
    ds_read_b128 a[16:19], v28 offset:4096
    ds_read_b128 a[20:23], v28 offset:5120
    s_waitcnt lgkmcnt(4)
    v_mfma_f32_32x32x16_bf16 v[48:63], a[4:7], v[160:163], v[48:63]
    ds_read_b128 a[24:27], v28 offset:6144
    ds_read_b128 a[28:31], v28 offset:7168
    s_waitcnt lgkmcnt(5)
    v_mfma_f32_32x32x16_bf16 v[64:79], a[8:11], v[160:163], v[64:79]
    buffer_load_dwordx4 a[72:75], v5, s[20:23], s36 offen offset:2048 sc1
    s_waitcnt lgkmcnt(4)
    v_mfma_f32_32x32x16_bf16 v[80:95], a[12:15], v[160:163], v[80:95]
    buffer_load_dwordx4 a[76:79], v5, s[20:23], s36 offen offset:3072 sc1
    s_waitcnt vmcnt(26) lgkmcnt(3)
    v_mfma_f32_32x32x16_bf16 v[32:47], a[16:19], v[164:167], v[32:47]
    ds_read_b128 a[0:3], v28 offset:8192
    ds_read_b128 a[4:7], v28 offset:9216
    s_waitcnt lgkmcnt(4)
    v_mfma_f32_32x32x16_bf16 v[48:63], a[20:23], v[164:167], v[48:63]
    ds_read_b128 a[8:11], v28 offset:10240
    ds_read_b128 a[12:15], v28 offset:11264
    s_waitcnt lgkmcnt(5)
    v_mfma_f32_32x32x16_bf16 v[64:79], a[24:27], v[164:167], v[64:79]
    s_waitcnt lgkmcnt(4)
    v_mfma_f32_32x32x16_bf16 v[80:95], a[28:31], v[164:167], v[80:95]
    s_waitcnt vmcnt(25) lgkmcnt(3)
    v_mfma_f32_32x32x16_bf16 v[32:47], a[0:3], v[168:171], v[32:47]
    ds_read_b128 a[16:19], v28 offset:12288
    ds_read_b128 a[20:23], v28 offset:13312
    s_waitcnt lgkmcnt(4)
    v_mfma_f32_32x32x16_bf16 v[48:63], a[4:7], v[168:171], v[48:63]
    ds_read_b128 a[24:27], v28 offset:14336
    ds_read_b128 a[28:31], v28 offset:15360
    s_waitcnt lgkmcnt(5)
    v_mfma_f32_32x32x16_bf16 v[64:79], a[8:11], v[168:171], v[64:79]
    s_waitcnt lgkmcnt(4)
    v_mfma_f32_32x32x16_bf16 v[80:95], a[12:15], v[168:171], v[80:95]
    s_waitcnt lgkmcnt(0)
    s_barrier
    s_waitcnt vmcnt(24)
    v_mfma_f32_32x32x16_bf16 v[32:47], a[16:19], v[172:175], v[32:47]
    ds_read_b128 a[0:3], v28 offset:16384
    ds_read_b128 a[4:7], v28 offset:17408
    v_mfma_f32_32x32x16_bf16 v[48:63], a[20:23], v[172:175], v[48:63]
    ds_read_b128 a[8:11], v28 offset:18432
    ds_read_b128 a[12:15], v28 offset:19456
    v_mfma_f32_32x32x16_bf16 v[64:79], a[24:27], v[172:175], v[64:79]
    s_add_u32 m0, s35, 0
    s_add_u32 s46, s69, 163840
    buffer_load_dwordx4 v5, s[20:23], s46 offen sc1 lds
    v_mfma_f32_32x32x16_bf16 v[80:95], a[28:31], v[172:175], v[80:95]
    buffer_load_dwordx4 v5, s[20:23], s46 offen offset:1024 sc1 lds
    s_waitcnt vmcnt(25) lgkmcnt(3)
    v_mfma_f32_32x32x16_bf16 v[32:47], a[0:3], v[176:179], v[32:47]
    ds_read_b128 a[16:19], v28 offset:20480
    ds_read_b128 a[20:23], v28 offset:21504
    s_waitcnt lgkmcnt(4)
    v_mfma_f32_32x32x16_bf16 v[48:63], a[4:7], v[176:179], v[48:63]
    ds_read_b128 a[24:27], v28 offset:22528
    ds_read_b128 a[28:31], v28 offset:23552
    s_waitcnt lgkmcnt(5)
    v_mfma_f32_32x32x16_bf16 v[64:79], a[8:11], v[176:179], v[64:79]
    buffer_load_dwordx4 v5, s[20:23], s46 offen offset:2048 sc1 lds
    s_waitcnt lgkmcnt(4)
    v_mfma_f32_32x32x16_bf16 v[80:95], a[12:15], v[176:179], v[80:95]
    buffer_load_dwordx4 v5, s[20:23], s46 offen offset:3072 sc1 lds
    s_waitcnt vmcnt(26) lgkmcnt(3)
    v_mfma_f32_32x32x16_bf16 v[32:47], a[16:19], v[180:183], v[32:47]
    ds_read_b128 a[0:3], v28 offset:24576
    ds_read_b128 a[4:7], v28 offset:25600
    s_waitcnt lgkmcnt(4)
    v_mfma_f32_32x32x16_bf16 v[48:63], a[20:23], v[180:183], v[48:63]
    ds_read_b128 a[8:11], v28 offset:26624
    ds_read_b128 a[12:15], v28 offset:27648
    s_waitcnt lgkmcnt(5)
    v_mfma_f32_32x32x16_bf16 v[64:79], a[24:27], v[180:183], v[64:79]
    s_add_u32 m0, s35, 16384
    s_add_u32 s46, s69, 180224
    buffer_load_dwordx4 v5, s[20:23], s46 offen sc1 lds
    s_waitcnt lgkmcnt(4)
    v_mfma_f32_32x32x16_bf16 v[80:95], a[28:31], v[180:183], v[80:95]
    buffer_load_dwordx4 v5, s[20:23], s46 offen offset:1024 sc1 lds
    s_waitcnt vmcnt(27) lgkmcnt(3)
    v_mfma_f32_32x32x16_bf16 v[32:47], a[0:3], v[184:187], v[32:47]
    ds_read_b128 a[16:19], v28 offset:28672
    ds_read_b128 a[20:23], v28 offset:29696
    s_waitcnt lgkmcnt(4)
    v_mfma_f32_32x32x16_bf16 v[48:63], a[4:7], v[184:187], v[48:63]
    ds_read_b128 a[24:27], v28 offset:30720
    ds_read_b128 a[28:31], v28 offset:31744
    s_waitcnt lgkmcnt(5)
    v_mfma_f32_32x32x16_bf16 v[64:79], a[8:11], v[184:187], v[64:79]
    buffer_load_dwordx4 v5, s[20:23], s46 offen offset:2048 sc1 lds
    s_waitcnt lgkmcnt(4)
    v_mfma_f32_32x32x16_bf16 v[80:95], a[12:15], v[184:187], v[80:95]
    buffer_load_dwordx4 v5, s[20:23], s46 offen offset:3072 sc1 lds
    s_waitcnt vmcnt(28) lgkmcnt(3)
    v_mfma_f32_32x32x16_bf16 v[32:47], a[16:19], v[188:191], v[32:47]
    ds_read_b128 a[0:3], v28 offset:32768
    ds_read_b128 a[4:7], v28 offset:33792
    s_waitcnt lgkmcnt(4)
    v_mfma_f32_32x32x16_bf16 v[48:63], a[20:23], v[188:191], v[48:63]
    ds_read_b128 a[8:11], v28 offset:34816
    ds_read_b128 a[12:15], v28 offset:35840
    s_waitcnt lgkmcnt(5)
    v_mfma_f32_32x32x16_bf16 v[64:79], a[24:27], v[188:191], v[64:79]
    s_add_u32 m0, s35, 32768
    s_add_u32 s46, s69, 196608
    buffer_load_dwordx4 v5, s[20:23], s46 offen sc1 lds
    s_waitcnt lgkmcnt(4)
    v_mfma_f32_32x32x16_bf16 v[80:95], a[28:31], v[188:191], v[80:95]
    buffer_load_dwordx4 v5, s[20:23], s46 offen offset:1024 sc1 lds
    s_waitcnt vmcnt(29) lgkmcnt(3)
    v_mfma_f32_32x32x16_bf16 v[32:47], a[0:3], v[192:195], v[32:47]
    ds_read_b128 a[16:19], v28 offset:36864
    ds_read_b128 a[20:23], v28 offset:37888
    s_waitcnt lgkmcnt(4)
    v_mfma_f32_32x32x16_bf16 v[48:63], a[4:7], v[192:195], v[48:63]
    ds_read_b128 a[24:27], v28 offset:38912
    ds_read_b128 a[28:31], v28 offset:39936
    s_waitcnt lgkmcnt(5)
    v_mfma_f32_32x32x16_bf16 v[64:79], a[8:11], v[192:195], v[64:79]
    buffer_load_dwordx4 v5, s[20:23], s46 offen offset:2048 sc1 lds
    s_waitcnt lgkmcnt(4)
    v_mfma_f32_32x32x16_bf16 v[80:95], a[12:15], v[192:195], v[80:95]
    buffer_load_dwordx4 v5, s[20:23], s46 offen offset:3072 sc1 lds
    s_waitcnt vmcnt(30) lgkmcnt(3)
    v_mfma_f32_32x32x16_bf16 v[32:47], a[16:19], v[196:199], v[32:47]
    ds_read_b128 a[0:3], v28 offset:40960
    ds_read_b128 a[4:7], v28 offset:41984
    s_waitcnt lgkmcnt(4)
    v_mfma_f32_32x32x16_bf16 v[48:63], a[20:23], v[196:199], v[48:63]
    ds_read_b128 a[8:11], v28 offset:43008
    ds_read_b128 a[12:15], v28 offset:44032
    s_waitcnt lgkmcnt(5)
    v_mfma_f32_32x32x16_bf16 v[64:79], a[24:27], v[196:199], v[64:79]
    s_add_u32 m0, s35, 49152
    s_add_u32 s46, s69, 212992
    buffer_load_dwordx4 v5, s[20:23], s46 offen sc1 lds
    s_waitcnt lgkmcnt(4)
    v_mfma_f32_32x32x16_bf16 v[80:95], a[28:31], v[196:199], v[80:95]
    buffer_load_dwordx4 v5, s[20:23], s46 offen offset:1024 sc1 lds
    s_waitcnt vmcnt(31) lgkmcnt(3)
    v_mfma_f32_32x32x16_bf16 v[32:47], a[0:3], v[200:203], v[32:47]
    ds_read_b128 a[16:19], v28 offset:45056
    ds_read_b128 a[20:23], v28 offset:46080
    s_waitcnt lgkmcnt(4)
    v_mfma_f32_32x32x16_bf16 v[48:63], a[4:7], v[200:203], v[48:63]
    ds_read_b128 a[24:27], v28 offset:47104
    ds_read_b128 a[28:31], v28 offset:48128
    s_waitcnt lgkmcnt(5)
    v_mfma_f32_32x32x16_bf16 v[64:79], a[8:11], v[200:203], v[64:79]
    buffer_load_dwordx4 v5, s[20:23], s46 offen offset:2048 sc1 lds
    s_waitcnt lgkmcnt(4)
    v_mfma_f32_32x32x16_bf16 v[80:95], a[12:15], v[200:203], v[80:95]
    buffer_load_dwordx4 v5, s[20:23], s46 offen offset:3072 sc1 lds
    s_waitcnt vmcnt(32) lgkmcnt(3)
    v_mfma_f32_32x32x16_bf16 v[32:47], a[16:19], v[204:207], v[32:47]
    ds_read_b128 a[0:3], v28 offset:49152
    ds_read_b128 a[4:7], v28 offset:50176
    s_waitcnt lgkmcnt(4)
    v_mfma_f32_32x32x16_bf16 v[48:63], a[20:23], v[204:207], v[48:63]
    ds_read_b128 a[8:11], v28 offset:51200
    ds_read_b128 a[12:15], v28 offset:52224
    s_waitcnt lgkmcnt(5)
    v_mfma_f32_32x32x16_bf16 v[64:79], a[24:27], v[204:207], v[64:79]
    s_add_u32 m0, s35, 65536
    s_add_u32 s46, s69, 229376
    buffer_load_dwordx4 v5, s[20:23], s46 offen sc1 lds
    s_waitcnt lgkmcnt(4)
    v_mfma_f32_32x32x16_bf16 v[80:95], a[28:31], v[204:207], v[80:95]
    buffer_load_dwordx4 v5, s[20:23], s46 offen offset:1024 sc1 lds
    s_waitcnt vmcnt(33) lgkmcnt(3)
    v_mfma_f32_32x32x16_bf16 v[32:47], a[0:3], v[208:211], v[32:47]
    ds_read_b128 a[16:19], v28 offset:53248
    ds_read_b128 a[20:23], v28 offset:54272
    s_waitcnt lgkmcnt(4)
    v_mfma_f32_32x32x16_bf16 v[48:63], a[4:7], v[208:211], v[48:63]
    ds_read_b128 a[24:27], v28 offset:55296
    ds_read_b128 a[28:31], v28 offset:56320
    s_waitcnt lgkmcnt(5)
    v_mfma_f32_32x32x16_bf16 v[64:79], a[8:11], v[208:211], v[64:79]
    buffer_load_dwordx4 v5, s[20:23], s46 offen offset:2048 sc1 lds
    s_waitcnt lgkmcnt(4)
    v_mfma_f32_32x32x16_bf16 v[80:95], a[12:15], v[208:211], v[80:95]
    buffer_load_dwordx4 v5, s[20:23], s46 offen offset:3072 sc1 lds
    s_waitcnt vmcnt(34) lgkmcnt(3)
    v_mfma_f32_32x32x16_bf16 v[32:47], a[16:19], v[212:215], v[32:47]
    ds_read_b128 a[0:3], v28 offset:57344
    ds_read_b128 a[4:7], v28 offset:58368
    s_waitcnt lgkmcnt(4)
    v_mfma_f32_32x32x16_bf16 v[48:63], a[20:23], v[212:215], v[48:63]
    ds_read_b128 a[8:11], v28 offset:59392
    ds_read_b128 a[12:15], v28 offset:60416
    s_waitcnt lgkmcnt(5)
    v_mfma_f32_32x32x16_bf16 v[64:79], a[24:27], v[212:215], v[64:79]
    s_waitcnt lgkmcnt(4)
    v_mfma_f32_32x32x16_bf16 v[80:95], a[28:31], v[212:215], v[80:95]
    s_waitcnt vmcnt(33) lgkmcnt(3)
    v_mfma_f32_32x32x16_bf16 v[32:47], a[0:3], v[216:219], v[32:47]
    ds_read_b128 a[16:19], v28 offset:61440
    ds_read_b128 a[20:23], v28 offset:62464
    s_waitcnt vmcnt(23)
    v_accvgpr_read_b32 v12, a64
    v_accvgpr_read_b32 v13, a65
    s_waitcnt lgkmcnt(4)
    v_mfma_f32_32x32x16_bf16 v[48:63], a[4:7], v[216:219], v[48:63]
    ds_read_b128 a[24:27], v28 offset:63488
    ds_read_b128 a[28:31], v28 offset:64512
    v_accvgpr_read_b32 v14, a66
    v_accvgpr_read_b32 v15, a67
    s_waitcnt lgkmcnt(5)
    v_mfma_f32_32x32x16_bf16 v[64:79], a[8:11], v[216:219], v[64:79]
    v_add_f32 v12, v12, v14
    v_add_f32 v13, v13, v15
    s_waitcnt lgkmcnt(4)
    v_mfma_f32_32x32x16_bf16 v[80:95], a[12:15], v[216:219], v[80:95]
    s_waitcnt vmcnt(22)
    v_accvgpr_read_b32 v14, a68
    v_accvgpr_read_b32 v15, a69
    s_add_u32 s78, s78, 122880
    v_lshlrev_b32 v9, 7, v2
    buffer_load_dword v31, v9, s[20:23], s78 offen sc1
    s_waitcnt lgkmcnt(3)
    v_mfma_f32_32x32x16_bf16 v[32:47], a[16:19], v[220:223], v[32:47]
    ds_read_b128 a[0:3], v29 offset:0
    ds_read_b128 a[4:7], v29 offset:1024
    v_add_f32 v12, v12, v14
    v_add_f32 v13, v13, v15
    s_waitcnt lgkmcnt(4)
    v_mfma_f32_32x32x16_bf16 v[48:63], a[20:23], v[220:223], v[48:63]
    ds_read_b128 a[8:11], v29 offset:2048
    ds_read_b128 a[12:15], v29 offset:3072
    v_accvgpr_read_b32 v14, a70
    v_accvgpr_read_b32 v15, a71
    s_waitcnt lgkmcnt(5)
    v_mfma_f32_32x32x16_bf16 v[64:79], a[24:27], v[220:223], v[64:79]
    v_add_f32 v12, v12, v14
    v_add_f32 v13, v13, v15
    s_waitcnt lgkmcnt(4)
    v_mfma_f32_32x32x16_bf16 v[80:95], a[28:31], v[220:223], v[80:95]
    s_waitcnt vmcnt(22)
    v_accvgpr_read_b32 v14, a72
    v_accvgpr_read_b32 v15, a73
    s_waitcnt lgkmcnt(3)
    v_mfma_f32_32x32x16_bf16 v[32:47], a[0:3], v[224:227], v[32:47]
    ds_read_b128 a[16:19], v29 offset:4096
    ds_read_b128 a[20:23], v29 offset:5120
    v_add_f32 v12, v12, v14
    v_add_f32 v13, v13, v15
    s_waitcnt lgkmcnt(4)
    v_mfma_f32_32x32x16_bf16 v[48:63], a[4:7], v[224:227], v[48:63]
    ds_read_b128 a[24:27], v29 offset:6144
    ds_read_b128 a[28:31], v29 offset:7168
    v_accvgpr_read_b32 v14, a74
    v_accvgpr_read_b32 v15, a75
    s_waitcnt lgkmcnt(5)
    v_mfma_f32_32x32x16_bf16 v[64:79], a[8:11], v[224:227], v[64:79]
    v_add_f32 v12, v12, v14
    v_add_f32 v13, v13, v15
    s_waitcnt lgkmcnt(4)
    v_mfma_f32_32x32x16_bf16 v[80:95], a[12:15], v[224:227], v[80:95]
    s_waitcnt vmcnt(21)
    v_accvgpr_read_b32 v14, a76
    v_accvgpr_read_b32 v15, a77
    s_waitcnt lgkmcnt(3)
    v_mfma_f32_32x32x16_bf16 v[32:47], a[16:19], v[228:231], v[32:47]
    ds_read_b128 a[0:3], v29 offset:8192
    ds_read_b128 a[4:7], v29 offset:9216
    v_add_f32 v12, v12, v14
    v_add_f32 v13, v13, v15
    s_waitcnt lgkmcnt(4)
    v_mfma_f32_32x32x16_bf16 v[48:63], a[20:23], v[228:231], v[48:63]
    ds_read_b128 a[8:11], v29 offset:10240
    ds_read_b128 a[12:15], v29 offset:11264
    v_accvgpr_read_b32 v14, a78
    v_accvgpr_read_b32 v15, a79
    s_waitcnt lgkmcnt(5)
    v_mfma_f32_32x32x16_bf16 v[64:79], a[24:27], v[228:231], v[64:79]
    v_add_f32 v12, v12, v14
    v_add_f32 v13, v13, v15
    s_waitcnt lgkmcnt(4)
    v_mfma_f32_32x32x16_bf16 v[80:95], a[28:31], v[228:231], v[80:95]
    v_mov_b32 v8, v12
    s_nop 1
    v_permlane32_swap_b32 v12, v8
    s_waitcnt lgkmcnt(3)
    v_mfma_f32_32x32x16_bf16 v[32:47], a[0:3], v[232:235], v[32:47]
    ds_read_b128 a[16:19], v29 offset:12288
    ds_read_b128 a[20:23], v29 offset:13312
    v_add_f32 v12, v12, v8
    v_mov_b32 v8, v13
    s_waitcnt lgkmcnt(4)
    v_mfma_f32_32x32x16_bf16 v[48:63], a[4:7], v[232:235], v[48:63]
    ds_read_b128 a[24:27], v29 offset:14336
    ds_read_b128 a[28:31], v29 offset:15360
    v_permlane32_swap_b32 v13, v8
    v_add_f32 v13, v13, v8
    s_waitcnt lgkmcnt(5)
    v_mfma_f32_32x32x16_bf16 v[64:79], a[8:11], v[232:235], v[64:79]
    v_mul_f32 v12, 0x3acccccd, v12
    v_mul_f32 v13, 0x3acccccd, v13
    s_waitcnt lgkmcnt(4)
    v_mfma_f32_32x32x16_bf16 v[80:95], a[12:15], v[232:235], v[80:95]
    v_fma_f32 v8, -v12, v12, v13
    v_max_f32 v8, 0, v8
    s_waitcnt lgkmcnt(3)
    v_mfma_f32_32x32x16_bf16 v[32:47], a[16:19], v[236:239], v[32:47]
    ds_read_b128 a[0:3], v29 offset:16384
    ds_read_b128 a[4:7], v29 offset:17408
    v_cvt_pk_bf16_f32 v14, v12, v12
    v_and_b32 v14, 0xffff0000, v14
    s_waitcnt lgkmcnt(4)
    v_mfma_f32_32x32x16_bf16 v[48:63], a[20:23], v[236:239], v[48:63]
    ds_read_b128 a[8:11], v29 offset:18432
    ds_read_b128 a[12:15], v29 offset:19456
    v_cvt_pk_bf16_f32 v8, v8, v8
    v_and_b32 v8, 0xffff0000, v8
    s_waitcnt lgkmcnt(5)
    v_mfma_f32_32x32x16_bf16 v[64:79], a[24:27], v[236:239], v[64:79]
    v_add_f32 v8, 0x3727c5ac, v8
    v_cvt_pk_bf16_f32 v8, v8, v8
    s_waitcnt lgkmcnt(4)
    v_mfma_f32_32x32x16_bf16 v[80:95], a[28:31], v[236:239], v[80:95]
    v_and_b32 v8, 0xffff0000, v8
    v_sqrt_f32 v8, v8
    s_waitcnt lgkmcnt(3)
    v_mfma_f32_32x32x16_bf16 v[32:47], a[0:3], v[240:243], v[32:47]
    ds_read_b128 a[16:19], v29 offset:20480
    ds_read_b128 a[20:23], v29 offset:21504
    v_cvt_pk_bf16_f32 v10, v8, v8
    v_and_b32 v10, 0xffff0000, v10
    s_waitcnt lgkmcnt(4)
    v_mfma_f32_32x32x16_bf16 v[48:63], a[4:7], v[240:243], v[48:63]
    ds_read_b128 a[24:27], v29 offset:22528
    ds_read_b128 a[28:31], v29 offset:23552
    v_rcp_f32 v11, v10
    v_cvt_pk_bf16_f32 v14, -v14, -v14
    s_waitcnt lgkmcnt(5)
    v_mfma_f32_32x32x16_bf16 v[64:79], a[8:11], v[240:243], v[64:79]
    v_cmp_eq_u32 vcc, 0, v6
    v_mul_f32 v11, 0xbfb8aa3b, v11
    s_waitcnt lgkmcnt(4)
    v_mfma_f32_32x32x16_bf16 v[80:95], a[12:15], v[240:243], v[80:95]
    v_mov_b32 v13, 0
    v_mov_b32 v15, 0
    s_waitcnt lgkmcnt(3)
    v_mfma_f32_32x32x16_bf16 v[32:47], a[16:19], v[244:247], v[32:47]
    ds_read_b128 a[0:3], v29 offset:24576
    ds_read_b128 a[4:7], v29 offset:25600
    v_cndmask_b32 v12, 0, v14, vcc
    v_cndmask_b32 v14, v14, 0, vcc
    s_waitcnt lgkmcnt(4)
    v_mfma_f32_32x32x16_bf16 v[48:63], a[20:23], v[244:247], v[48:63]
    ds_read_b128 a[8:11], v29 offset:26624
    ds_read_b128 a[12:15], v29 offset:27648
    s_waitcnt lgkmcnt(5)
    v_mfma_f32_32x32x16_bf16 v[64:79], a[24:27], v[244:247], v[64:79]
    s_waitcnt lgkmcnt(4)
    v_mfma_f32_32x32x16_bf16 v[80:95], a[28:31], v[244:247], v[80:95]
    s_waitcnt lgkmcnt(3)
    v_mfma_f32_32x32x16_bf16 v[32:47], a[0:3], v[248:251], v[32:47]
    ds_read_b128 a[16:19], v29 offset:28672
    ds_read_b128 a[20:23], v29 offset:29696
    s_waitcnt lgkmcnt(4)
    v_mfma_f32_32x32x16_bf16 v[48:63], a[4:7], v[248:251], v[48:63]
    ds_read_b128 a[24:27], v29 offset:30720
    ds_read_b128 a[28:31], v29 offset:31744
    s_waitcnt lgkmcnt(5)
    v_mfma_f32_32x32x16_bf16 v[64:79], a[8:11], v[248:251], v[64:79]
    s_waitcnt lgkmcnt(4)
    v_mfma_f32_32x32x16_bf16 v[80:95], a[12:15], v[248:251], v[80:95]
    s_waitcnt lgkmcnt(0)
    s_waitcnt vmcnt(1)
    s_barrier
    v_mfma_f32_32x32x16_bf16 v[32:47], a[16:19], v[252:255], v[32:47]
    ds_read_b128 a[0:3], v5 offset:0
    ds_read_b128 a[4:7], v5 offset:1024
    v_mfma_f32_32x32x16_bf16 v[48:63], a[20:23], v[252:255], v[48:63]
    ds_read_b128 a[8:11], v5 offset:2048
    ds_read_b128 a[12:15], v5 offset:3072
    v_mfma_f32_32x32x16_bf16 v[64:79], a[24:27], v[252:255], v[64:79]
    v_mfma_f32_32x32x16_bf16 v[80:95], a[28:31], v[252:255], v[80:95]
    s_bitcmp1_b32 s53, 0
    s_cbranch_scc1 L_codd
    v_mfma_f32_32x32x8_bf16 a[32:47], a[248:249], v[14:15], 0
    v_mfma_f32_32x32x8_bf16 a[48:63], a[250:251], v[14:15], 0
    v_mfma_f32_32x32x8_bf16 v[32:47], a[248:249], v[12:13], v[32:47]
    v_mfma_f32_32x32x8_bf16 v[48:63], a[250:251], v[12:13], v[48:63]
    v_mfma_f32_32x32x8_bf16 v[64:79], a[252:253], v[12:13], v[64:79]
    v_mfma_f32_32x32x8_bf16 v[80:95], a[254:255], v[12:13], v[80:95]
    s_branch L_cj
L_codd:
    v_mfma_f32_32x32x8_bf16 a[32:47], a[252:253], v[14:15], 0
    v_mfma_f32_32x32x8_bf16 a[48:63], a[254:255], v[14:15], 0
    v_mfma_f32_32x32x8_bf16 v[32:47], a[252:253], v[12:13], v[32:47]
    v_mfma_f32_32x32x8_bf16 v[48:63], a[254:255], v[12:13], v[48:63]
    v_mfma_f32_32x32x8_bf16 v[64:79], a[248:249], v[14:15], v[64:79]
    v_mfma_f32_32x32x8_bf16 v[80:95], a[250:251], v[14:15], v[80:95]
L_cj:
    s_waitcnt lgkmcnt(2)
    v_mfma_f32_32x32x16_bf16 a[32:47], a[0:3], v[96:99], a[32:47]
    ds_read_b128 a[16:19], v5 offset:4096
    ds_read_b128 a[20:23], v5 offset:5120
    s_mul_i32 s36, s54, 96
    s_lshl_b32 s45, s53, 2
    s_add_u32 s45, s45, s36
    s_lshl_b32 s45, s45, 10
    s_add_u32 s57, s45, 13369344
    v_mfma_f32_32x32x16_bf16 a[48:63], a[4:7], v[96:99], a[48:63]
    s_lshl_b32 s45, s53, 1
    s_add_u32 s45, s45, s36
    s_lshl_b32 s45, s45, 10
    s_add_u32 s58, s45, 13434880
    s_mul_i32 s35, s24, 5120
    s_mul_i32 s29, s26, 245760
    s_waitcnt lgkmcnt(2)
    v_mfma_f32_32x32x16_bf16 a[32:47], a[8:11], v[100:103], a[32:47]
    ds_read_b128 a[24:27], v5 offset:6144
    ds_read_b128 a[28:31], v5 offset:7168
    s_add_u32 s29, s29, s35
    s_add_u32 s29, s29, 21266432
    v_mul_f32 v32, v11, v32
    v_mul_f32 v33, v11, v33
    v_mul_f32 v34, v11, v34
    v_mfma_f32_32x32x16_bf16 a[48:63], a[12:15], v[100:103], a[48:63]
    v_mul_f32 v35, v11, v35
    v_exp_f32 v32, v32
    v_exp_f32 v33, v33
    s_waitcnt lgkmcnt(2)
    v_mfma_f32_32x32x16_bf16 a[32:47], a[16:19], v[104:107], a[32:47]
    ds_read_b128 a[0:3], v5 offset:8192
    ds_read_b128 a[4:7], v5 offset:9216
    v_exp_f32 v34, v34
    v_exp_f32 v35, v35
    v_fma_f32 v32, v32, v10, v10
    v_mfma_f32_32x32x16_bf16 a[48:63], a[20:23], v[104:107], a[48:63]
    v_fma_f32 v33, v33, v10, v10
    v_fma_f32 v34, v34, v10, v10
    v_fma_f32 v35, v35, v10, v10
    v_rcp_f32 v32, v32
    s_waitcnt lgkmcnt(2)
    v_mfma_f32_32x32x16_bf16 a[32:47], a[24:27], v[108:111], a[32:47]
    ds_read_b128 a[8:11], v5 offset:10240
    ds_read_b128 a[12:15], v5 offset:11264
    v_rcp_f32 v33, v33
    v_rcp_f32 v34, v34
    v_mfma_f32_32x32x16_bf16 a[48:63], a[28:31], v[108:111], a[48:63]
    s_add_u32 m0, s35, 81920
    s_add_u32 s46, s29, 0
    buffer_load_dwordx4 v5, s[20:23], s46 offen sc1 lds
    v_rcp_f32 v35, v35
    v_mul_f32 v32, v32, v36
    s_waitcnt lgkmcnt(2)
    v_mfma_f32_32x32x16_bf16 a[32:47], a[0:3], v[112:115], a[32:47]
    ds_read_b128 a[16:19], v5 offset:12288
    ds_read_b128 a[20:23], v5 offset:13312
    v_mul_f32 v33, v33, v37
    v_mul_f32 v34, v34, v38
    v_mul_f32 v35, v35, v39
    v_mul_f32 v40, v11, v40
    v_mul_f32 v41, v11, v41
    v_mfma_f32_32x32x16_bf16 a[48:63], a[4:7], v[112:115], a[48:63]
    v_mul_f32 v42, v11, v42
    v_mul_f32 v43, v11, v43
    v_exp_f32 v40, v40
    v_exp_f32 v41, v41
    s_waitcnt lgkmcnt(2)
    v_mfma_f32_32x32x16_bf16 a[32:47], a[8:11], v[116:119], a[32:47]
    ds_read_b128 a[24:27], v5 offset:14336
    ds_read_b128 a[28:31], v5 offset:15360
    v_exp_f32 v42, v42
    v_exp_f32 v43, v43
    v_fma_f32 v40, v40, v10, v10
    v_mfma_f32_32x32x16_bf16 a[48:63], a[12:15], v[116:119], a[48:63]
    buffer_load_dwordx4 v5, s[20:23], s46 offen offset:1024 sc1 lds
    v_fma_f32 v41, v41, v10, v10
    v_fma_f32 v42, v42, v10, v10
    v_fma_f32 v43, v43, v10, v10
    v_rcp_f32 v40, v40
    s_waitcnt lgkmcnt(2)
    v_mfma_f32_32x32x16_bf16 a[32:47], a[16:19], v[120:123], a[32:47]
    ds_read_b128 a[0:3], v5 offset:16384
    ds_read_b128 a[4:7], v5 offset:17408
    v_rcp_f32 v41, v41
    v_rcp_f32 v42, v42
    v_mfma_f32_32x32x16_bf16 a[48:63], a[20:23], v[120:123], a[48:63]
    v_rcp_f32 v43, v43
    v_mul_f32 v40, v40, v44
    v_mul_f32 v41, v41, v45
    v_mul_f32 v42, v42, v46
    v_mul_f32 v43, v43, v47
    s_waitcnt lgkmcnt(2)
    v_mfma_f32_32x32x16_bf16 a[32:47], a[24:27], v[124:127], a[32:47]
    ds_read_b128 a[8:11], v5 offset:18432
    ds_read_b128 a[12:15], v5 offset:19456
    v_cvt_pk_bf16_f32 v36, v32, v33
    v_cvt_pk_bf16_f32 v37, v34, v35
    v_cvt_pk_bf16_f32 v38, v40, v41
    v_cvt_pk_bf16_f32 v39, v42, v43
    buffer_store_dwordx4 v[36:39], v5, s[20:23], s57 offen offset:0 sc1
    v_mfma_f32_32x32x16_bf16 a[48:63], a[28:31], v[124:127], a[48:63]
    buffer_load_dwordx4 v5, s[20:23], s46 offen offset:2048 sc1 lds
    v_mul_f32 v48, v11, v48
    v_mul_f32 v49, v11, v49
    v_mul_f32 v50, v11, v50
    v_mul_f32 v51, v11, v51
    s_waitcnt lgkmcnt(2)
    v_mfma_f32_32x32x16_bf16 a[32:47], a[0:3], v[128:131], a[32:47]
    ds_read_b128 a[16:19], v5 offset:20480
    ds_read_b128 a[20:23], v5 offset:21504
    v_exp_f32 v48, v48
    v_exp_f32 v49, v49
    v_mfma_f32_32x32x16_bf16 a[48:63], a[4:7], v[128:131], a[48:63]
    v_exp_f32 v50, v50
    v_exp_f32 v51, v51
    v_fma_f32 v48, v48, v10, v10
    v_fma_f32 v49, v49, v10, v10
    s_waitcnt lgkmcnt(2)
    v_mfma_f32_32x32x16_bf16 a[32:47], a[8:11], v[132:135], a[32:47]
    ds_read_b128 a[24:27], v5 offset:22528
    ds_read_b128 a[28:31], v5 offset:23552
    v_fma_f32 v50, v50, v10, v10
    v_fma_f32 v51, v51, v10, v10
    v_rcp_f32 v48, v48
    v_mfma_f32_32x32x16_bf16 a[48:63], a[12:15], v[132:135], a[48:63]
    buffer_load_dwordx4 v5, s[20:23], s46 offen offset:3072 sc1 lds
    v_rcp_f32 v49, v49
    v_rcp_f32 v50, v50
    s_waitcnt lgkmcnt(2)
    v_mfma_f32_32x32x16_bf16 a[32:47], a[16:19], v[136:139], a[32:47]
    ds_read_b128 a[0:3], v5 offset:24576
    ds_read_b128 a[4:7], v5 offset:25600
    v_rcp_f32 v51, v51
    v_mul_f32 v48, v48, v52
    v_mul_f32 v49, v49, v53
    v_mul_f32 v50, v50, v54
    v_mfma_f32_32x32x16_bf16 a[48:63], a[20:23], v[136:139], a[48:63]
    v_mul_f32 v51, v51, v55
    v_mul_f32 v56, v11, v56
    v_mul_f32 v57, v11, v57
    v_mul_f32 v58, v11, v58
    v_mul_f32 v59, v11, v59
    s_waitcnt lgkmcnt(2)
    v_mfma_f32_32x32x16_bf16 a[32:47], a[24:27], v[140:143], a[32:47]
    ds_read_b128 a[8:11], v5 offset:26624
    ds_read_b128 a[12:15], v5 offset:27648
    v_exp_f32 v56, v56
    v_exp_f32 v57, v57
    v_mfma_f32_32x32x16_bf16 a[48:63], a[28:31], v[140:143], a[48:63]
    s_add_u32 m0, s35, 86016
    s_add_u32 s46, s29, 4096
    buffer_load_dwordx4 v5, s[20:23], s46 offen sc1 lds
    v_exp_f32 v58, v58
    s_waitcnt lgkmcnt(2)
    v_mfma_f32_32x32x16_bf16 a[32:47], a[0:3], v[144:147], a[32:47]
    ds_read_b128 a[16:19], v5 offset:28672
    ds_read_b128 a[20:23], v5 offset:29696
    v_exp_f32 v59, v59
    v_fma_f32 v56, v56, v10, v10
    v_fma_f32 v57, v57, v10, v10
    v_fma_f32 v58, v58, v10, v10
    v_mfma_f32_32x32x16_bf16 a[48:63], a[4:7], v[144:147], a[48:63]
    v_fma_f32 v59, v59, v10, v10
    v_rcp_f32 v56, v56
    v_rcp_f32 v57, v57
    s_waitcnt lgkmcnt(2)
    v_mfma_f32_32x32x16_bf16 a[32:47], a[8:11], v[148:151], a[32:47]
    ds_read_b128 a[24:27], v5 offset:30720
    ds_read_b128 a[28:31], v5 offset:31744
    v_rcp_f32 v58, v58
    v_rcp_f32 v59, v59
    v_mul_f32 v56, v56, v60
    v_mfma_f32_32x32x16_bf16 a[48:63], a[12:15], v[148:151], a[48:63]
    s_add_u32 m0, s35, 102400
    s_add_u32 s46, s29, 20480
    buffer_load_dwordx4 v5, s[20:23], s46 offen sc1 lds
    v_mul_f32 v57, v57, v61
    v_mul_f32 v58, v58, v62
    v_mul_f32 v59, v59, v63
    s_waitcnt lgkmcnt(2)
    v_mfma_f32_32x32x16_bf16 a[32:47], a[16:19], v[152:155], a[32:47]
    ds_read_b128 a[0:3], v5 offset:32768
    ds_read_b128 a[4:7], v5 offset:33792
    v_cvt_pk_bf16_f32 v52, v48, v49
    v_cvt_pk_bf16_f32 v53, v50, v51
    v_cvt_pk_bf16_f32 v54, v56, v57
    v_cvt_pk_bf16_f32 v55, v58, v59
    buffer_store_dwordx4 v[52:55], v5, s[20:23], s57 offen offset:1024 sc1
    v_mfma_f32_32x32x16_bf16 a[48:63], a[20:23], v[152:155], a[48:63]
    v_mul_f32 v64, v11, v64
    v_mul_f32 v65, v11, v65
    v_mul_f32 v66, v11, v66
    v_mul_f32 v67, v11, v67
    v_exp_f32 v64, v64
    s_waitcnt lgkmcnt(2)
    v_mfma_f32_32x32x16_bf16 a[32:47], a[24:27], v[156:159], a[32:47]
    ds_read_b128 a[8:11], v5 offset:34816
    ds_read_b128 a[12:15], v5 offset:35840
    v_exp_f32 v65, v65
    v_exp_f32 v66, v66
    v_mfma_f32_32x32x16_bf16 a[48:63], a[28:31], v[156:159], a[48:63]
    buffer_load_dwordx4 v5, s[20:23], s46 offen offset:1024 sc1 lds
    v_exp_f32 v67, v67
    v_fma_f32 v64, v64, v10, v10
    v_fma_f32 v65, v65, v10, v10
    v_fma_f32 v66, v66, v10, v10
    s_waitcnt lgkmcnt(2)
    v_mfma_f32_32x32x16_bf16 a[32:47], a[0:3], v[160:163], a[32:47]
    ds_read_b128 a[16:19], v5 offset:36864
    ds_read_b128 a[20:23], v5 offset:37888
    v_fma_f32 v67, v67, v10, v10
    v_rcp_f32 v64, v64
    v_rcp_f32 v65, v65
    v_mfma_f32_32x32x16_bf16 a[48:63], a[4:7], v[160:163], a[48:63]
    v_rcp_f32 v66, v66
    v_rcp_f32 v67, v67
    v_mul_f32 v64, v64, v68
    v_mul_f32 v65, v65, v69
    s_waitcnt lgkmcnt(2)
    v_mfma_f32_32x32x16_bf16 a[32:47], a[8:11], v[164:167], a[32:47]
    ds_read_b128 a[24:27], v5 offset:38912
    ds_read_b128 a[28:31], v5 offset:39936
    v_mul_f32 v66, v66, v70
    v_mul_f32 v67, v67, v71
    v_mul_f32 v72, v11, v72
    v_mul_f32 v73, v11, v73
    v_mul_f32 v74, v11, v74
    v_mfma_f32_32x32x16_bf16 a[48:63], a[12:15], v[164:167], a[48:63]
    buffer_load_dwordx4 v5, s[20:23], s46 offen offset:2048 sc1 lds
    v_mul_f32 v75, v11, v75
    v_exp_f32 v72, v72
    v_exp_f32 v73, v73
    s_waitcnt lgkmcnt(2)
    v_mfma_f32_32x32x16_bf16 a[32:47], a[16:19], v[168:171], a[32:47]
    ds_read_b128 a[0:3], v5 offset:40960
    ds_read_b128 a[4:7], v5 offset:41984
    v_exp_f32 v74, v74
    v_exp_f32 v75, v75
    v_fma_f32 v72, v72, v10, v10
    v_mfma_f32_32x32x16_bf16 a[48:63], a[20:23], v[168:171], a[48:63]
    v_fma_f32 v73, v73, v10, v10
    v_fma_f32 v74, v74, v10, v10
    v_fma_f32 v75, v75, v10, v10
    v_rcp_f32 v72, v72
    s_waitcnt lgkmcnt(2)
    v_mfma_f32_32x32x16_bf16 a[32:47], a[24:27], v[172:175], a[32:47]
    ds_read_b128 a[8:11], v5 offset:43008
    ds_read_b128 a[12:15], v5 offset:44032
    v_rcp_f32 v73, v73
    v_rcp_f32 v74, v74
    v_mfma_f32_32x32x16_bf16 a[48:63], a[28:31], v[172:175], a[48:63]
    buffer_load_dwordx4 v5, s[20:23], s46 offen offset:3072 sc1 lds
    v_rcp_f32 v75, v75
    v_mul_f32 v72, v72, v76
    v_mul_f32 v73, v73, v77
    v_mul_f32 v74, v74, v78
    s_waitcnt lgkmcnt(2)
    v_mfma_f32_32x32x16_bf16 a[32:47], a[0:3], v[176:179], a[32:47]
    ds_read_b128 a[16:19], v5 offset:45056
    ds_read_b128 a[20:23], v5 offset:46080
    v_mul_f32 v75, v75, v79
    v_cvt_pk_bf16_f32 v68, v64, v65
    v_cvt_pk_bf16_f32 v69, v66, v67
    v_cvt_pk_bf16_f32 v70, v72, v73
    v_cvt_pk_bf16_f32 v71, v74, v75
    v_mfma_f32_32x32x16_bf16 a[48:63], a[4:7], v[176:179], a[48:63]
    buffer_store_dwordx4 v[68:71], v5, s[20:23], s57 offen offset:2048 sc1
    v_mul_f32 v80, v11, v80
    v_mul_f32 v81, v11, v81
    v_mul_f32 v82, v11, v82
    v_mul_f32 v83, v11, v83
    s_waitcnt lgkmcnt(2)
    v_mfma_f32_32x32x16_bf16 a[32:47], a[8:11], v[180:183], a[32:47]
    ds_read_b128 a[24:27], v5 offset:47104
    ds_read_b128 a[28:31], v5 offset:48128
    v_exp_f32 v80, v80
    v_exp_f32 v81, v81
    v_mfma_f32_32x32x16_bf16 a[48:63], a[12:15], v[180:183], a[48:63]
    s_add_u32 m0, s35, 106496
    s_add_u32 s46, s29, 24576
    buffer_load_dwordx4 v5, s[20:23], s46 offen sc1 lds
    v_exp_f32 v82, v82
    s_waitcnt lgkmcnt(2)
    v_mfma_f32_32x32x16_bf16 a[32:47], a[16:19], v[184:187], a[32:47]
    ds_read_b128 a[0:3], v5 offset:49152
    ds_read_b128 a[4:7], v5 offset:50176
    v_exp_f32 v83, v83
    v_fma_f32 v80, v80, v10, v10
    v_fma_f32 v81, v81, v10, v10
    v_fma_f32 v82, v82, v10, v10
    v_mfma_f32_32x32x16_bf16 a[48:63], a[20:23], v[184:187], a[48:63]
    v_fma_f32 v83, v83, v10, v10
    v_rcp_f32 v80, v80
    v_rcp_f32 v81, v81
    s_waitcnt lgkmcnt(2)
    v_mfma_f32_32x32x16_bf16 a[32:47], a[24:27], v[188:191], a[32:47]
    ds_read_b128 a[8:11], v5 offset:51200
    ds_read_b128 a[12:15], v5 offset:52224
    v_rcp_f32 v82, v82
    v_rcp_f32 v83, v83
    v_mul_f32 v80, v80, v84
    v_mfma_f32_32x32x16_bf16 a[48:63], a[28:31], v[188:191], a[48:63]
    s_add_u32 m0, s35, 122880
    s_add_u32 s46, s29, 40960
    buffer_load_dwordx4 v5, s[20:23], s46 offen sc1 lds
    v_mul_f32 v81, v81, v85
    v_mul_f32 v82, v82, v86
    v_mul_f32 v83, v83, v87
    s_waitcnt lgkmcnt(2)
    v_mfma_f32_32x32x16_bf16 a[32:47], a[0:3], v[192:195], a[32:47]
    ds_read_b128 a[16:19], v5 offset:53248
    ds_read_b128 a[20:23], v5 offset:54272
    v_mul_f32 v88, v11, v88
    v_mul_f32 v89, v11, v89
    v_mul_f32 v90, v11, v90
    v_mul_f32 v91, v11, v91
    v_mfma_f32_32x32x16_bf16 a[48:63], a[4:7], v[192:195], a[48:63]
    v_exp_f32 v88, v88
    v_exp_f32 v89, v89
    v_exp_f32 v90, v90
    s_waitcnt lgkmcnt(2)
    v_mfma_f32_32x32x16_bf16 a[32:47], a[8:11], v[196:199], a[32:47]
    ds_read_b128 a[24:27], v5 offset:55296
    ds_read_b128 a[28:31], v5 offset:56320
    v_exp_f32 v91, v91
    v_fma_f32 v88, v88, v10, v10
    v_fma_f32 v89, v89, v10, v10
    v_fma_f32 v90, v90, v10, v10
    v_mfma_f32_32x32x16_bf16 a[48:63], a[12:15], v[196:199], a[48:63]
    buffer_load_dwordx4 v5, s[20:23], s46 offen offset:1024 sc1 lds
    v_fma_f32 v91, v91, v10, v10
    v_rcp_f32 v88, v88
    v_rcp_f32 v89, v89
    s_waitcnt lgkmcnt(2)
    v_mfma_f32_32x32x16_bf16 a[32:47], a[16:19], v[200:203], a[32:47]
    ds_read_b128 a[0:3], v5 offset:57344
    ds_read_b128 a[4:7], v5 offset:58368
    v_rcp_f32 v90, v90
    v_rcp_f32 v91, v91
    v_mul_f32 v88, v88, v92
    v_mfma_f32_32x32x16_bf16 a[48:63], a[20:23], v[200:203], a[48:63]
    v_mul_f32 v89, v89, v93
    v_mul_f32 v90, v90, v94
    v_mul_f32 v91, v91, v95
    v_cvt_pk_bf16_f32 v84, v80, v81
    v_cvt_pk_bf16_f32 v85, v82, v83
    v_cvt_pk_bf16_f32 v86, v88, v89
    s_waitcnt lgkmcnt(2)
    v_mfma_f32_32x32x16_bf16 a[32:47], a[24:27], v[204:207], a[32:47]
    ds_read_b128 a[8:11], v5 offset:59392
    ds_read_b128 a[12:15], v5 offset:60416
    v_cvt_pk_bf16_f32 v87, v90, v91
    buffer_store_dwordx4 v[84:87], v5, s[20:23], s57 offen offset:3072 sc1
    v_mfma_f32_32x32x16_bf16 a[48:63], a[28:31], v[204:207], a[48:63]
    buffer_load_dwordx4 v5, s[20:23], s46 offen offset:2048 sc1 lds
    s_waitcnt lgkmcnt(2)
    v_mfma_f32_32x32x16_bf16 a[32:47], a[0:3], v[208:211], a[32:47]
    ds_read_b128 a[16:19], v5 offset:61440
    ds_read_b128 a[20:23], v5 offset:62464
    v_mfma_f32_32x32x16_bf16 a[48:63], a[4:7], v[208:211], a[48:63]
    buffer_load_dwordx4 v5, s[20:23], s46 offen offset:3072 sc1 lds
    s_waitcnt lgkmcnt(2)
    v_mfma_f32_32x32x16_bf16 a[32:47], a[8:11], v[212:215], a[32:47]
    ds_read_b128 a[24:27], v5 offset:63488
    ds_read_b128 a[28:31], v5 offset:64512
    v_mfma_f32_32x32x16_bf16 a[48:63], a[12:15], v[212:215], a[48:63]
    s_add_u32 m0, s35, 126976
    s_add_u32 s46, s29, 45056
    buffer_load_dwordx4 v5, s[20:23], s46 offen sc1 lds
    s_waitcnt lgkmcnt(2)
    v_mfma_f32_32x32x16_bf16 a[32:47], a[16:19], v[216:219], a[32:47]
    ds_read_b128 a[0:3], v28 offset:0
    ds_read_b128 a[4:7], v28 offset:1024
    v_mfma_f32_32x32x16_bf16 a[48:63], a[20:23], v[216:219], a[48:63]
    s_add_u32 m0, s35, 143360
    s_add_u32 s46, s29, 61440
    buffer_load_dwordx4 v5, s[20:23], s46 offen sc1 lds
    s_waitcnt lgkmcnt(2)
    v_mfma_f32_32x32x16_bf16 a[32:47], a[24:27], v[220:223], a[32:47]
    ds_read_b128 a[8:11], v28 offset:2048
    ds_read_b128 a[12:15], v28 offset:3072
    v_mfma_f32_32x32x16_bf16 a[48:63], a[28:31], v[220:223], a[48:63]
    buffer_load_dwordx4 v5, s[20:23], s46 offen offset:1024 sc1 lds
    s_waitcnt lgkmcnt(2)
    v_mfma_f32_32x32x16_bf16 a[32:47], a[0:3], v[224:227], a[32:47]
    ds_read_b128 a[16:19], v28 offset:4096
    ds_read_b128 a[20:23], v28 offset:5120
    v_mfma_f32_32x32x16_bf16 a[48:63], a[4:7], v[224:227], a[48:63]
    buffer_load_dwordx4 v5, s[20:23], s46 offen offset:2048 sc1 lds
    s_waitcnt lgkmcnt(2)
    v_mfma_f32_32x32x16_bf16 a[32:47], a[8:11], v[228:231], a[32:47]
    ds_read_b128 a[24:27], v28 offset:6144
    ds_read_b128 a[28:31], v28 offset:7168
    v_mfma_f32_32x32x16_bf16 a[48:63], a[12:15], v[228:231], a[48:63]
    buffer_load_dwordx4 v5, s[20:23], s46 offen offset:3072 sc1 lds
    s_waitcnt lgkmcnt(2)
    v_mfma_f32_32x32x16_bf16 a[32:47], a[16:19], v[232:235], a[32:47]
    ds_read_b128 a[0:3], v28 offset:8192
    ds_read_b128 a[4:7], v28 offset:9216
    v_mfma_f32_32x32x16_bf16 a[48:63], a[20:23], v[232:235], a[48:63]
    s_add_u32 m0, s35, 147456
    s_add_u32 s46, s29, 65536
    buffer_load_dwordx4 v5, s[20:23], s46 offen sc1 lds
    s_waitcnt lgkmcnt(2)
    v_mfma_f32_32x32x16_bf16 a[32:47], a[24:27], v[236:239], a[32:47]
    ds_read_b128 a[8:11], v28 offset:10240
    ds_read_b128 a[12:15], v28 offset:11264
    v_mfma_f32_32x32x16_bf16 a[48:63], a[28:31], v[236:239], a[48:63]
    s_waitcnt lgkmcnt(2)
    v_mfma_f32_32x32x16_bf16 a[32:47], a[0:3], v[240:243], a[32:47]
    ds_read_b128 a[16:19], v28 offset:12288
    ds_read_b128 a[20:23], v28 offset:13312
    v_mfma_f32_32x32x16_bf16 a[48:63], a[4:7], v[240:243], a[48:63]
    s_waitcnt lgkmcnt(2)
    v_mfma_f32_32x32x16_bf16 a[32:47], a[8:11], v[244:247], a[32:47]
    ds_read_b128 a[24:27], v28 offset:14336
    ds_read_b128 a[28:31], v28 offset:15360
    v_mfma_f32_32x32x16_bf16 a[48:63], a[12:15], v[244:247], a[48:63]
    s_waitcnt lgkmcnt(2)
    v_mfma_f32_32x32x16_bf16 a[32:47], a[16:19], v[248:251], a[32:47]
    v_mfma_f32_32x32x16_bf16 a[48:63], a[20:23], v[248:251], a[48:63]
    s_waitcnt lgkmcnt(0)
    v_mfma_f32_32x32x16_bf16 a[32:47], a[24:27], v[252:255], a[32:47]
    v_mfma_f32_32x32x16_bf16 a[48:63], a[28:31], v[252:255], a[48:63]
    s_add_u32 s40, s56, 27287552
    s_waitcnt vmcnt(8)
    s_barrier
    s_cmp_lg_u32 s24, 0
    s_cbranch_scc1 L_sg6
    v_mov_b32 v8, 1
    s_mov_b64 exec, 0xffff
    buffer_atomic_add v8, v3, s[20:23], s40 offen sc1
    s_mov_b64 exec, -1
L_sg6:
    s_add_u32 s43, s55, 27287552
    s_nop 4
    v_accvgpr_read_b32 v32, a32
    v_accvgpr_read_b32 v33, a33
    v_accvgpr_read_b32 v34, a34
    v_accvgpr_read_b32 v35, a35
    v_accvgpr_read_b32 v36, a36
    v_accvgpr_read_b32 v37, a37
    s_add_u32 m0, s35, 0
    s_add_u32 s46, s29, 81920
    buffer_load_dwordx4 v5, s[20:23], s46 offen sc1 lds
    v_accvgpr_read_b32 v38, a38
    v_accvgpr_read_b32 v39, a39
    v_accvgpr_read_b32 v40, a40
    v_accvgpr_read_b32 v41, a41
    v_accvgpr_read_b32 v42, a42
    v_accvgpr_read_b32 v43, a43
    v_accvgpr_read_b32 v44, a44
    v_accvgpr_read_b32 v45, a45
    v_accvgpr_read_b32 v46, a46
    v_accvgpr_read_b32 v47, a47
    buffer_load_dwordx4 v5, s[20:23], s46 offen offset:1024 sc1 lds
    v_mul_f32 v32, v11, v32
    v_mul_f32 v33, v11, v33
    v_mul_f32 v34, v11, v34
    v_mul_f32 v35, v11, v35
    v_exp_f32 v32, v32
    v_exp_f32 v33, v33
    v_exp_f32 v34, v34
    v_exp_f32 v35, v35
    v_fma_f32 v32, v32, v10, v10
    v_fma_f32 v33, v33, v10, v10
    buffer_load_dwordx4 v5, s[20:23], s46 offen offset:2048 sc1 lds
    v_fma_f32 v34, v34, v10, v10
    v_fma_f32 v35, v35, v10, v10
    v_rcp_f32 v32, v32
    v_rcp_f32 v33, v33
    v_rcp_f32 v34, v34
    v_rcp_f32 v35, v35
    v_mul_f32 v32, v32, v36
    v_mul_f32 v33, v33, v37
    v_mul_f32 v34, v34, v38
    v_mul_f32 v35, v35, v39
    buffer_load_dwordx4 v5, s[20:23], s46 offen offset:3072 sc1 lds
    v_mul_f32 v40, v11, v40
    v_mul_f32 v41, v11, v41
    v_mul_f32 v42, v11, v42
    v_mul_f32 v43, v11, v43
    v_exp_f32 v40, v40
    v_exp_f32 v41, v41
    v_exp_f32 v42, v42
    v_exp_f32 v43, v43
    v_fma_f32 v40, v40, v10, v10
    v_fma_f32 v41, v41, v10, v10
    s_add_u32 m0, s35, 4096
    s_add_u32 s46, s29, 86016
    buffer_load_dwordx4 v5, s[20:23], s46 offen sc1 lds
    v_fma_f32 v42, v42, v10, v10
    v_fma_f32 v43, v43, v10, v10
    v_rcp_f32 v40, v40
    v_rcp_f32 v41, v41
    v_rcp_f32 v42, v42
    v_rcp_f32 v43, v43
    v_mul_f32 v40, v40, v44
    v_mul_f32 v41, v41, v45
    v_mul_f32 v42, v42, v46
    v_mul_f32 v43, v43, v47
    s_add_u32 m0, s35, 20480
    s_add_u32 s46, s29, 102400
    buffer_load_dwordx4 v5, s[20:23], s46 offen sc1 lds
    v_cvt_pk_bf16_f32 v36, v32, v33
    v_cvt_pk_bf16_f32 v37, v34, v35
    v_cvt_pk_bf16_f32 v38, v40, v41
    v_cvt_pk_bf16_f32 v39, v42, v43
    buffer_store_dwordx4 v[36:39], v5, s[20:23], s58 offen offset:0 sc1
    v_accvgpr_read_b32 v48, a48
    v_accvgpr_read_b32 v49, a49
    v_accvgpr_read_b32 v50, a50
    v_accvgpr_read_b32 v51, a51
    v_accvgpr_read_b32 v52, a52
    buffer_load_dwordx4 v5, s[20:23], s46 offen offset:1024 sc1 lds
    v_accvgpr_read_b32 v53, a53
    v_accvgpr_read_b32 v54, a54
    v_accvgpr_read_b32 v55, a55
    v_accvgpr_read_b32 v56, a56
    v_accvgpr_read_b32 v57, a57
    v_accvgpr_read_b32 v58, a58
    v_accvgpr_read_b32 v59, a59
    v_accvgpr_read_b32 v60, a60
    v_accvgpr_read_b32 v61, a61
    v_accvgpr_read_b32 v62, a62
    buffer_load_dwordx4 v5, s[20:23], s46 offen offset:2048 sc1 lds
    v_accvgpr_read_b32 v63, a63
    v_mul_f32 v48, v11, v48
    v_mul_f32 v49, v11, v49
    v_mul_f32 v50, v11, v50
    v_mul_f32 v51, v11, v51
    v_exp_f32 v48, v48
    v_exp_f32 v49, v49
    v_exp_f32 v50, v50
    v_exp_f32 v51, v51
    v_fma_f32 v48, v48, v10, v10
    buffer_load_dwordx4 v5, s[20:23], s46 offen offset:3072 sc1 lds
    v_fma_f32 v49, v49, v10, v10
    v_fma_f32 v50, v50, v10, v10
    v_fma_f32 v51, v51, v10, v10
    v_rcp_f32 v48, v48
    v_rcp_f32 v49, v49
    v_rcp_f32 v50, v50
    v_rcp_f32 v51, v51
    v_mul_f32 v48, v48, v52
    v_mul_f32 v49, v49, v53
    v_mul_f32 v50, v50, v54
    s_add_u32 m0, s35, 24576
    s_add_u32 s46, s29, 106496
    buffer_load_dwordx4 v5, s[20:23], s46 offen sc1 lds
    v_mul_f32 v51, v51, v55
    v_mul_f32 v56, v11, v56
    v_mul_f32 v57, v11, v57
    v_mul_f32 v58, v11, v58
    v_mul_f32 v59, v11, v59
    v_exp_f32 v56, v56
    v_exp_f32 v57, v57
    v_exp_f32 v58, v58
    v_exp_f32 v59, v59
    v_fma_f32 v56, v56, v10, v10
    s_add_u32 m0, s35, 40960
    s_add_u32 s46, s29, 122880
    buffer_load_dwordx4 v5, s[20:23], s46 offen sc1 lds
    v_fma_f32 v57, v57, v10, v10
    v_fma_f32 v58, v58, v10, v10
    v_fma_f32 v59, v59, v10, v10
    v_rcp_f32 v56, v56
    v_rcp_f32 v57, v57
    s_cmp_eq_u32 s24, 0
    s_cselect_b32 s44, s43, 0x2000000
    v_mov_b32 v8, 0
    s_mov_b64 exec, 1
    buffer_atomic_add v8, v1, s[20:23], s44 offen sc0 sc1
    s_mov_b64 exec, -1
    v_rcp_f32 v58, v58
    v_rcp_f32 v59, v59
    v_mul_f32 v56, v56, v60
    v_mul_f32 v57, v57, v61
    v_mul_f32 v58, v58, v62
    buffer_load_dwordx4 v5, s[20:23], s46 offen offset:1024 sc1 lds
    v_mul_f32 v59, v59, v63
    v_cvt_pk_bf16_f32 v52, v48, v49
    v_cvt_pk_bf16_f32 v53, v50, v51
    v_cvt_pk_bf16_f32 v54, v56, v57
    v_cvt_pk_bf16_f32 v55, v58, v59
    buffer_store_dwordx4 v[52:55], v5, s[20:23], s58 offen offset:1024 sc1
    v_and_b32 v14, 15, v2
    v_lshlrev_b32 v14, 4, v14
    v_lshl_add_u32 v14, v6, 8, v14
    s_mul_i32 s38, s34, 2560
    v_add_u32 v14, s38, v14
    v_add_u32 v15, 2048, v14
    v_bfe_u32 v12, v2, 4, 1
    v_lshl_add_u32 v14, v12, 9, v14
    v_add_u32 v116, 0, v14
    v_add_u32 v117, 0, v15
    v_add_u32 v118, 61440, v14
    v_add_u32 v119, 61440, v15
    v_add_u32 v120, 122880, v14
    v_add_u32 v121, 122880, v15
    s_mov_b32 s12, s74
    s_mov_b32 s13, s75
    s_mov_b32 s14, 2621440
    s_mov_b32 s15, 0x00020000
    v_mul_u32_u24 v12, 1280, v7
    v_lshl_add_u32 v12, v6, 4, v12
    s_mul_i32 s28, s27, 98304
    s_lshl_b32 s38, s34, 10
    s_add_u32 s28, s28, s38
    s_add_u32 s28, s28, 13369344
    s_add_u32 s57, s56, 27320320
    s_add_u32 s40, s55, 27320320
    buffer_load_dwordx4 v5, s[20:23], s46 offen offset:2048 sc1 lds
    buffer_load_dwordx4 v5, s[20:23], s46 offen offset:3072 sc1 lds
    s_add_u32 m0, s35, 45056
    s_add_u32 s46, s29, 126976
    buffer_load_dwordx4 v5, s[20:23], s46 offen sc1 lds
    s_add_u32 m0, s35, 61440
    s_add_u32 s46, s29, 143360
    buffer_load_dwordx4 v5, s[20:23], s46 offen sc1 lds
    buffer_load_dwordx4 v5, s[20:23], s46 offen offset:1024 sc1 lds
    buffer_load_dwordx4 v5, s[20:23], s46 offen offset:2048 sc1 lds
    buffer_load_dwordx4 v5, s[20:23], s46 offen offset:3072 sc1 lds
    s_add_u32 m0, s35, 65536
    s_add_u32 s46, s29, 147456
    buffer_load_dwordx4 v5, s[20:23], s46 offen sc1 lds
    s_mul_i32 s38, s24, 6144
    s_add_u32 s38, s38, 0
    v_add_u32 v30, s38, v5
    s_xor_b32 s38, s24, 2
    s_mul_i32 s38, s38, 6144
    s_add_u32 s38, s38, 0
    v_add_u32 v31, s38, v5
    s_cmp_eq_u32 s34, 0
    s_cselect_b32 s44, 0xffff0000, 0
    s_cselect_b32 s45, 0, 0xffff0000
    v_lshlrev_b32 v9, 16, v16
    v_and_b32 v32, s44, v9
    v_and_b32 v33, s44, v16
    v_lshlrev_b32 v9, 16, v17
    v_and_b32 v34, s44, v9
    v_and_b32 v35, s44, v17
    v_lshlrev_b32 v9, 16, v18
    v_and_b32 v36, s44, v9
    v_and_b32 v37, s44, v18
    v_lshlrev_b32 v9, 16, v19
    v_and_b32 v38, s44, v9
    v_and_b32 v39, s44, v19
    v_lshlrev_b32 v9, 16, v20
    v_and_b32 v40, s44, v9
    v_and_b32 v41, s44, v20
    v_lshlrev_b32 v9, 16, v21
    v_and_b32 v42, s44, v9
    v_and_b32 v43, s44, v21
    v_lshlrev_b32 v9, 16, v22
    v_and_b32 v44, s44, v9
    v_and_b32 v45, s44, v22
    v_lshlrev_b32 v9, 16, v23
    v_and_b32 v46, s44, v9
    v_and_b32 v47, s44, v23
    v_lshlrev_b32 v9, 16, v24
    v_and_b32 v48, s44, v9
    v_and_b32 v49, s44, v24
    v_lshlrev_b32 v9, 16, v25
    v_and_b32 v50, s44, v9
    v_and_b32 v51, s44, v25
    v_lshlrev_b32 v9, 16, v26
    v_and_b32 v52, s44, v9
    v_and_b32 v53, s44, v26
    v_lshlrev_b32 v9, 16, v27
    v_and_b32 v54, s44, v9
    v_and_b32 v55, s44, v27
    v_lshlrev_b32 v9, 16, v16
    v_and_b32 v56, s45, v9
    v_and_b32 v57, s45, v16
    v_lshlrev_b32 v9, 16, v17
    v_and_b32 v58, s45, v9
    v_and_b32 v59, s45, v17
    v_lshlrev_b32 v9, 16, v18
    v_and_b32 v60, s45, v9
    v_and_b32 v61, s45, v18
    v_lshlrev_b32 v9, 16, v19
    v_and_b32 v62, s45, v9
    v_and_b32 v63, s45, v19
    v_lshlrev_b32 v9, 16, v20
    v_and_b32 v64, s45, v9
    v_and_b32 v65, s45, v20
    v_lshlrev_b32 v9, 16, v21
    v_and_b32 v66, s45, v9
    v_and_b32 v67, s45, v21
    v_lshlrev_b32 v9, 16, v22
    v_and_b32 v68, s45, v9
    v_and_b32 v69, s45, v22
    v_lshlrev_b32 v9, 16, v23
    v_and_b32 v70, s45, v9
    v_and_b32 v71, s45, v23
    v_mov_b32 v72, 0
    v_mov_b32 v73, 0
    v_mov_b32 v74, 0
    v_mov_b32 v75, 0
    v_mov_b32 v76, 0
    v_mov_b32 v77, 0
    v_mov_b32 v78, 0
    v_mov_b32 v79, 0
    s_waitcnt vmcnt(10)
    s_mov_b32 s58, s45
    s_cmp_lg_u32 s24, 0
    s_cbranch_scc1 L_pd7
    s_mov_b32 s44, 200000
    s_branch L_pc7
L_pl7:
    v_mov_b32 v8, 0
    s_mov_b64 exec, 1
    buffer_atomic_add v8, v1, s[20:23], s43 offen sc0 sc1
    s_mov_b64 exec, -1
    s_waitcnt vmcnt(0)
L_pc7:
    v_readfirstlane_b32 s45, v8
    s_nop 0
    s_cmp_ge_u32 s45, 16
    s_cbranch_scc1 L_pd7
    s_sub_u32 s44, s44, 1
    s_cmp_lg_u32 s44, 0
    s_cbranch_scc1 L_pl7
L_pd7:
    s_mov_b32 s45, s58
    s_barrier
    s_add_u32 s47, s28, 0
    buffer_load_dwordx4 a[0:3], v5, s[20:23], s47 offen offset:0 sc1
    buffer_load_dwordx4 a[4:7], v5, s[20:23], s47 offen offset:2048 sc1
    s_add_u32 s47, s28, 4096
    buffer_load_dwordx4 a[8:11], v5, s[20:23], s47 offen offset:0 sc1
    buffer_load_dwordx4 a[12:15], v5, s[20:23], s47 offen offset:2048 sc1
    s_add_u32 s47, s28, 8192
    buffer_load_dwordx4 a[16:19], v5, s[20:23], s47 offen offset:0 sc1
    buffer_load_dwordx4 a[20:23], v5, s[20:23], s47 offen offset:2048 sc1
    s_add_u32 s47, s28, 12288
    buffer_load_dwordx4 a[24:27], v5, s[20:23], s47 offen offset:0 sc1
    buffer_load_dwordx4 a[28:31], v5, s[20:23], s47 offen offset:2048 sc1
    s_add_u32 s47, s28, 16384
    buffer_load_dwordx4 a[32:35], v5, s[20:23], s47 offen offset:0 sc1
    buffer_load_dwordx4 a[36:39], v5, s[20:23], s47 offen offset:2048 sc1
    s_mov_b32 s84, 0xffff
    s_mov_b32 s85, 0xffff
    v_mov_b32 v88, 0
    v_mov_b32 v89, 0
    v_mov_b32 v90, 0
    v_mov_b32 v91, 0
    v_mov_b32 v100, 0
    v_mov_b32 v101, 0
    v_mov_b32 v102, 0
    v_mov_b32 v103, 0
    v_mov_b32 v112, 0
    v_mov_b32 v113, 0
    v_mov_b32 v114, 0
    v_mov_b32 v115, 0
    ds_read_b128 v[80:83], v118 offset:20480
    ds_read_b128 v[84:87], v118 offset:21504
    s_mov_b64 exec, s[84:85]
    ds_read_b128 v[88:91], v119 offset:20480
    s_mov_b64 exec, -1
    ds_read_b128 v[92:95], v118 offset:25600
    ds_read_b128 v[96:99], v118 offset:26624
    s_mov_b64 exec, s[84:85]
    ds_read_b128 v[100:103], v119 offset:25600
    s_mov_b64 exec, -1
    s_waitcnt vmcnt(9) lgkmcnt(3)
    v_mfma_f32_32x32x16_bf16 v[32:47], v[80:83], a[0:3], v[32:47]
    ds_read_b128 v[104:107], v118 offset:30720
    v_mfma_f32_32x32x16_bf16 v[48:63], v[84:87], a[0:3], v[48:63]
    ds_read_b128 v[108:111], v118 offset:31744
    s_add_u32 s47, s28, 20480
    buffer_load_dwordx4 a[40:43], v5, s[20:23], s47 offen offset:0 sc1
    v_mfma_f32_32x32x16_bf16 v[64:79], v[88:91], a[0:3], v[64:79]
    s_mov_b64 exec, s[84:85]
    ds_read_b128 v[112:115], v119 offset:30720
    s_mov_b64 exec, -1
    s_waitcnt vmcnt(9) lgkmcnt(3)
    v_mfma_f32_32x32x16_bf16 v[32:47], v[92:95], a[4:7], v[32:47]
    ds_read_b128 v[80:83], v118 offset:35840
    buffer_load_dwordx4 a[44:47], v5, s[20:23], s47 offen offset:2048 sc1
    v_mfma_f32_32x32x16_bf16 v[48:63], v[96:99], a[4:7], v[48:63]
    ds_read_b128 v[84:87], v118 offset:36864
    v_mfma_f32_32x32x16_bf16 v[64:79], v[100:103], a[4:7], v[64:79]
    s_mov_b64 exec, s[84:85]
    ds_read_b128 v[88:91], v119 offset:35840
    s_mov_b64 exec, -1
    s_add_u32 s47, s28, 24576
    buffer_load_dwordx4 a[48:51], v5, s[20:23], s47 offen offset:0 sc1
    s_barrier
    s_waitcnt vmcnt(10) lgkmcnt(3)
    v_mfma_f32_32x32x16_bf16 v[32:47], v[104:107], a[8:11], v[32:47]
    ds_read_b128 v[92:95], v118 offset:40960
    v_mfma_f32_32x32x16_bf16 v[48:63], v[108:111], a[8:11], v[48:63]
    ds_read_b128 v[96:99], v118 offset:41984
    buffer_load_dwordx4 a[52:55], v5, s[20:23], s47 offen offset:2048 sc1
    v_mfma_f32_32x32x16_bf16 v[64:79], v[112:115], a[8:11], v[64:79]
    s_mov_b64 exec, s[84:85]
    ds_read_b128 v[100:103], v119 offset:40960
    s_mov_b64 exec, -1
    s_waitcnt vmcnt(10) lgkmcnt(3)
    v_mfma_f32_32x32x16_bf16 v[32:47], v[80:83], a[12:15], v[32:47]
    ds_read_b128 v[104:107], v118 offset:46080
    s_add_u32 s47, s28, 28672
    buffer_load_dwordx4 a[56:59], v5, s[20:23], s47 offen offset:0 sc1
    v_mfma_f32_32x32x16_bf16 v[48:63], v[84:87], a[12:15], v[48:63]
    ds_read_b128 v[108:111], v118 offset:47104
    v_mfma_f32_32x32x16_bf16 v[64:79], v[88:91], a[12:15], v[64:79]
    s_mov_b64 exec, s[84:85]
    ds_read_b128 v[112:115], v119 offset:46080
    s_mov_b64 exec, -1
    buffer_load_dwordx4 a[60:63], v5, s[20:23], s47 offen offset:2048 sc1
    s_waitcnt vmcnt(11) lgkmcnt(3)
    v_mfma_f32_32x32x16_bf16 v[32:47], v[92:95], a[16:19], v[32:47]
    ds_read_b128 v[80:83], v118 offset:51200
    v_mfma_f32_32x32x16_bf16 v[48:63], v[96:99], a[16:19], v[48:63]
    ds_read_b128 v[84:87], v118 offset:52224
    s_add_u32 s47, s28, 32768
    buffer_load_dwordx4 a[64:67], v5, s[20:23], s47 offen offset:0 sc1
    v_mfma_f32_32x32x16_bf16 v[64:79], v[100:103], a[16:19], v[64:79]
    s_mov_b64 exec, s[84:85]
    ds_read_b128 v[88:91], v119 offset:51200
    s_mov_b64 exec, -1
    s_waitcnt vmcnt(11) lgkmcnt(3)
    v_mfma_f32_32x32x16_bf16 v[32:47], v[104:107], a[20:23], v[32:47]
    ds_read_b128 v[92:95], v118 offset:56320
    buffer_load_dwordx4 a[68:71], v5, s[20:23], s47 offen offset:2048 sc1
    v_mfma_f32_32x32x16_bf16 v[48:63], v[108:111], a[20:23], v[48:63]
    ds_read_b128 v[96:99], v118 offset:57344
    v_mfma_f32_32x32x16_bf16 v[64:79], v[112:115], a[20:23], v[64:79]
    s_mov_b64 exec, s[84:85]
    ds_read_b128 v[100:103], v119 offset:56320
    s_mov_b64 exec, -1
    s_add_u32 s47, s28, 36864
    buffer_load_dwordx4 a[72:75], v5, s[20:23], s47 offen offset:0 sc1
    s_barrier
    s_cmp_lg_u32 s24, 0
    s_cbranch_scc1 L_sg8
    v_mov_b32 v8, 1
    s_mov_b64 exec, 0xffff
    buffer_atomic_add v8, v3, s[20:23], s57 offen sc1
    s_mov_b64 exec, -1
L_sg8:
    s_waitcnt vmcnt(12) lgkmcnt(3)
    v_mfma_f32_32x32x16_bf16 v[32:47], v[80:83], a[24:27], v[32:47]
    ds_read_b128 v[104:107], v120 offset:0
    v_mfma_f32_32x32x16_bf16 v[48:63], v[84:87], a[24:27], v[48:63]
    ds_read_b128 v[108:111], v120 offset:1024
    s_add_u32 m0, s35, 81920
    s_add_u32 s46, s29, 163840
    buffer_load_dwordx4 v5, s[20:23], s46 offen sc1 lds
    v_mfma_f32_32x32x16_bf16 v[64:79], v[88:91], a[24:27], v[64:79]
    s_mov_b64 exec, s[84:85]
    ds_read_b128 v[112:115], v121 offset:0
    s_mov_b64 exec, -1
    s_waitcnt vmcnt(12) lgkmcnt(3)
    v_mfma_f32_32x32x16_bf16 v[32:47], v[92:95], a[28:31], v[32:47]
    ds_read_b128 v[80:83], v120 offset:5120
    buffer_load_dwordx4 v5, s[20:23], s46 offen offset:1024 sc1 lds
    v_mfma_f32_32x32x16_bf16 v[48:63], v[96:99], a[28:31], v[48:63]
    ds_read_b128 v[84:87], v120 offset:6144
    v_mfma_f32_32x32x16_bf16 v[64:79], v[100:103], a[28:31], v[64:79]
    s_mov_b64 exec, s[84:85]
    ds_read_b128 v[88:91], v121 offset:5120
    s_mov_b64 exec, -1
    buffer_load_dwordx4 v5, s[20:23], s46 offen offset:2048 sc1 lds
    s_waitcnt vmcnt(13) lgkmcnt(3)
    v_mfma_f32_32x32x16_bf16 v[32:47], v[104:107], a[32:35], v[32:47]
    ds_read_b128 v[92:95], v120 offset:10240
    v_mfma_f32_32x32x16_bf16 v[48:63], v[108:111], a[32:35], v[48:63]
    ds_read_b128 v[96:99], v120 offset:11264
    buffer_load_dwordx4 v5, s[20:23], s46 offen offset:3072 sc1 lds
    v_mfma_f32_32x32x16_bf16 v[64:79], v[112:115], a[32:35], v[64:79]
    s_mov_b64 exec, s[84:85]
    ds_read_b128 v[100:103], v121 offset:10240
    s_mov_b64 exec, -1
    s_waitcnt vmcnt(13) lgkmcnt(3)
    v_mfma_f32_32x32x16_bf16 v[32:47], v[80:83], a[36:39], v[32:47]
    ds_read_b128 v[104:107], v120 offset:15360
    buffer_load_dwordx4 a[76:79], v5, s[20:23], s47 offen offset:2048 sc1
    v_mfma_f32_32x32x16_bf16 v[48:63], v[84:87], a[36:39], v[48:63]
    ds_read_b128 v[108:111], v120 offset:16384
    v_mfma_f32_32x32x16_bf16 v[64:79], v[88:91], a[36:39], v[64:79]
    s_mov_b64 exec, s[84:85]
    ds_read_b128 v[112:115], v121 offset:15360
    s_mov_b64 exec, -1
    s_add_u32 m0, s35, 86016
    s_add_u32 s46, s29, 167936
    buffer_load_dwordx4 v5, s[20:23], s46 offen sc1 lds
    s_barrier
    s_waitcnt vmcnt(14) lgkmcnt(3)
    v_mfma_f32_32x32x16_bf16 v[32:47], v[92:95], a[40:43], v[32:47]
    ds_read_b128 v[80:83], v120 offset:20480
    v_mfma_f32_32x32x16_bf16 v[48:63], v[96:99], a[40:43], v[48:63]
    ds_read_b128 v[84:87], v120 offset:21504
    s_add_u32 s47, s28, 40960
    buffer_load_dwordx4 a[80:83], v5, s[20:23], s47 offen offset:0 sc1
    v_mfma_f32_32x32x16_bf16 v[64:79], v[100:103], a[40:43], v[64:79]
    s_mov_b64 exec, s[84:85]
    ds_read_b128 v[88:91], v121 offset:20480
    s_mov_b64 exec, -1
    s_waitcnt vmcnt(14) lgkmcnt(3)
    v_mfma_f32_32x32x16_bf16 v[32:47], v[104:107], a[44:47], v[32:47]
    ds_read_b128 v[92:95], v120 offset:25600
    buffer_load_dwordx4 a[84:87], v5, s[20:23], s47 offen offset:2048 sc1
    v_mfma_f32_32x32x16_bf16 v[48:63], v[108:111], a[44:47], v[48:63]
    ds_read_b128 v[96:99], v120 offset:26624
    v_mfma_f32_32x32x16_bf16 v[64:79], v[112:115], a[44:47], v[64:79]
    s_mov_b64 exec, s[84:85]
    ds_read_b128 v[100:103], v121 offset:25600
    s_mov_b64 exec, -1
    s_add_u32 m0, s35, 102400
    s_add_u32 s46, s29, 184320
    buffer_load_dwordx4 v5, s[20:23], s46 offen sc1 lds
    s_waitcnt vmcnt(15) lgkmcnt(3)
    v_mfma_f32_32x32x16_bf16 v[32:47], v[80:83], a[48:51], v[32:47]
    ds_read_b128 v[104:107], v120 offset:30720
    v_mfma_f32_32x32x16_bf16 v[48:63], v[84:87], a[48:51], v[48:63]
    ds_read_b128 v[108:111], v120 offset:31744
    s_add_u32 s47, s28, 45056
    buffer_load_dwordx4 a[88:91], v5, s[20:23], s47 offen offset:0 sc1
    v_mfma_f32_32x32x16_bf16 v[64:79], v[88:91], a[48:51], v[64:79]
    s_mov_b64 exec, s[84:85]
    ds_read_b128 v[112:115], v121 offset:30720
    s_mov_b64 exec, -1
    s_waitcnt vmcnt(15) lgkmcnt(3)
    v_mfma_f32_32x32x16_bf16 v[32:47], v[92:95], a[52:55], v[32:47]
    ds_read_b128 v[80:83], v120 offset:35840
    buffer_load_dwordx4 a[92:95], v5, s[20:23], s47 offen offset:2048 sc1
    v_mfma_f32_32x32x16_bf16 v[48:63], v[96:99], a[52:55], v[48:63]
    ds_read_b128 v[84:87], v120 offset:36864
    v_mfma_f32_32x32x16_bf16 v[64:79], v[100:103], a[52:55], v[64:79]
    s_mov_b64 exec, s[84:85]
    ds_read_b128 v[88:91], v121 offset:35840
    s_mov_b64 exec, -1
    buffer_load_dwordx4 v5, s[20:23], s46 offen offset:1024 sc1 lds
    s_barrier
    s_waitcnt vmcnt(16) lgkmcnt(3)
    v_mfma_f32_32x32x16_bf16 v[32:47], v[104:107], a[56:59], v[32:47]
    ds_read_b128 v[92:95], v116 offset:0
    v_mfma_f32_32x32x16_bf16 v[48:63], v[108:111], a[56:59], v[48:63]
    ds_read_b128 v[96:99], v116 offset:1024
    s_add_u32 s47, s28, 49152
    buffer_load_dwordx4 a[96:99], v5, s[20:23], s47 offen offset:0 sc1
    v_mfma_f32_32x32x16_bf16 v[64:79], v[112:115], a[56:59], v[64:79]
    s_mov_b64 exec, s[84:85]
    ds_read_b128 v[100:103], v117 offset:0
    s_mov_b64 exec, -1
    s_waitcnt vmcnt(16) lgkmcnt(3)
    v_mfma_f32_32x32x16_bf16 v[32:47], v[80:83], a[60:63], v[32:47]
    ds_read_b128 v[104:107], v116 offset:5120
    buffer_load_dwordx4 a[100:103], v5, s[20:23], s47 offen offset:2048 sc1
    v_mfma_f32_32x32x16_bf16 v[48:63], v[84:87], a[60:63], v[48:63]
    ds_read_b128 v[108:111], v116 offset:6144
    v_mfma_f32_32x32x16_bf16 v[64:79], v[88:91], a[60:63], v[64:79]
    s_mov_b64 exec, s[84:85]
    ds_read_b128 v[112:115], v117 offset:5120
    s_mov_b64 exec, -1
    buffer_load_dwordx4 v5, s[20:23], s46 offen offset:2048 sc1 lds
    s_cmp_eq_u32 s24, 0
    s_cselect_b32 s44, s40, 0x2000000
    v_mov_b32 v8, 0
    s_mov_b64 exec, 1
    buffer_atomic_add v8, v1, s[20:23], s44 offen sc0 sc1
    s_mov_b64 exec, -1
    s_waitcnt vmcnt(18) lgkmcnt(3)
    v_mfma_f32_32x32x16_bf16 v[32:47], v[92:95], a[64:67], v[32:47]
    ds_read_b128 v[80:83], v116 offset:10240
    v_mfma_f32_32x32x16_bf16 v[48:63], v[96:99], a[64:67], v[48:63]
    ds_read_b128 v[84:87], v116 offset:11264
    s_add_u32 s47, s28, 53248
    buffer_load_dwordx4 a[104:107], v5, s[20:23], s47 offen offset:0 sc1
    v_mfma_f32_32x32x16_bf16 v[64:79], v[100:103], a[64:67], v[64:79]
    s_mov_b64 exec, s[84:85]
    ds_read_b128 v[88:91], v117 offset:10240
    s_mov_b64 exec, -1
    s_waitcnt vmcnt(18) lgkmcnt(3)
    v_mfma_f32_32x32x16_bf16 v[32:47], v[104:107], a[68:71], v[32:47]
    ds_read_b128 v[92:95], v116 offset:15360
    buffer_load_dwordx4 a[108:111], v5, s[20:23], s47 offen offset:2048 sc1
    v_mfma_f32_32x32x16_bf16 v[48:63], v[108:111], a[68:71], v[48:63]
    ds_read_b128 v[96:99], v116 offset:16384
    v_mfma_f32_32x32x16_bf16 v[64:79], v[112:115], a[68:71], v[64:79]
    s_mov_b64 exec, s[84:85]
    ds_read_b128 v[100:103], v117 offset:15360
    s_mov_b64 exec, -1
    buffer_load_dwordx4 v5, s[20:23], s46 offen offset:3072 sc1 lds
    s_barrier
    s_waitcnt vmcnt(19) lgkmcnt(3)
    v_mfma_f32_32x32x16_bf16 v[32:47], v[80:83], a[72:75], v[32:47]
    ds_read_b128 v[104:107], v116 offset:20480
    v_mfma_f32_32x32x16_bf16 v[48:63], v[84:87], a[72:75], v[48:63]
    ds_read_b128 v[108:111], v116 offset:21504
    s_add_u32 s47, s28, 57344
    buffer_load_dwordx4 a[112:115], v5, s[20:23], s47 offen offset:0 sc1
    v_mfma_f32_32x32x16_bf16 v[64:79], v[88:91], a[72:75], v[64:79]
    s_mov_b64 exec, s[84:85]
    ds_read_b128 v[112:115], v117 offset:20480
    s_mov_b64 exec, -1
    s_waitcnt vmcnt(15) lgkmcnt(3)
    v_mfma_f32_32x32x16_bf16 v[32:47], v[92:95], a[76:79], v[32:47]
    ds_read_b128 v[80:83], v116 offset:25600
    buffer_load_dwordx4 a[116:119], v5, s[20:23], s47 offen offset:2048 sc1
    v_mfma_f32_32x32x16_bf16 v[48:63], v[96:99], a[76:79], v[48:63]
    ds_read_b128 v[84:87], v116 offset:26624
    v_mfma_f32_32x32x16_bf16 v[64:79], v[100:103], a[76:79], v[64:79]
    s_mov_b64 exec, s[84:85]
    ds_read_b128 v[88:91], v117 offset:25600
    s_mov_b64 exec, -1
    s_add_u32 m0, s35, 106496
    s_add_u32 s46, s29, 188416
    buffer_load_dwordx4 v5, s[20:23], s46 offen sc1 lds
    s_waitcnt vmcnt(15) lgkmcnt(3)
    v_mfma_f32_32x32x16_bf16 v[32:47], v[104:107], a[80:83], v[32:47]
    ds_read_b128 v[92:95], v116 offset:30720
    v_mfma_f32_32x32x16_bf16 v[48:63], v[108:111], a[80:83], v[48:63]
    ds_read_b128 v[96:99], v116 offset:31744
    s_add_u32 s47, s28, 61440
    buffer_load_dwordx4 a[120:123], v5, s[20:23], s47 offen offset:0 sc1
    v_mfma_f32_32x32x16_bf16 v[64:79], v[112:115], a[80:83], v[64:79]
    s_mov_b64 exec, s[84:85]
    ds_read_b128 v[100:103], v117 offset:30720
    s_mov_b64 exec, -1
    s_waitcnt vmcnt(15) lgkmcnt(3)
    v_mfma_f32_32x32x16_bf16 v[32:47], v[80:83], a[84:87], v[32:47]
    ds_read_b128 v[104:107], v116 offset:35840
    buffer_load_dwordx4 a[124:127], v5, s[20:23], s47 offen offset:2048 sc1
    v_mfma_f32_32x32x16_bf16 v[48:63], v[84:87], a[84:87], v[48:63]
    ds_read_b128 v[108:111], v116 offset:36864
    v_mfma_f32_32x32x16_bf16 v[64:79], v[88:91], a[84:87], v[64:79]
    s_mov_b64 exec, s[84:85]
    ds_read_b128 v[112:115], v117 offset:35840
    s_mov_b64 exec, -1
    s_add_u32 m0, s35, 122880
    s_add_u32 s46, s29, 204800
    buffer_load_dwordx4 v5, s[20:23], s46 offen sc1 lds
    s_waitcnt vmcnt(9)
    s_mov_b32 s43, s45
    s_cmp_lg_u32 s24, 0
    s_cbranch_scc1 L_pd9
    s_mov_b32 s44, 200000
    s_branch L_pc9
L_pl9:
    v_mov_b32 v8, 0
    s_mov_b64 exec, 1
    buffer_atomic_add v8, v1, s[20:23], s40 offen sc0 sc1
    s_mov_b64 exec, -1
    s_waitcnt vmcnt(0)
L_pc9:
    v_readfirstlane_b32 s45, v8
    s_nop 0
    s_cmp_ge_u32 s45, 16
    s_cbranch_scc1 L_pd9
    s_sub_u32 s44, s44, 1
    s_cmp_lg_u32 s44, 0
    s_cbranch_scc1 L_pl9
L_pd9:
    s_mov_b32 s45, s43
    s_barrier
    s_waitcnt lgkmcnt(3)
    v_mfma_f32_32x32x16_bf16 v[32:47], v[92:95], a[88:91], v[32:47]
    ds_read_b128 v[80:83], v116 offset:40960
    v_mfma_f32_32x32x16_bf16 v[48:63], v[96:99], a[88:91], v[48:63]
    ds_read_b128 v[84:87], v116 offset:41984
    s_add_u32 s47, s28, 65536
    buffer_load_dwordx4 a[128:131], v5, s[20:23], s47 offen offset:0 sc1
    v_mfma_f32_32x32x16_bf16 v[64:79], v[100:103], a[88:91], v[64:79]
    s_mov_b64 exec, s[84:85]
    ds_read_b128 v[88:91], v117 offset:40960
    s_mov_b64 exec, -1
    s_waitcnt lgkmcnt(3)
    v_mfma_f32_32x32x16_bf16 v[32:47], v[104:107], a[92:95], v[32:47]
    ds_read_b128 v[92:95], v116 offset:46080
    buffer_load_dwordx4 a[132:135], v5, s[20:23], s47 offen offset:2048 sc1
    v_mfma_f32_32x32x16_bf16 v[48:63], v[108:111], a[92:95], v[48:63]
    ds_read_b128 v[96:99], v116 offset:47104
    v_mfma_f32_32x32x16_bf16 v[64:79], v[112:115], a[92:95], v[64:79]
    s_mov_b64 exec, s[84:85]
    ds_read_b128 v[100:103], v117 offset:46080
    s_mov_b64 exec, -1
    buffer_load_dwordx4 v5, s[20:23], s46 offen offset:1024 sc1 lds
    s_waitcnt lgkmcnt(3)
    v_mfma_f32_32x32x16_bf16 v[32:47], v[80:83], a[96:99], v[32:47]
    ds_read_b128 v[104:107], v116 offset:51200
    v_mfma_f32_32x32x16_bf16 v[48:63], v[84:87], a[96:99], v[48:63]
    ds_read_b128 v[108:111], v116 offset:52224
    s_add_u32 s47, s28, 69632
    buffer_load_dwordx4 a[136:139], v5, s[20:23], s47 offen offset:0 sc1
    v_mfma_f32_32x32x16_bf16 v[64:79], v[88:91], a[96:99], v[64:79]
    s_mov_b64 exec, s[84:85]
    ds_read_b128 v[112:115], v117 offset:51200
    s_mov_b64 exec, -1
    s_waitcnt lgkmcnt(3)
    v_mfma_f32_32x32x16_bf16 v[32:47], v[92:95], a[100:103], v[32:47]
    ds_read_b128 v[80:83], v116 offset:56320
    buffer_load_dwordx4 a[140:143], v5, s[20:23], s47 offen offset:2048 sc1
    v_mfma_f32_32x32x16_bf16 v[48:63], v[96:99], a[100:103], v[48:63]
    ds_read_b128 v[84:87], v116 offset:57344
    v_mfma_f32_32x32x16_bf16 v[64:79], v[100:103], a[100:103], v[64:79]
    s_mov_b64 exec, s[84:85]
    ds_read_b128 v[88:91], v117 offset:56320
    s_mov_b64 exec, -1
    buffer_load_dwordx4 v5, s[20:23], s46 offen offset:2048 sc1 lds
    s_barrier
    s_waitcnt vmcnt(14) lgkmcnt(3)
    v_mfma_f32_32x32x16_bf16 v[32:47], v[104:107], a[104:107], v[32:47]
    ds_read_b128 v[92:95], v118 offset:0
    v_mfma_f32_32x32x16_bf16 v[48:63], v[108:111], a[104:107], v[48:63]
    ds_read_b128 v[96:99], v118 offset:1024
    buffer_load_dwordx4 v5, s[20:23], s46 offen offset:3072 sc1 lds
    v_mfma_f32_32x32x16_bf16 v[64:79], v[112:115], a[104:107], v[64:79]
    s_mov_b64 exec, s[84:85]
    ds_read_b128 v[100:103], v119 offset:0
    s_mov_b64 exec, -1
    s_waitcnt vmcnt(14) lgkmcnt(3)
    v_mfma_f32_32x32x16_bf16 v[32:47], v[80:83], a[108:111], v[32:47]
    ds_read_b128 v[104:107], v118 offset:5120
    s_add_u32 m0, s35, 126976
    s_add_u32 s46, s29, 208896
    buffer_load_dwordx4 v5, s[20:23], s46 offen sc1 lds
    v_mfma_f32_32x32x16_bf16 v[48:63], v[84:87], a[108:111], v[48:63]
    ds_read_b128 v[108:111], v118 offset:6144
    v_mfma_f32_32x32x16_bf16 v[64:79], v[88:91], a[108:111], v[64:79]
    s_mov_b64 exec, s[84:85]
    ds_read_b128 v[112:115], v119 offset:5120
    s_mov_b64 exec, -1
    s_add_u32 s47, s28, 73728
    buffer_load_dwordx4 a[144:147], v5, s[20:23], s47 offen offset:0 sc1
    s_waitcnt vmcnt(14) lgkmcnt(3)
    v_mfma_f32_32x32x16_bf16 v[32:47], v[92:95], a[112:115], v[32:47]
    ds_read_b128 v[80:83], v118 offset:10240
    v_mfma_f32_32x32x16_bf16 v[48:63], v[96:99], a[112:115], v[48:63]
    ds_read_b128 v[84:87], v118 offset:11264
    buffer_load_dwordx4 a[148:151], v5, s[20:23], s47 offen offset:2048 sc1
    v_mfma_f32_32x32x16_bf16 v[64:79], v[100:103], a[112:115], v[64:79]
    s_mov_b64 exec, s[84:85]
    ds_read_b128 v[88:91], v119 offset:10240
    s_mov_b64 exec, -1
    s_waitcnt vmcnt(14) lgkmcnt(3)
    v_mfma_f32_32x32x16_bf16 v[32:47], v[104:107], a[116:119], v[32:47]
    ds_read_b128 v[92:95], v118 offset:15360
    s_add_u32 s47, s28, 77824
    buffer_load_dwordx4 a[152:155], v5, s[20:23], s47 offen offset:0 sc1
    v_mfma_f32_32x32x16_bf16 v[48:63], v[108:111], a[116:119], v[48:63]
    ds_read_b128 v[96:99], v118 offset:16384
    v_mfma_f32_32x32x16_bf16 v[64:79], v[112:115], a[116:119], v[64:79]
    s_mov_b64 exec, s[84:85]
    ds_read_b128 v[100:103], v119 offset:15360
    s_mov_b64 exec, -1
    buffer_load_dwordx4 a[156:159], v5, s[20:23], s47 offen offset:2048 sc1
    s_barrier
    s_waitcnt vmcnt(14) lgkmcnt(3)
    v_mfma_f32_32x32x16_bf16 v[32:47], v[80:83], a[120:123], v[32:47]
    ds_read_b128 v[104:107], v118 offset:20480
    v_mfma_f32_32x32x16_bf16 v[48:63], v[84:87], a[120:123], v[48:63]
    ds_read_b128 v[108:111], v118 offset:21504
    s_add_u32 m0, s35, 143360
    s_add_u32 s46, s29, 225280
    buffer_load_dwordx4 v5, s[20:23], s46 offen sc1 lds
    v_mfma_f32_32x32x16_bf16 v[64:79], v[88:91], a[120:123], v[64:79]
    s_mov_b64 exec, s[84:85]
    ds_read_b128 v[112:115], v119 offset:20480
    s_mov_b64 exec, -1
    s_waitcnt vmcnt(14) lgkmcnt(3)
    v_mfma_f32_32x32x16_bf16 v[32:47], v[92:95], a[124:127], v[32:47]
    ds_read_b128 v[80:83], v118 offset:25600
    buffer_load_dwordx4 v5, s[20:23], s46 offen offset:1024 sc1 lds
    v_mfma_f32_32x32x16_bf16 v[48:63], v[96:99], a[124:127], v[48:63]
    ds_read_b128 v[84:87], v118 offset:26624
    v_mfma_f32_32x32x16_bf16 v[64:79], v[100:103], a[124:127], v[64:79]
    s_mov_b64 exec, s[84:85]
    ds_read_b128 v[88:91], v119 offset:25600
    s_mov_b64 exec, -1
    buffer_load_dwordx4 v5, s[20:23], s46 offen offset:2048 sc1 lds
    s_waitcnt vmcnt(14) lgkmcnt(3)
    v_mfma_f32_32x32x16_bf16 v[32:47], v[104:107], a[128:131], v[32:47]
    ds_read_b128 v[92:95], v118 offset:30720
    v_mfma_f32_32x32x16_bf16 v[48:63], v[108:111], a[128:131], v[48:63]
    ds_read_b128 v[96:99], v118 offset:31744
    buffer_load_dwordx4 v5, s[20:23], s46 offen offset:3072 sc1 lds
    v_mfma_f32_32x32x16_bf16 v[64:79], v[112:115], a[128:131], v[64:79]
    s_mov_b64 exec, s[84:85]
    ds_read_b128 v[100:103], v119 offset:30720
    s_mov_b64 exec, -1
    s_waitcnt vmcnt(14) lgkmcnt(3)
    v_mfma_f32_32x32x16_bf16 v[32:47], v[80:83], a[132:135], v[32:47]
    ds_read_b128 v[104:107], v118 offset:35840
    s_add_u32 m0, s35, 147456
    s_add_u32 s46, s29, 229376
    buffer_load_dwordx4 v5, s[20:23], s46 offen sc1 lds
    v_mfma_f32_32x32x16_bf16 v[48:63], v[84:87], a[132:135], v[48:63]
    ds_read_b128 v[108:111], v118 offset:36864
    v_mfma_f32_32x32x16_bf16 v[64:79], v[88:91], a[132:135], v[64:79]
    s_mov_b64 exec, s[84:85]
    ds_read_b128 v[112:115], v119 offset:35840
    s_mov_b64 exec, -1
    s_add_u32 s47, s28, 81920
    buffer_load_dwordx4 a[160:163], v5, s[20:23], s47 offen offset:0 sc1
    s_barrier
    s_waitcnt vmcnt(14) lgkmcnt(3)
    v_mfma_f32_32x32x16_bf16 v[32:47], v[92:95], a[136:139], v[32:47]
    ds_read_b128 v[80:83], v118 offset:40960
    v_mfma_f32_32x32x16_bf16 v[48:63], v[96:99], a[136:139], v[48:63]
    ds_read_b128 v[84:87], v118 offset:41984
    buffer_load_dwordx4 a[164:167], v5, s[20:23], s47 offen offset:2048 sc1
    v_mfma_f32_32x32x16_bf16 v[64:79], v[100:103], a[136:139], v[64:79]
    s_mov_b64 exec, s[84:85]
    ds_read_b128 v[88:91], v119 offset:40960
    s_mov_b64 exec, -1
    s_waitcnt vmcnt(14) lgkmcnt(3)
    v_mfma_f32_32x32x16_bf16 v[32:47], v[104:107], a[140:143], v[32:47]
    ds_read_b128 v[92:95], v118 offset:46080
    s_add_u32 s47, s28, 86016
    buffer_load_dwordx4 a[168:171], v5, s[20:23], s47 offen offset:0 sc1
    v_mfma_f32_32x32x16_bf16 v[48:63], v[108:111], a[140:143], v[48:63]
    ds_read_b128 v[96:99], v118 offset:47104
    v_mfma_f32_32x32x16_bf16 v[64:79], v[112:115], a[140:143], v[64:79]
    s_mov_b64 exec, s[84:85]
    ds_read_b128 v[100:103], v119 offset:46080
    s_mov_b64 exec, -1
    buffer_load_dwordx4 a[172:175], v5, s[20:23], s47 offen offset:2048 sc1
    s_waitcnt vmcnt(12) lgkmcnt(3)
    v_mfma_f32_32x32x16_bf16 v[32:47], v[80:83], a[144:147], v[32:47]
    ds_read_b128 v[104:107], v118 offset:51200
    v_mfma_f32_32x32x16_bf16 v[48:63], v[84:87], a[144:147], v[48:63]
    ds_read_b128 v[108:111], v118 offset:52224
    s_add_u32 s47, s28, 90112
    buffer_load_dwordx4 a[176:179], v5, s[20:23], s47 offen offset:0 sc1
    v_mfma_f32_32x32x16_bf16 v[64:79], v[88:91], a[144:147], v[64:79]
    s_mov_b64 exec, s[84:85]
    ds_read_b128 v[112:115], v119 offset:51200
    s_mov_b64 exec, -1
    s_waitcnt vmcnt(12) lgkmcnt(3)
    v_mfma_f32_32x32x16_bf16 v[32:47], v[92:95], a[148:151], v[32:47]
    ds_read_b128 v[80:83], v118 offset:56320
    buffer_load_dwordx4 a[180:183], v5, s[20:23], s47 offen offset:2048 sc1
    v_mfma_f32_32x32x16_bf16 v[48:63], v[96:99], a[148:151], v[48:63]
    ds_read_b128 v[84:87], v118 offset:57344
    v_mfma_f32_32x32x16_bf16 v[64:79], v[100:103], a[148:151], v[64:79]
    s_mov_b64 exec, s[84:85]
    ds_read_b128 v[88:91], v119 offset:56320
    s_mov_b64 exec, -1
    s_add_u32 s47, s28, 94208
    buffer_load_dwordx4 a[184:187], v5, s[20:23], s47 offen offset:0 sc1
    s_barrier
    s_waitcnt vmcnt(13) lgkmcnt(3)
    v_mfma_f32_32x32x16_bf16 v[32:47], v[104:107], a[152:155], v[32:47]
    ds_read_b128 v[92:95], v120 offset:0
    v_mfma_f32_32x32x16_bf16 v[48:63], v[108:111], a[152:155], v[48:63]
    ds_read_b128 v[96:99], v120 offset:1024
    buffer_load_dwordx4 a[188:191], v5, s[20:23], s47 offen offset:2048 sc1
    v_mfma_f32_32x32x16_bf16 v[64:79], v[112:115], a[152:155], v[64:79]
    s_mov_b64 exec, s[84:85]
    ds_read_b128 v[100:103], v121 offset:0
    s_mov_b64 exec, -1
    s_waitcnt vmcnt(13) lgkmcnt(3)
    v_mfma_f32_32x32x16_bf16 v[32:47], v[80:83], a[156:159], v[32:47]
    ds_read_b128 v[104:107], v120 offset:5120
    v_mfma_f32_32x32x16_bf16 v[48:63], v[84:87], a[156:159], v[48:63]
    ds_read_b128 v[108:111], v120 offset:6144
    v_mfma_f32_32x32x16_bf16 v[64:79], v[88:91], a[156:159], v[64:79]
    s_mov_b64 exec, s[84:85]
    ds_read_b128 v[112:115], v121 offset:5120
    s_mov_b64 exec, -1
    s_waitcnt vmcnt(7) lgkmcnt(3)
    v_mfma_f32_32x32x16_bf16 v[32:47], v[92:95], a[160:163], v[32:47]
    ds_read_b128 v[80:83], v120 offset:10240
    v_mfma_f32_32x32x16_bf16 v[48:63], v[96:99], a[160:163], v[48:63]
    ds_read_b128 v[84:87], v120 offset:11264
    v_mfma_f32_32x32x16_bf16 v[64:79], v[100:103], a[160:163], v[64:79]
    s_mov_b64 exec, s[84:85]
    ds_read_b128 v[88:91], v121 offset:10240
    s_mov_b64 exec, -1
    s_waitcnt vmcnt(6) lgkmcnt(3)
    v_mfma_f32_32x32x16_bf16 v[32:47], v[104:107], a[164:167], v[32:47]
    ds_read_b128 v[92:95], v120 offset:15360
    v_mfma_f32_32x32x16_bf16 v[48:63], v[108:111], a[164:167], v[48:63]
    ds_read_b128 v[96:99], v120 offset:16384
    v_mfma_f32_32x32x16_bf16 v[64:79], v[112:115], a[164:167], v[64:79]
    s_mov_b64 exec, s[84:85]
    ds_read_b128 v[100:103], v121 offset:15360
    s_mov_b64 exec, -1
    s_barrier
    s_waitcnt vmcnt(5) lgkmcnt(3)
    v_mfma_f32_32x32x16_bf16 v[32:47], v[80:83], a[168:171], v[32:47]
    ds_read_b128 v[104:107], v120 offset:20480
    v_mfma_f32_32x32x16_bf16 v[48:63], v[84:87], a[168:171], v[48:63]
    ds_read_b128 v[108:111], v120 offset:21504
    v_mfma_f32_32x32x16_bf16 v[64:79], v[88:91], a[168:171], v[64:79]
    s_mov_b64 exec, s[84:85]
    ds_read_b128 v[112:115], v121 offset:20480
    s_mov_b64 exec, -1
    s_waitcnt vmcnt(4) lgkmcnt(3)
    v_mfma_f32_32x32x16_bf16 v[32:47], v[92:95], a[172:175], v[32:47]
    ds_read_b128 v[80:83], v120 offset:25600
    v_mfma_f32_32x32x16_bf16 v[48:63], v[96:99], a[172:175], v[48:63]
    ds_read_b128 v[84:87], v120 offset:26624
    v_mfma_f32_32x32x16_bf16 v[64:79], v[100:103], a[172:175], v[64:79]
    s_mov_b64 exec, s[84:85]
    ds_read_b128 v[88:91], v121 offset:25600
    s_mov_b64 exec, -1
    s_waitcnt vmcnt(3) lgkmcnt(3)
    v_mfma_f32_32x32x16_bf16 v[32:47], v[104:107], a[176:179], v[32:47]
    ds_read_b128 v[92:95], v120 offset:30720
    v_mfma_f32_32x32x16_bf16 v[48:63], v[108:111], a[176:179], v[48:63]
    ds_read_b128 v[96:99], v120 offset:31744
    v_mfma_f32_32x32x16_bf16 v[64:79], v[112:115], a[176:179], v[64:79]
    s_mov_b64 exec, s[84:85]
    ds_read_b128 v[100:103], v121 offset:30720
    s_mov_b64 exec, -1
    s_waitcnt vmcnt(2) lgkmcnt(3)
    v_mfma_f32_32x32x16_bf16 v[32:47], v[80:83], a[180:183], v[32:47]
    ds_read_b128 v[104:107], v120 offset:35840
    v_mfma_f32_32x32x16_bf16 v[48:63], v[84:87], a[180:183], v[48:63]
    ds_read_b128 v[108:111], v120 offset:36864
    v_mfma_f32_32x32x16_bf16 v[64:79], v[88:91], a[180:183], v[64:79]
    s_mov_b64 exec, s[84:85]
    ds_read_b128 v[112:115], v121 offset:35840
    s_mov_b64 exec, -1
    s_waitcnt vmcnt(1) lgkmcnt(3)
    v_mfma_f32_32x32x16_bf16 v[32:47], v[92:95], a[184:187], v[32:47]
    v_mfma_f32_32x32x16_bf16 v[48:63], v[96:99], a[184:187], v[48:63]
    v_mfma_f32_32x32x16_bf16 v[64:79], v[100:103], a[184:187], v[64:79]
    s_waitcnt vmcnt(0) lgkmcnt(0)
    v_mfma_f32_32x32x16_bf16 v[32:47], v[104:107], a[188:191], v[32:47]
    v_mfma_f32_32x32x16_bf16 v[48:63], v[108:111], a[188:191], v[48:63]
    v_mfma_f32_32x32x16_bf16 v[64:79], v[112:115], a[188:191], v[64:79]
    s_cmp_eq_u32 s34, 0
    s_cbranch_scc1 L_x50
    s_nop 7
    ds_write_b128 v30, v[32:35] offset:0
    ds_write_b128 v30, v[36:39] offset:1024
    ds_write_b128 v30, v[40:43] offset:2048
    ds_write_b128 v30, v[44:47] offset:3072
    ds_write_b128 v30, v[48:51] offset:4096
    ds_write_b128 v30, v[52:55] offset:5120
    s_waitcnt lgkmcnt(0)
    s_barrier
    ds_read_b128 v[80:83], v31 offset:0
    ds_read_b128 v[84:87], v31 offset:1024
    ds_read_b128 v[88:91], v31 offset:2048
    ds_read_b128 v[92:95], v31 offset:3072
    s_waitcnt lgkmcnt(3)
    v_pk_add_f32 v[56:57], v[56:57], v[80:81]
    v_pk_add_f32 v[58:59], v[58:59], v[82:83]
    s_waitcnt lgkmcnt(2)
    v_pk_add_f32 v[60:61], v[60:61], v[84:85]
    v_pk_add_f32 v[62:63], v[62:63], v[86:87]
    v_cvt_pk_bf16_f32 v216, v56, v57
    v_cvt_pk_bf16_f32 v217, v58, v59
    v_cvt_pk_bf16_f32 v218, v60, v61
    v_cvt_pk_bf16_f32 v219, v62, v63
    buffer_store_dwordx4 v[216:219], v12, s[12:15], s39 offen offset:96
    s_waitcnt lgkmcnt(1)
    v_pk_add_f32 v[64:65], v[64:65], v[88:89]
    v_pk_add_f32 v[66:67], v[66:67], v[90:91]
    s_waitcnt lgkmcnt(0)
    v_pk_add_f32 v[68:69], v[68:69], v[92:93]
    v_pk_add_f32 v[70:71], v[70:71], v[94:95]
    v_cvt_pk_bf16_f32 v220, v64, v65
    v_cvt_pk_bf16_f32 v221, v66, v67
    v_cvt_pk_bf16_f32 v222, v68, v69
    v_cvt_pk_bf16_f32 v223, v70, v71
    buffer_store_dwordx4 v[220:223], v12, s[12:15], s39 offen offset:128
    s_branch L_x5j
L_x50:
    s_nop 8
    ds_write_b128 v30, v[56:59] offset:0
    ds_write_b128 v30, v[60:63] offset:1024
    ds_write_b128 v30, v[64:67] offset:2048
    ds_write_b128 v30, v[68:71] offset:3072
    s_waitcnt lgkmcnt(0)
    s_barrier
    ds_read_b128 v[80:83], v31 offset:0
    ds_read_b128 v[84:87], v31 offset:1024
    ds_read_b128 v[88:91], v31 offset:2048
    ds_read_b128 v[92:95], v31 offset:3072
    ds_read_b128 v[96:99], v31 offset:4096
    ds_read_b128 v[100:103], v31 offset:5120
    s_waitcnt lgkmcnt(5)
    v_pk_add_f32 v[32:33], v[32:33], v[80:81]
    v_pk_add_f32 v[34:35], v[34:35], v[82:83]
    s_waitcnt lgkmcnt(4)
    v_pk_add_f32 v[36:37], v[36:37], v[84:85]
    v_pk_add_f32 v[38:39], v[38:39], v[86:87]
    v_cvt_pk_bf16_f32 v216, v32, v33
    v_cvt_pk_bf16_f32 v217, v34, v35
    v_cvt_pk_bf16_f32 v218, v36, v37
    v_cvt_pk_bf16_f32 v219, v38, v39
    buffer_store_dwordx4 v[216:219], v12, s[12:15], s39 offen offset:0
    s_waitcnt lgkmcnt(3)
    v_pk_add_f32 v[40:41], v[40:41], v[88:89]
    v_pk_add_f32 v[42:43], v[42:43], v[90:91]
    s_waitcnt lgkmcnt(2)
    v_pk_add_f32 v[44:45], v[44:45], v[92:93]
    v_pk_add_f32 v[46:47], v[46:47], v[94:95]
    v_cvt_pk_bf16_f32 v220, v40, v41
    v_cvt_pk_bf16_f32 v221, v42, v43
    v_cvt_pk_bf16_f32 v222, v44, v45
    v_cvt_pk_bf16_f32 v223, v46, v47
    buffer_store_dwordx4 v[220:223], v12, s[12:15], s39 offen offset:32
    s_waitcnt lgkmcnt(1)
    v_pk_add_f32 v[48:49], v[48:49], v[96:97]
    v_pk_add_f32 v[50:51], v[50:51], v[98:99]
    s_waitcnt lgkmcnt(0)
    v_pk_add_f32 v[52:53], v[52:53], v[100:101]
    v_pk_add_f32 v[54:55], v[54:55], v[102:103]
    v_cvt_pk_bf16_f32 v224, v48, v49
    v_cvt_pk_bf16_f32 v225, v50, v51
    v_cvt_pk_bf16_f32 v226, v52, v53
    v_cvt_pk_bf16_f32 v227, v54, v55
    buffer_store_dwordx4 v[224:227], v12, s[12:15], s39 offen offset:64
L_x5j:
L_end:
    s_endpgm
L_wslow:
    s_mov_b32 s44, 200000
L_wchk:
    buffer_load_dword v20, v21, s[20:23], s47 offen sc0 sc1
    s_waitcnt vmcnt(0)
    v_cmp_le_u32 vcc, 32, v20
    s_nop 0
    s_cmp_eq_u64 vcc, -1
    s_cbranch_scc1 L_wok
    s_sub_u32 s44, s44, 1
    s_cmp_lg_u32 s44, 0
    s_cbranch_scc1 L_wchk
    s_branch L_wok
L_fb:
    s_waitcnt vmcnt(0)
    s_barrier
    s_mov_b32 s71, 1
    v_add_u32 v4, 151552, v5
    s_lshl_b32 s40, s24, 8
    v_lshlrev_b32 v12, 2, v2
    v_add_u32 v12, s40, v12
    s_mov_b32 s42, 4
    v_cmp_eq_u32 vcc, 0, v6
L_fbl:
    ds_read_b128 v[104:107], v4 offset:0
    ds_read_b64 v[112:113], v4 offset:2048
    ds_read_b128 v[108:111], v4 offset:1024
    ds_read_b64 v[114:115], v4 offset:2056
    s_waitcnt lgkmcnt(2)
    v_cndmask_b32 v112, 0, v112, vcc
    v_cndmask_b32 v113, 0, v113, vcc
    s_waitcnt lgkmcnt(0)
    v_cndmask_b32 v114, 0, v114, vcc
    v_cndmask_b32 v115, 0, v115, vcc
    v_mov_b32 v14, 0xff800000
    v_mov_b32 v15, 0xff800000
    v_mfma_f32_32x32x16_bf16 v[32:47], a[0:3], v[104:107], 0
    v_mfma_f32_32x32x8_bf16 v[32:47], a[64:65], v[112:113], v[32:47]
    v_mfma_f32_32x32x16_bf16 v[48:63], a[0:3], v[108:111], 0
    v_mfma_f32_32x32x8_bf16 v[48:63], a[64:65], v[114:115], v[48:63]
    s_nop 9
    v_max3_f32 v14, v14, v32, v33
    v_max3_f32 v14, v14, v34, v35
    v_max3_f32 v14, v14, v36, v37
    v_max3_f32 v14, v14, v38, v39
    v_max3_f32 v14, v14, v40, v41
    v_max3_f32 v14, v14, v42, v43
    v_max3_f32 v14, v14, v44, v45
    v_max3_f32 v14, v14, v46, v47
    v_max3_f32 v15, v15, v48, v49
    v_max3_f32 v15, v15, v50, v51
    v_max3_f32 v15, v15, v52, v53
    v_max3_f32 v15, v15, v54, v55
    v_max3_f32 v15, v15, v56, v57
    v_max3_f32 v15, v15, v58, v59
    v_max3_f32 v15, v15, v60, v61
    v_max3_f32 v15, v15, v62, v63
    v_mfma_f32_32x32x16_bf16 v[32:47], a[4:7], v[104:107], 0
    v_mfma_f32_32x32x8_bf16 v[32:47], a[66:67], v[112:113], v[32:47]
    v_mfma_f32_32x32x16_bf16 v[48:63], a[4:7], v[108:111], 0
    v_mfma_f32_32x32x8_bf16 v[48:63], a[66:67], v[114:115], v[48:63]
    s_nop 9
    v_max3_f32 v14, v14, v32, v33
    v_max3_f32 v14, v14, v34, v35
    v_max3_f32 v14, v14, v36, v37
    v_max3_f32 v14, v14, v38, v39
    v_max3_f32 v14, v14, v40, v41
    v_max3_f32 v14, v14, v42, v43
    v_max3_f32 v14, v14, v44, v45
    v_max3_f32 v14, v14, v46, v47
    v_max3_f32 v15, v15, v48, v49
    v_max3_f32 v15, v15, v50, v51
    v_max3_f32 v15, v15, v52, v53
    v_max3_f32 v15, v15, v54, v55
    v_max3_f32 v15, v15, v56, v57
    v_max3_f32 v15, v15, v58, v59
    v_max3_f32 v15, v15, v60, v61
    v_max3_f32 v15, v15, v62, v63
    v_mfma_f32_32x32x16_bf16 v[32:47], a[8:11], v[104:107], 0
    v_mfma_f32_32x32x8_bf16 v[32:47], a[68:69], v[112:113], v[32:47]
    v_mfma_f32_32x32x16_bf16 v[48:63], a[8:11], v[108:111], 0
    v_mfma_f32_32x32x8_bf16 v[48:63], a[68:69], v[114:115], v[48:63]
    s_nop 9
    v_max3_f32 v14, v14, v32, v33
    v_max3_f32 v14, v14, v34, v35
    v_max3_f32 v14, v14, v36, v37
    v_max3_f32 v14, v14, v38, v39
    v_max3_f32 v14, v14, v40, v41
    v_max3_f32 v14, v14, v42, v43
    v_max3_f32 v14, v14, v44, v45
    v_max3_f32 v14, v14, v46, v47
    v_max3_f32 v15, v15, v48, v49
    v_max3_f32 v15, v15, v50, v51
    v_max3_f32 v15, v15, v52, v53
    v_max3_f32 v15, v15, v54, v55
    v_max3_f32 v15, v15, v56, v57
    v_max3_f32 v15, v15, v58, v59
    v_max3_f32 v15, v15, v60, v61
    v_max3_f32 v15, v15, v62, v63
    v_mfma_f32_32x32x16_bf16 v[32:47], a[12:15], v[104:107], 0
    v_mfma_f32_32x32x8_bf16 v[32:47], a[70:71], v[112:113], v[32:47]
    v_mfma_f32_32x32x16_bf16 v[48:63], a[12:15], v[108:111], 0
    v_mfma_f32_32x32x8_bf16 v[48:63], a[70:71], v[114:115], v[48:63]
    s_nop 9
    v_max3_f32 v14, v14, v32, v33
    v_max3_f32 v14, v14, v34, v35
    v_max3_f32 v14, v14, v36, v37
    v_max3_f32 v14, v14, v38, v39
    v_max3_f32 v14, v14, v40, v41
    v_max3_f32 v14, v14, v42, v43
    v_max3_f32 v14, v14, v44, v45
    v_max3_f32 v14, v14, v46, v47
    v_max3_f32 v15, v15, v48, v49
    v_max3_f32 v15, v15, v50, v51
    v_max3_f32 v15, v15, v52, v53
    v_max3_f32 v15, v15, v54, v55
    v_max3_f32 v15, v15, v56, v57
    v_max3_f32 v15, v15, v58, v59
    v_max3_f32 v15, v15, v60, v61
    v_max3_f32 v15, v15, v62, v63
    v_mfma_f32_32x32x16_bf16 v[32:47], a[16:19], v[104:107], 0
    v_mfma_f32_32x32x8_bf16 v[32:47], a[72:73], v[112:113], v[32:47]
    v_mfma_f32_32x32x16_bf16 v[48:63], a[16:19], v[108:111], 0
    v_mfma_f32_32x32x8_bf16 v[48:63], a[72:73], v[114:115], v[48:63]
    s_nop 9
    v_max3_f32 v14, v14, v32, v33
    v_max3_f32 v14, v14, v34, v35
    v_max3_f32 v14, v14, v36, v37
    v_max3_f32 v14, v14, v38, v39
    v_max3_f32 v14, v14, v40, v41
    v_max3_f32 v14, v14, v42, v43
    v_max3_f32 v14, v14, v44, v45
    v_max3_f32 v14, v14, v46, v47
    v_max3_f32 v15, v15, v48, v49
    v_max3_f32 v15, v15, v50, v51
    v_max3_f32 v15, v15, v52, v53
    v_max3_f32 v15, v15, v54, v55
    v_max3_f32 v15, v15, v56, v57
    v_max3_f32 v15, v15, v58, v59
    v_max3_f32 v15, v15, v60, v61
    v_max3_f32 v15, v15, v62, v63
    v_mfma_f32_32x32x16_bf16 v[32:47], a[20:23], v[104:107], 0
    v_mfma_f32_32x32x8_bf16 v[32:47], a[74:75], v[112:113], v[32:47]
    v_mfma_f32_32x32x16_bf16 v[48:63], a[20:23], v[108:111], 0
    v_mfma_f32_32x32x8_bf16 v[48:63], a[74:75], v[114:115], v[48:63]
    s_nop 9
    v_max3_f32 v14, v14, v32, v33
    v_max3_f32 v14, v14, v34, v35
    v_max3_f32 v14, v14, v36, v37
    v_max3_f32 v14, v14, v38, v39
    v_max3_f32 v14, v14, v40, v41
    v_max3_f32 v14, v14, v42, v43
    v_max3_f32 v14, v14, v44, v45
    v_max3_f32 v14, v14, v46, v47
    v_max3_f32 v15, v15, v48, v49
    v_max3_f32 v15, v15, v50, v51
    v_max3_f32 v15, v15, v52, v53
    v_max3_f32 v15, v15, v54, v55
    v_max3_f32 v15, v15, v56, v57
    v_max3_f32 v15, v15, v58, v59
    v_max3_f32 v15, v15, v60, v61
    v_max3_f32 v15, v15, v62, v63
    v_mfma_f32_32x32x16_bf16 v[32:47], a[24:27], v[104:107], 0
    v_mfma_f32_32x32x8_bf16 v[32:47], a[76:77], v[112:113], v[32:47]
    v_mfma_f32_32x32x16_bf16 v[48:63], a[24:27], v[108:111], 0
    v_mfma_f32_32x32x8_bf16 v[48:63], a[76:77], v[114:115], v[48:63]
    s_nop 9
    v_max3_f32 v14, v14, v32, v33
    v_max3_f32 v14, v14, v34, v35
    v_max3_f32 v14, v14, v36, v37
    v_max3_f32 v14, v14, v38, v39
    v_max3_f32 v14, v14, v40, v41
    v_max3_f32 v14, v14, v42, v43
    v_max3_f32 v14, v14, v44, v45
    v_max3_f32 v14, v14, v46, v47
    v_max3_f32 v15, v15, v48, v49
    v_max3_f32 v15, v15, v50, v51
    v_max3_f32 v15, v15, v52, v53
    v_max3_f32 v15, v15, v54, v55
    v_max3_f32 v15, v15, v56, v57
    v_max3_f32 v15, v15, v58, v59
    v_max3_f32 v15, v15, v60, v61
    v_max3_f32 v15, v15, v62, v63
    v_mfma_f32_32x32x16_bf16 v[32:47], a[28:31], v[104:107], 0
    v_mfma_f32_32x32x8_bf16 v[32:47], a[78:79], v[112:113], v[32:47]
    v_mfma_f32_32x32x16_bf16 v[48:63], a[28:31], v[108:111], 0
    v_mfma_f32_32x32x8_bf16 v[48:63], a[78:79], v[114:115], v[48:63]
    s_nop 9
    v_max3_f32 v14, v14, v32, v33
    v_max3_f32 v14, v14, v34, v35
    v_max3_f32 v14, v14, v36, v37
    v_max3_f32 v14, v14, v38, v39
    v_max3_f32 v14, v14, v40, v41
    v_max3_f32 v14, v14, v42, v43
    v_max3_f32 v14, v14, v44, v45
    v_max3_f32 v14, v14, v46, v47
    v_max3_f32 v15, v15, v48, v49
    v_max3_f32 v15, v15, v50, v51
    v_max3_f32 v15, v15, v52, v53
    v_max3_f32 v15, v15, v54, v55
    v_max3_f32 v15, v15, v56, v57
    v_max3_f32 v15, v15, v58, v59
    v_max3_f32 v15, v15, v60, v61
    v_max3_f32 v15, v15, v62, v63
    v_mfma_f32_32x32x16_bf16 v[32:47], a[32:35], v[104:107], 0
    v_mfma_f32_32x32x8_bf16 v[32:47], a[80:81], v[112:113], v[32:47]
    v_mfma_f32_32x32x16_bf16 v[48:63], a[32:35], v[108:111], 0
    v_mfma_f32_32x32x8_bf16 v[48:63], a[80:81], v[114:115], v[48:63]
    s_nop 9
    v_max3_f32 v14, v14, v32, v33
    v_max3_f32 v14, v14, v34, v35
    v_max3_f32 v14, v14, v36, v37
    v_max3_f32 v14, v14, v38, v39
    v_max3_f32 v14, v14, v40, v41
    v_max3_f32 v14, v14, v42, v43
    v_max3_f32 v14, v14, v44, v45
    v_max3_f32 v14, v14, v46, v47
    v_max3_f32 v15, v15, v48, v49
    v_max3_f32 v15, v15, v50, v51
    v_max3_f32 v15, v15, v52, v53
    v_max3_f32 v15, v15, v54, v55
    v_max3_f32 v15, v15, v56, v57
    v_max3_f32 v15, v15, v58, v59
    v_max3_f32 v15, v15, v60, v61
    v_max3_f32 v15, v15, v62, v63
    v_mfma_f32_32x32x16_bf16 v[32:47], a[36:39], v[104:107], 0
    v_mfma_f32_32x32x8_bf16 v[32:47], a[82:83], v[112:113], v[32:47]
    v_mfma_f32_32x32x16_bf16 v[48:63], a[36:39], v[108:111], 0
    v_mfma_f32_32x32x8_bf16 v[48:63], a[82:83], v[114:115], v[48:63]
    s_nop 9
    v_max3_f32 v14, v14, v32, v33
    v_max3_f32 v14, v14, v34, v35
    v_max3_f32 v14, v14, v36, v37
    v_max3_f32 v14, v14, v38, v39
    v_max3_f32 v14, v14, v40, v41
    v_max3_f32 v14, v14, v42, v43
    v_max3_f32 v14, v14, v44, v45
    v_max3_f32 v14, v14, v46, v47
    v_max3_f32 v15, v15, v48, v49
    v_max3_f32 v15, v15, v50, v51
    v_max3_f32 v15, v15, v52, v53
    v_max3_f32 v15, v15, v54, v55
    v_max3_f32 v15, v15, v56, v57
    v_max3_f32 v15, v15, v58, v59
    v_max3_f32 v15, v15, v60, v61
    v_max3_f32 v15, v15, v62, v63
    v_mfma_f32_32x32x16_bf16 v[32:47], a[40:43], v[104:107], 0
    v_mfma_f32_32x32x8_bf16 v[32:47], a[84:85], v[112:113], v[32:47]
    v_mfma_f32_32x32x16_bf16 v[48:63], a[40:43], v[108:111], 0
    v_mfma_f32_32x32x8_bf16 v[48:63], a[84:85], v[114:115], v[48:63]
    s_nop 9
    v_max3_f32 v14, v14, v32, v33
    v_max3_f32 v14, v14, v34, v35
    v_max3_f32 v14, v14, v36, v37
    v_max3_f32 v14, v14, v38, v39
    v_max3_f32 v14, v14, v40, v41
    v_max3_f32 v14, v14, v42, v43
    v_max3_f32 v14, v14, v44, v45
    v_max3_f32 v14, v14, v46, v47
    v_max3_f32 v15, v15, v48, v49
    v_max3_f32 v15, v15, v50, v51
    v_max3_f32 v15, v15, v52, v53
    v_max3_f32 v15, v15, v54, v55
    v_max3_f32 v15, v15, v56, v57
    v_max3_f32 v15, v15, v58, v59
    v_max3_f32 v15, v15, v60, v61
    v_max3_f32 v15, v15, v62, v63
    v_mfma_f32_32x32x16_bf16 v[32:47], a[44:47], v[104:107], 0
    v_mfma_f32_32x32x8_bf16 v[32:47], a[86:87], v[112:113], v[32:47]
    v_mfma_f32_32x32x16_bf16 v[48:63], a[44:47], v[108:111], 0
    v_mfma_f32_32x32x8_bf16 v[48:63], a[86:87], v[114:115], v[48:63]
    s_nop 9
    v_max3_f32 v14, v14, v32, v33
    v_max3_f32 v14, v14, v34, v35
    v_max3_f32 v14, v14, v36, v37
    v_max3_f32 v14, v14, v38, v39
    v_max3_f32 v14, v14, v40, v41
    v_max3_f32 v14, v14, v42, v43
    v_max3_f32 v14, v14, v44, v45
    v_max3_f32 v14, v14, v46, v47
    v_max3_f32 v15, v15, v48, v49
    v_max3_f32 v15, v15, v50, v51
    v_max3_f32 v15, v15, v52, v53
    v_max3_f32 v15, v15, v54, v55
    v_max3_f32 v15, v15, v56, v57
    v_max3_f32 v15, v15, v58, v59
    v_max3_f32 v15, v15, v60, v61
    v_max3_f32 v15, v15, v62, v63
    v_mfma_f32_32x32x16_bf16 v[32:47], a[48:51], v[104:107], 0
    v_mfma_f32_32x32x8_bf16 v[32:47], a[88:89], v[112:113], v[32:47]
    v_mfma_f32_32x32x16_bf16 v[48:63], a[48:51], v[108:111], 0
    v_mfma_f32_32x32x8_bf16 v[48:63], a[88:89], v[114:115], v[48:63]
    s_nop 9
    v_max3_f32 v14, v14, v32, v33
    v_max3_f32 v14, v14, v34, v35
    v_max3_f32 v14, v14, v36, v37
    v_max3_f32 v14, v14, v38, v39
    v_max3_f32 v14, v14, v40, v41
    v_max3_f32 v14, v14, v42, v43
    v_max3_f32 v14, v14, v44, v45
    v_max3_f32 v14, v14, v46, v47
    v_max3_f32 v15, v15, v48, v49
    v_max3_f32 v15, v15, v50, v51
    v_max3_f32 v15, v15, v52, v53
    v_max3_f32 v15, v15, v54, v55
    v_max3_f32 v15, v15, v56, v57
    v_max3_f32 v15, v15, v58, v59
    v_max3_f32 v15, v15, v60, v61
    v_max3_f32 v15, v15, v62, v63
    v_mfma_f32_32x32x16_bf16 v[32:47], a[52:55], v[104:107], 0
    v_mfma_f32_32x32x8_bf16 v[32:47], a[90:91], v[112:113], v[32:47]
    v_mfma_f32_32x32x16_bf16 v[48:63], a[52:55], v[108:111], 0
    v_mfma_f32_32x32x8_bf16 v[48:63], a[90:91], v[114:115], v[48:63]
    s_nop 9
    v_max3_f32 v14, v14, v32, v33
    v_max3_f32 v14, v14, v34, v35
    v_max3_f32 v14, v14, v36, v37
    v_max3_f32 v14, v14, v38, v39
    v_max3_f32 v14, v14, v40, v41
    v_max3_f32 v14, v14, v42, v43
    v_max3_f32 v14, v14, v44, v45
    v_max3_f32 v14, v14, v46, v47
    v_max3_f32 v15, v15, v48, v49
    v_max3_f32 v15, v15, v50, v51
    v_max3_f32 v15, v15, v52, v53
    v_max3_f32 v15, v15, v54, v55
    v_max3_f32 v15, v15, v56, v57
    v_max3_f32 v15, v15, v58, v59
    v_max3_f32 v15, v15, v60, v61
    v_max3_f32 v15, v15, v62, v63
    v_mfma_f32_32x32x16_bf16 v[32:47], a[56:59], v[104:107], 0
    v_mfma_f32_32x32x8_bf16 v[32:47], a[92:93], v[112:113], v[32:47]
    v_mfma_f32_32x32x16_bf16 v[48:63], a[56:59], v[108:111], 0
    v_mfma_f32_32x32x8_bf16 v[48:63], a[92:93], v[114:115], v[48:63]
    s_nop 9
    v_max3_f32 v14, v14, v32, v33
    v_max3_f32 v14, v14, v34, v35
    v_max3_f32 v14, v14, v36, v37
    v_max3_f32 v14, v14, v38, v39
    v_max3_f32 v14, v14, v40, v41
    v_max3_f32 v14, v14, v42, v43
    v_max3_f32 v14, v14, v44, v45
    v_max3_f32 v14, v14, v46, v47
    v_max3_f32 v15, v15, v48, v49
    v_max3_f32 v15, v15, v50, v51
    v_max3_f32 v15, v15, v52, v53
    v_max3_f32 v15, v15, v54, v55
    v_max3_f32 v15, v15, v56, v57
    v_max3_f32 v15, v15, v58, v59
    v_max3_f32 v15, v15, v60, v61
    v_max3_f32 v15, v15, v62, v63
    v_mfma_f32_32x32x16_bf16 v[32:47], a[60:63], v[104:107], 0
    v_mfma_f32_32x32x8_bf16 v[32:47], a[94:95], v[112:113], v[32:47]
    v_mfma_f32_32x32x16_bf16 v[48:63], a[60:63], v[108:111], 0
    v_mfma_f32_32x32x8_bf16 v[48:63], a[94:95], v[114:115], v[48:63]
    s_nop 9
    v_max3_f32 v14, v14, v32, v33
    v_max3_f32 v14, v14, v34, v35
    v_max3_f32 v14, v14, v36, v37
    v_max3_f32 v14, v14, v38, v39
    v_max3_f32 v14, v14, v40, v41
    v_max3_f32 v14, v14, v42, v43
    v_max3_f32 v14, v14, v44, v45
    v_max3_f32 v14, v14, v46, v47
    v_max3_f32 v15, v15, v48, v49
    v_max3_f32 v15, v15, v50, v51
    v_max3_f32 v15, v15, v52, v53
    v_max3_f32 v15, v15, v54, v55
    v_max3_f32 v15, v15, v56, v57
    v_max3_f32 v15, v15, v58, v59
    v_max3_f32 v15, v15, v60, v61
    v_max3_f32 v15, v15, v62, v63
    ds_write_b32 v12, v14
    ds_write_b32 v12, v15 offset:1024
    v_add_u32 v12, 2048, v12
    v_add_u32 v4, 3072, v4
    s_sub_u32 s42, s42, 1
    s_cmp_lg_u32 s42, 0
    s_cbranch_scc1 L_fbl
    s_waitcnt lgkmcnt(0)
    s_barrier
    s_lshl_b32 s40, s24, 11
    v_lshlrev_b32 v12, 2, v2
    v_add_u32 v12, s40, v12
    ds_read2st64_b32 v[32:33], v12 offset0:0 offset1:1
    ds_read2st64_b32 v[34:35], v12 offset0:2 offset1:3
    ds_read2st64_b32 v[36:37], v12 offset0:4 offset1:5
    ds_read2st64_b32 v[38:39], v12 offset0:6 offset1:7
    s_waitcnt lgkmcnt(2)
    v_max3_f32 v14, v32, v33, v34
    v_max_f32 v14, v14, v35
    v_mov_b32 v16, v14
    s_nop 1
    v_permlane32_swap_b32 v14, v16
    v_max_f32 v14, v14, v16
    v_sub_f32 v14, 0, v14
    v_cvt_pk_bf16_f32 v16, v14, v14
    v_and_b32 v16, 0xffff0000, v16
    v_sub_f32 v14, v14, v16
    v_cvt_pk_bf16_f32 v17, v14, v14
    v_and_b32 v17, 0xffff0000, v17
    v_sub_f32 v14, v14, v17
    v_cvt_pk_bf16_f32 v212, v16, v17
    v_cvt_pk_bf16_f32 v213, v14, 0
    s_waitcnt lgkmcnt(0)
    v_max3_f32 v14, v36, v37, v38
    v_max_f32 v14, v14, v39
    v_mov_b32 v16, v14
    s_nop 1
    v_permlane32_swap_b32 v14, v16
    v_max_f32 v14, v14, v16
    v_sub_f32 v14, 0, v14
    v_cvt_pk_bf16_f32 v16, v14, v14
    v_and_b32 v16, 0xffff0000, v16
    v_sub_f32 v14, v14, v16
    v_cvt_pk_bf16_f32 v17, v14, v14
    v_and_b32 v17, 0xffff0000, v17
    v_sub_f32 v14, v14, v17
    v_cvt_pk_bf16_f32 v214, v16, v17
    v_cvt_pk_bf16_f32 v215, v14, 0
    s_mov_b32 s43, 0x2000000
    v_mov_b32 v19, 0
L_codeend:
    s_branch L_att
.section .rodata,"a"
.p2align 6
.amdhsa_kernel sequential_preLN__softmax_full_mha__glu_gated_glu__prompt_kernel
  .amdhsa_next_free_vgpr 512
  .amdhsa_next_free_sgpr 102
  .amdhsa_accum_offset 256
  .amdhsa_group_segment_fixed_size 0
  .amdhsa_kernarg_size 80
  .amdhsa_user_sgpr_count 2
  .amdhsa_user_sgpr_kernarg_segment_ptr 1
  .amdhsa_system_sgpr_workgroup_id_x 1
.end_amdhsa_kernel
```
